```python
import torch

def _softmax(x, axis=-1):
    return torch.softmax(x, dim=axis)

def _gelu(x):
    return torch.nn.functional.gelu(x, approximate='tanh')

def _silu(x):
    return torch.nn.functional.silu(x)

def _sigmoid(x):
    return torch.sigmoid(x)

def _layernorm(x, axis=-1, eps=1e-05):
    m = x.mean(dim=axis, keepdim=True)
    v = x.var(dim=axis, keepdim=True, unbiased=False)
    return (x - m) / torch.sqrt(v + eps)

def _scatter_add(tgt, idx, src, axis=0):
    return tgt.clone().index_add_(axis, idx, src)

def _segment_sum(src, seg, n):
    out = torch.zeros((n,) + src.shape[1:], dtype=src.dtype)
    return out.index_add_(0, seg, src)

def _pad(x, pw):
    flat = tuple((v for pair in reversed(pw) for v in pair))
    return torch.nn.functional.pad(x, flat)
kernel_name = 'sequential_preLN__memory_aug_recurrent_mem_tr__swiglu_ffn__prompt'

def setup_inputs():

    _w = lambda a: (lambda t: t.to(torch.bfloat16) if t.is_floating_point() else t)(torch.as_tensor(a))

    def _A_setup():
        B, S, Dm = (1, 2048, 640)
        H, Dh = (32, 128)
        M, seg = (8, 32)
        seg = min(seg, S)
        S = S // seg * seg
        return {'x': _w((lambda *s: torch.randn(*s, dtype=torch.bfloat16) * 0.05)(B, S, Dm)), 'mem0': _w((lambda *s: torch.randn(*s, dtype=torch.bfloat16) * 0.2)(B, M, Dm)), 'Wq': _w((lambda *s: torch.randn(*s, dtype=torch.bfloat16) * 1.6)(Dm, H, Dh) * Dm ** (-0.5)), 'Wk': _w((lambda *s: torch.randn(*s, dtype=torch.bfloat16) * 1.6)(Dm, H, Dh) * Dm ** (-0.5)), 'Wv': _w((lambda *s: torch.randn(*s, dtype=torch.bfloat16) * 0.2)(Dm, H, Dh) * Dm ** (-0.5)), 'Wo': _w((lambda *s: torch.randn(*s, dtype=torch.bfloat16) * 0.2)(H, Dh, Dm) * (H * Dh) ** (-0.5)), 'seg_len': seg}
    _A_in = _A_setup()

    def _B_setup():
        B, S, D, F = (1, 2048, 640, 1728)
        return {'x': _w((lambda *s: torch.randn(*s, dtype=torch.bfloat16) * 0.05)(B, S, D)), 'w_gate': _w((lambda *s: torch.randn(*s, dtype=torch.bfloat16) * 0.05)(D, F)), 'w_up': _w((lambda *s: torch.randn(*s, dtype=torch.bfloat16) * 0.05)(D, F)), 'w_down': _w((lambda *s: torch.randn(*s, dtype=torch.bfloat16) * 0.05)(F, D))}
    _B_in = _B_setup()
    return {'A_x': _A_in['x'], 'A_mem0': _A_in['mem0'], 'A_Wq': _A_in['Wq'], 'A_Wk': _A_in['Wk'], 'A_Wv': _A_in['Wv'], 'A_Wo': _A_in['Wo'], 'A_seg_len': _A_in['seg_len'], 'B_x': _B_in['x'], 'B_w_gate': _B_in['w_gate'], 'B_w_up': _B_in['w_up'], 'B_w_down': _B_in['w_down']}

def reference(A_x, A_mem0, A_Wq, A_Wk, A_Wv, A_Wo, A_seg_len, B_x, B_w_gate, B_w_up, B_w_down):

    def _A_ref(x, mem0, Wq, Wk, Wv, Wo, seg_len):
        B, S, Dm = x.shape
        H, Dh = (Wq.shape[1], Wq.shape[2])
        M = mem0.shape[1]
        scale = Dh ** (-0.5)
        n_seg = S // seg_len
        L = M + seg_len
        idx = torch.arange(L)
        mask = (idx[:, None] < M) | (idx[:, None] >= idx[None, :])
        mem = mem0
        outs = []
        for s in range(n_seg):
            xs = x[:, s * seg_len:(s + 1) * seg_len, :].clone()
            h = torch.concatenate([mem, xs], axis=1)
            q = torch.einsum('btd,dhe->bhte', h, Wq)
            k = torch.einsum('btd,dhe->bhte', h, Wk)
            v = torch.einsum('btd,dhe->bhte', h, Wv)
            scores = torch.einsum('bhqe,bhke->bhqk', q, k) * scale
            scores = torch.where(mask[None, None], scores, -1000000000.0)
            p = _softmax(scores, axis=-1)
            o = torch.einsum('bhqk,bhke->bhqe', p, v)
            o = torch.einsum('bhte,hed->btd', o, Wo)
            mem = o[:, :M, :].clone()
            outs.append(o[:, M:, :])
        return torch.concatenate(outs, axis=1)

    def _B_ref(x, w_gate, w_up, w_down):
        g = _silu(x @ w_gate)
        u = x @ w_up
        return g * u @ w_down
    x = A_x
    h = x + _A_ref(_layernorm(x, axis=-1), A_mem0, A_Wq, A_Wk, A_Wv, A_Wo, A_seg_len)
    h2 = h + _B_ref(_layernorm(h, axis=-1), B_w_gate, B_w_up, B_w_down)
    return h2
```

```asm
; @launch grid=(256,1,1) block=(256,1,1) lds=163840
.amdgcn_target "amdgcn-amd-amdhsa--gfx950"
.text
.globl sequential_preLN__memory_aug_recurrent_mem_tr__swiglu_ffn__prompt_kernel
.p2align 8
.type sequential_preLN__memory_aug_recurrent_mem_tr__swiglu_ffn__prompt_kernel,@function
sequential_preLN__memory_aug_recurrent_mem_tr__swiglu_ffn__prompt_kernel:
  s_cmp_ge_u32 s2, 256
  s_cbranch_scc1 fz_end
  s_and_b32 s3, s2, 7
  s_lshr_b32 s16, s2, 3
  s_mul_i32 s60, s16, 6
  s_add_u32 s60, s60, s3
  s_sub_u32 s60, s60, 2
  s_cmp_gt_u32 s3, 1
  s_cbranch_scc1 worker
  s_load_dwordx2 s[4:5], s[0:1], 104
  s_mov_b32 s6, 268435456
  s_mov_b32 s7, 0x00020000
  s_load_dwordx2 s[12:13], s[0:1], 96
  s_mov_b32 s14, 256
  s_mov_b32 s15, 0x00020000
  v_lshrrev_b32 v1, 6, v0
  s_nop 0
  v_readfirstlane_b32 s17, v1
  v_and_b32 v0, 63, v0
  s_mov_b32 s40, 0xCCCCCCCC
  s_mov_b32 s41, 0xCCCCCCCC
  s_mov_b32 s42, -1
  s_mov_b32 s43, 0
  v_mov_b32 v1, 0x4444
  v_mov_b32 v2, 0xEEEE
  v_cndmask_b32 v1, v1, v2, s[40:41]
  v_lshlrev_b32 v2, 4, v0
  s_mov_b32 s44, 0x3e0293ee
  s_mov_b32 s61, 0x42700000
  s_mov_b32 s19, 0
  s_mov_b32 s64, 0
  s_mov_b32 s65, 0
  s_mov_b32 s66, 0
  s_mov_b32 s67, 0
  s_mov_b32 s68, 0
  s_mov_b32 s69, 0
  s_mov_b32 s70, 0
  s_mov_b32 s71, 0
  s_mov_b32 s72, 0
  s_mov_b32 s73, 0
  s_mov_b32 s74, 0
  s_mov_b32 s75, 0
  s_mov_b32 s76, 0
  s_mov_b32 s77, 0
  v_add_u32 v4, 32768, v2
  s_waitcnt lgkmcnt(0)
  s_cmp_eq_u32 s3, 1
  s_cbranch_scc1 chain_helper
  s_load_dwordx2 s[8:9], s[0:1], 16
  s_mov_b32 s10, 5242880
  s_mov_b32 s11, 0x00020000
  s_load_dwordx2 s[20:21], s[0:1], 24
  s_mov_b32 s22, 5242880
  s_mov_b32 s23, 0x00020000
  s_load_dwordx2 s[24:25], s[0:1], 40
  s_mov_b32 s26, 5242880
  s_mov_b32 s27, 0x00020000
  s_cmp_lg_u32 s17, 0
  s_cbranch_scc1 xo_4400001
  s_mov_b64 s[62:63], exec
  s_mov_b64 exec, 1
  v_mov_b32 v36, 0
  s_getreg_b32 s50, hwreg(HW_REG_XCC_ID)
  s_and_b32 s50, s50, 15
  s_lshl_b32 s50, 1, s50
  v_mov_b32 v37, s50
  buffer_atomic_or v37, v36, s[12:15], 0 offen offset:4
  s_waitcnt vmcnt(0)
  v_mov_b32 v37, 1
  buffer_atomic_add v37, v36, s[12:15], 0 offen
  s_waitcnt vmcnt(0)
  s_mov_b64 exec, s[62:63]
xo_4400001:
  s_load_dwordx2 s[84:85], s[0:1], 8
  s_mov_b32 s86, 10240
  s_mov_b32 s87, 0x00020000
  v_bfe_u32 v36, v0, 2, 2
  v_lshlrev_b32 v36, 1, v36
  v_and_b32 v37, 1, v0
  v_add_u32 v36, v36, v37
  v_mul_u32_u24 v36, 1280, v36
  v_lshrrev_b32 v37, 4, v0
  v_lshlrev_b32 v37, 5, v37
  v_add_u32 v36, v36, v37
  v_bfe_u32 v37, v0, 1, 1
  v_lshlrev_b32 v37, 2, v37
  v_add_u32 v36, v36, v37
  s_lshl_b32 s50, s17, 7
  s_waitcnt lgkmcnt(0)
  s_add_u32 s51, s50, 0
  buffer_load_dword v116, v36, s[84:87], s51 offen offset:0
  buffer_load_dword v117, v36, s[84:87], s51 offen offset:8
  buffer_load_dword v118, v36, s[84:87], s51 offen offset:16
  buffer_load_dword v119, v36, s[84:87], s51 offen offset:24
  s_add_u32 s51, s50, 512
  buffer_load_dword v120, v36, s[84:87], s51 offen offset:0
  buffer_load_dword v121, v36, s[84:87], s51 offen offset:8
  buffer_load_dword v122, v36, s[84:87], s51 offen offset:16
  buffer_load_dword v123, v36, s[84:87], s51 offen offset:24
  s_add_u32 s51, s50, 1024
  buffer_load_dword v124, v36, s[84:87], s51 offen offset:0
  buffer_load_dword v125, v36, s[84:87], s51 offen offset:8
  buffer_load_dword v126, v36, s[84:87], s51 offen offset:16
  buffer_load_dword v127, v36, s[84:87], s51 offen offset:24
  s_waitcnt vmcnt(0)
  v_lshrrev_b32 v36, 4, v0
  v_and_b32 v37, 15, v0
  v_lshlrev_b32 v37, 4, v37
  v_lshlrev_b32 v10, 13, v36
  v_add_u32 v10, v10, v37
  v_mul_u32_u24 v11, 1280, v36
  v_add_u32 v11, v11, v37
  v_lshrrev_b32 v36, 4, v0
  v_bfe_u32 v37, v0, 2, 2
  v_lshlrev_b32 v38, 3, v36
  v_add_u32 v38, v38, v37
  v_lshlrev_b32 v38, 8, v38
  v_and_b32 v39, 3, v0
  v_lshlrev_b32 v39, 3, v39
  v_add_u32 v12, v38, v39
  s_lshl_b32 s50, s17, 6
  v_add_u32 v12, s50, v12
  v_lshrrev_b32 v36, 4, v0
  v_bfe_u32 v37, v0, 2, 2
  v_and_b32 v38, 1, v36
  v_lshlrev_b32 v38, 5, v38
  v_lshrrev_b32 v39, 1, v36
  v_lshlrev_b32 v39, 2, v39
  v_add_u32 v38, v38, v39
  v_add_u32 v38, v38, v37
  v_lshlrev_b32 v38, 8, v38
  v_and_b32 v39, 3, v0
  v_lshlrev_b32 v39, 3, v39
  v_add_u32 v13, v38, v39
  s_lshl_b32 s50, s17, 5
  v_add_u32 v13, s50, v13
  s_lshl_b32 s28, s16, 8
  s_mul_i32 s29, s16, 163840
  s_waitcnt lgkmcnt(0)
  s_mul_i32 s50, s17, 131072
  s_add_u32 s50, s50, s28
  s_lshl_b32 s51, s17, 12
  s_add_u32 s52, s50, 0
  s_add_u32 m0, s51, 0
  s_nop 0
  buffer_load_dwordx4 v10, s[8:11], s52 offen lds
  s_add_u32 s52, s50, 32768
  s_add_u32 m0, s51, 1024
  s_nop 0
  buffer_load_dwordx4 v10, s[8:11], s52 offen lds
  s_add_u32 s52, s50, 65536
  s_add_u32 m0, s51, 2048
  s_nop 0
  buffer_load_dwordx4 v10, s[8:11], s52 offen lds
  s_add_u32 s52, s50, 98304
  s_add_u32 m0, s51, 3072
  s_nop 0
  buffer_load_dwordx4 v10, s[8:11], s52 offen lds
  s_mul_i32 s50, s17, 131072
  s_add_u32 s50, s50, s28
  s_lshl_b32 s51, s17, 12
  s_add_u32 s52, s50, 524288
  s_add_u32 m0, s51, 16384
  s_nop 0
  buffer_load_dwordx4 v10, s[8:11], s52 offen lds
  s_add_u32 s52, s50, 557056
  s_add_u32 m0, s51, 17408
  s_nop 0
  buffer_load_dwordx4 v10, s[8:11], s52 offen lds
  s_add_u32 s52, s50, 589824
  s_add_u32 m0, s51, 18432
  s_nop 0
  buffer_load_dwordx4 v10, s[8:11], s52 offen lds
  s_add_u32 s52, s50, 622592
  s_add_u32 m0, s51, 19456
  s_nop 0
  buffer_load_dwordx4 v10, s[8:11], s52 offen lds
  s_mul_i32 s50, s17, 131072
  s_add_u32 s50, s50, s28
  s_lshl_b32 s51, s17, 12
  s_add_u32 s52, s50, 1048576
  s_add_u32 m0, s51, 32768
  s_nop 0
  buffer_load_dwordx4 v10, s[8:11], s52 offen lds
  s_add_u32 s52, s50, 1081344
  s_add_u32 m0, s51, 33792
  s_nop 0
  buffer_load_dwordx4 v10, s[8:11], s52 offen lds
  s_add_u32 s52, s50, 1114112
  s_add_u32 m0, s51, 34816
  s_nop 0
  buffer_load_dwordx4 v10, s[8:11], s52 offen lds
  s_add_u32 s52, s50, 1146880
  s_add_u32 m0, s51, 35840
  s_nop 0
  buffer_load_dwordx4 v10, s[8:11], s52 offen lds
  s_mul_i32 s50, s17, 131072
  s_add_u32 s50, s50, s28
  s_lshl_b32 s51, s17, 12
  s_add_u32 s52, s50, 1572864
  s_add_u32 m0, s51, 49152
  s_nop 0
  buffer_load_dwordx4 v10, s[8:11], s52 offen lds
  s_add_u32 s52, s50, 1605632
  s_add_u32 m0, s51, 50176
  s_nop 0
  buffer_load_dwordx4 v10, s[8:11], s52 offen lds
  s_add_u32 s52, s50, 1638400
  s_add_u32 m0, s51, 51200
  s_nop 0
  buffer_load_dwordx4 v10, s[8:11], s52 offen lds
  s_add_u32 s52, s50, 1671168
  s_add_u32 m0, s51, 52224
  s_nop 0
  buffer_load_dwordx4 v10, s[8:11], s52 offen lds
  s_mul_i32 s50, s17, 131072
  s_add_u32 s50, s50, s28
  s_lshl_b32 s51, s17, 12
  s_add_u32 s52, s50, 2097152
  s_add_u32 m0, s51, 65536
  s_nop 0
  buffer_load_dwordx4 v10, s[8:11], s52 offen lds
  s_add_u32 s52, s50, 2129920
  s_add_u32 m0, s51, 66560
  s_nop 0
  buffer_load_dwordx4 v10, s[8:11], s52 offen lds
  s_add_u32 s52, s50, 2162688
  s_add_u32 m0, s51, 67584
  s_nop 0
  buffer_load_dwordx4 v10, s[8:11], s52 offen lds
  s_add_u32 s52, s50, 2195456
  s_add_u32 m0, s51, 68608
  s_nop 0
  buffer_load_dwordx4 v10, s[8:11], s52 offen lds
  s_mul_i32 s50, s17, 131072
  s_add_u32 s50, s50, s28
  s_lshl_b32 s51, s17, 12
  s_add_u32 s52, s50, 2621440
  s_add_u32 m0, s51, 81920
  s_nop 0
  buffer_load_dwordx4 v10, s[8:11], s52 offen lds
  s_add_u32 s52, s50, 2654208
  s_add_u32 m0, s51, 82944
  s_nop 0
  buffer_load_dwordx4 v10, s[8:11], s52 offen lds
  s_add_u32 s52, s50, 2686976
  s_add_u32 m0, s51, 83968
  s_nop 0
  buffer_load_dwordx4 v10, s[8:11], s52 offen lds
  s_add_u32 s52, s50, 2719744
  s_add_u32 m0, s51, 84992
  s_nop 0
  buffer_load_dwordx4 v10, s[8:11], s52 offen lds
  s_mul_i32 s50, s17, 131072
  s_add_u32 s50, s50, s28
  s_lshl_b32 s51, s17, 12
  s_add_u32 s52, s50, 3145728
  s_add_u32 m0, s51, 98304
  s_nop 0
  buffer_load_dwordx4 v10, s[8:11], s52 offen lds
  s_add_u32 s52, s50, 3178496
  s_add_u32 m0, s51, 99328
  s_nop 0
  buffer_load_dwordx4 v10, s[8:11], s52 offen lds
  s_add_u32 s52, s50, 3211264
  s_add_u32 m0, s51, 100352
  s_nop 0
  buffer_load_dwordx4 v10, s[8:11], s52 offen lds
  s_add_u32 s52, s50, 3244032
  s_add_u32 m0, s51, 101376
  s_nop 0
  buffer_load_dwordx4 v10, s[8:11], s52 offen lds
  s_mul_i32 s50, s17, 131072
  s_add_u32 s50, s50, s28
  s_lshl_b32 s51, s17, 12
  s_add_u32 s52, s50, 3670016
  s_add_u32 m0, s51, 114688
  s_nop 0
  buffer_load_dwordx4 v10, s[8:11], s52 offen lds
  s_add_u32 s52, s50, 3702784
  s_add_u32 m0, s51, 115712
  s_nop 0
  buffer_load_dwordx4 v10, s[8:11], s52 offen lds
  s_add_u32 s52, s50, 3735552
  s_add_u32 m0, s51, 116736
  s_nop 0
  buffer_load_dwordx4 v10, s[8:11], s52 offen lds
  s_add_u32 s52, s50, 3768320
  s_add_u32 m0, s51, 117760
  s_nop 0
  buffer_load_dwordx4 v10, s[8:11], s52 offen lds
  s_mul_i32 s50, s17, 131072
  s_add_u32 s50, s50, s28
  s_lshl_b32 s51, s17, 12
  s_add_u32 s52, s50, 4194304
  s_add_u32 m0, s51, 131072
  s_nop 0
  buffer_load_dwordx4 v10, s[8:11], s52 offen lds
  s_add_u32 s52, s50, 4227072
  s_add_u32 m0, s51, 132096
  s_nop 0
  buffer_load_dwordx4 v10, s[8:11], s52 offen lds
  s_add_u32 s52, s50, 4259840
  s_add_u32 m0, s51, 133120
  s_nop 0
  buffer_load_dwordx4 v10, s[8:11], s52 offen lds
  s_add_u32 s52, s50, 4292608
  s_add_u32 m0, s51, 134144
  s_nop 0
  buffer_load_dwordx4 v10, s[8:11], s52 offen lds
  s_waitcnt vmcnt(32)
  s_barrier
  s_mul_i32 s50, s17, 131072
  s_add_u32 s50, s50, s28
  s_lshl_b32 s51, s17, 12
  s_add_u32 s52, s50, 4718592
  s_add_u32 m0, s51, 147456
  s_nop 0
  buffer_load_dwordx4 v10, s[8:11], s52 offen lds
  s_add_u32 s52, s50, 4751360
  s_add_u32 m0, s51, 148480
  s_nop 0
  buffer_load_dwordx4 v10, s[8:11], s52 offen lds
  s_add_u32 s52, s50, 4784128
  s_add_u32 m0, s51, 149504
  s_nop 0
  buffer_load_dwordx4 v10, s[8:11], s52 offen lds
  s_add_u32 s52, s50, 4816896
  s_add_u32 m0, s51, 150528
  s_nop 0
  buffer_load_dwordx4 v10, s[8:11], s52 offen lds
  v_add_u32 v14, 0, v12
  ds_read_b64_tr_b16 a[0:1], v14 offset:0
  ds_read_b64_tr_b16 a[2:3], v14 offset:1024
  ds_read_b64_tr_b16 a[4:5], v14 offset:8192
  ds_read_b64_tr_b16 a[6:7], v14 offset:9216
  ds_read_b64_tr_b16 a[8:9], v14 offset:32
  ds_read_b64_tr_b16 a[10:11], v14 offset:1056
  ds_read_b64_tr_b16 a[12:13], v14 offset:8224
  ds_read_b64_tr_b16 a[14:15], v14 offset:9248
  s_waitcnt lgkmcnt(0)
  s_waitcnt vmcnt(32)
  s_barrier
  s_mul_i32 s50, s17, 131072
  s_add_u32 s50, s50, s28
  s_lshl_b32 s51, s17, 12
  s_add_u32 s52, s50, 0
  s_add_u32 m0, s51, 0
  s_nop 0
  buffer_load_dwordx4 v10, s[20:23], s52 offen lds
  s_add_u32 s52, s50, 32768
  s_add_u32 m0, s51, 1024
  s_nop 0
  buffer_load_dwordx4 v10, s[20:23], s52 offen lds
  s_add_u32 s52, s50, 65536
  s_add_u32 m0, s51, 2048
  s_nop 0
  buffer_load_dwordx4 v10, s[20:23], s52 offen lds
  s_add_u32 s52, s50, 98304
  s_add_u32 m0, s51, 3072
  s_nop 0
  buffer_load_dwordx4 v10, s[20:23], s52 offen lds
  v_add_u32 v14, 16384, v12
  ds_read_b64_tr_b16 a[16:17], v14 offset:0
  ds_read_b64_tr_b16 a[18:19], v14 offset:1024
  ds_read_b64_tr_b16 a[20:21], v14 offset:8192
  ds_read_b64_tr_b16 a[22:23], v14 offset:9216
  ds_read_b64_tr_b16 a[24:25], v14 offset:32
  ds_read_b64_tr_b16 a[26:27], v14 offset:1056
  ds_read_b64_tr_b16 a[28:29], v14 offset:8224
  ds_read_b64_tr_b16 a[30:31], v14 offset:9248
  s_waitcnt lgkmcnt(0)
  s_waitcnt vmcnt(32)
  s_barrier
  s_mul_i32 s50, s17, 131072
  s_add_u32 s50, s50, s28
  s_lshl_b32 s51, s17, 12
  s_add_u32 s52, s50, 524288
  s_add_u32 m0, s51, 16384
  s_nop 0
  buffer_load_dwordx4 v10, s[20:23], s52 offen lds
  s_add_u32 s52, s50, 557056
  s_add_u32 m0, s51, 17408
  s_nop 0
  buffer_load_dwordx4 v10, s[20:23], s52 offen lds
  s_add_u32 s52, s50, 589824
  s_add_u32 m0, s51, 18432
  s_nop 0
  buffer_load_dwordx4 v10, s[20:23], s52 offen lds
  s_add_u32 s52, s50, 622592
  s_add_u32 m0, s51, 19456
  s_nop 0
  buffer_load_dwordx4 v10, s[20:23], s52 offen lds
  v_add_u32 v14, 32768, v12
  ds_read_b64_tr_b16 a[32:33], v14 offset:0
  ds_read_b64_tr_b16 a[34:35], v14 offset:1024
  ds_read_b64_tr_b16 a[36:37], v14 offset:8192
  ds_read_b64_tr_b16 a[38:39], v14 offset:9216
  ds_read_b64_tr_b16 a[40:41], v14 offset:32
  ds_read_b64_tr_b16 a[42:43], v14 offset:1056
  ds_read_b64_tr_b16 a[44:45], v14 offset:8224
  ds_read_b64_tr_b16 a[46:47], v14 offset:9248
  s_waitcnt lgkmcnt(0)
  s_waitcnt vmcnt(32)
  s_barrier
  s_mul_i32 s50, s17, 131072
  s_add_u32 s50, s50, s28
  s_lshl_b32 s51, s17, 12
  s_add_u32 s52, s50, 1048576
  s_add_u32 m0, s51, 32768
  s_nop 0
  buffer_load_dwordx4 v10, s[20:23], s52 offen lds
  s_add_u32 s52, s50, 1081344
  s_add_u32 m0, s51, 33792
  s_nop 0
  buffer_load_dwordx4 v10, s[20:23], s52 offen lds
  s_add_u32 s52, s50, 1114112
  s_add_u32 m0, s51, 34816
  s_nop 0
  buffer_load_dwordx4 v10, s[20:23], s52 offen lds
  s_add_u32 s52, s50, 1146880
  s_add_u32 m0, s51, 35840
  s_nop 0
  buffer_load_dwordx4 v10, s[20:23], s52 offen lds
  v_add_u32 v14, 49152, v12
  ds_read_b64_tr_b16 a[48:49], v14 offset:0
  ds_read_b64_tr_b16 a[50:51], v14 offset:1024
  ds_read_b64_tr_b16 a[52:53], v14 offset:8192
  ds_read_b64_tr_b16 a[54:55], v14 offset:9216
  ds_read_b64_tr_b16 a[56:57], v14 offset:32
  ds_read_b64_tr_b16 a[58:59], v14 offset:1056
  ds_read_b64_tr_b16 a[60:61], v14 offset:8224
  ds_read_b64_tr_b16 a[62:63], v14 offset:9248
  s_waitcnt lgkmcnt(0)
  s_waitcnt vmcnt(32)
  s_barrier
  s_mul_i32 s50, s17, 131072
  s_add_u32 s50, s50, s28
  s_lshl_b32 s51, s17, 12
  s_add_u32 s52, s50, 1572864
  s_add_u32 m0, s51, 49152
  s_nop 0
  buffer_load_dwordx4 v10, s[20:23], s52 offen lds
  s_add_u32 s52, s50, 1605632
  s_add_u32 m0, s51, 50176
  s_nop 0
  buffer_load_dwordx4 v10, s[20:23], s52 offen lds
  s_add_u32 s52, s50, 1638400
  s_add_u32 m0, s51, 51200
  s_nop 0
  buffer_load_dwordx4 v10, s[20:23], s52 offen lds
  s_add_u32 s52, s50, 1671168
  s_add_u32 m0, s51, 52224
  s_nop 0
  buffer_load_dwordx4 v10, s[20:23], s52 offen lds
  v_add_u32 v14, 65536, v12
  ds_read_b64_tr_b16 a[64:65], v14 offset:0
  ds_read_b64_tr_b16 a[66:67], v14 offset:1024
  ds_read_b64_tr_b16 a[68:69], v14 offset:8192
  ds_read_b64_tr_b16 a[70:71], v14 offset:9216
  ds_read_b64_tr_b16 a[72:73], v14 offset:32
  ds_read_b64_tr_b16 a[74:75], v14 offset:1056
  ds_read_b64_tr_b16 a[76:77], v14 offset:8224
  ds_read_b64_tr_b16 a[78:79], v14 offset:9248
  s_waitcnt lgkmcnt(0)
  s_waitcnt vmcnt(32)
  s_barrier
  s_mul_i32 s50, s17, 131072
  s_add_u32 s50, s50, s28
  s_lshl_b32 s51, s17, 12
  s_add_u32 s52, s50, 2097152
  s_add_u32 m0, s51, 65536
  s_nop 0
  buffer_load_dwordx4 v10, s[20:23], s52 offen lds
  s_add_u32 s52, s50, 2129920
  s_add_u32 m0, s51, 66560
  s_nop 0
  buffer_load_dwordx4 v10, s[20:23], s52 offen lds
  s_add_u32 s52, s50, 2162688
  s_add_u32 m0, s51, 67584
  s_nop 0
  buffer_load_dwordx4 v10, s[20:23], s52 offen lds
  s_add_u32 s52, s50, 2195456
  s_add_u32 m0, s51, 68608
  s_nop 0
  buffer_load_dwordx4 v10, s[20:23], s52 offen lds
  v_add_u32 v14, 81920, v12
  ds_read_b64_tr_b16 a[80:81], v14 offset:0
  ds_read_b64_tr_b16 a[82:83], v14 offset:1024
  ds_read_b64_tr_b16 a[84:85], v14 offset:8192
  ds_read_b64_tr_b16 a[86:87], v14 offset:9216
  ds_read_b64_tr_b16 a[88:89], v14 offset:32
  ds_read_b64_tr_b16 a[90:91], v14 offset:1056
  ds_read_b64_tr_b16 a[92:93], v14 offset:8224
  ds_read_b64_tr_b16 a[94:95], v14 offset:9248
  s_waitcnt lgkmcnt(0)
  s_waitcnt vmcnt(32)
  s_barrier
  s_mul_i32 s50, s17, 131072
  s_add_u32 s50, s50, s28
  s_lshl_b32 s51, s17, 12
  s_add_u32 s52, s50, 2621440
  s_add_u32 m0, s51, 81920
  s_nop 0
  buffer_load_dwordx4 v10, s[20:23], s52 offen lds
  s_add_u32 s52, s50, 2654208
  s_add_u32 m0, s51, 82944
  s_nop 0
  buffer_load_dwordx4 v10, s[20:23], s52 offen lds
  s_add_u32 s52, s50, 2686976
  s_add_u32 m0, s51, 83968
  s_nop 0
  buffer_load_dwordx4 v10, s[20:23], s52 offen lds
  s_add_u32 s52, s50, 2719744
  s_add_u32 m0, s51, 84992
  s_nop 0
  buffer_load_dwordx4 v10, s[20:23], s52 offen lds
  v_add_u32 v14, 98304, v12
  ds_read_b64_tr_b16 a[96:97], v14 offset:0
  ds_read_b64_tr_b16 a[98:99], v14 offset:1024
  ds_read_b64_tr_b16 a[100:101], v14 offset:8192
  ds_read_b64_tr_b16 a[102:103], v14 offset:9216
  ds_read_b64_tr_b16 a[104:105], v14 offset:32
  ds_read_b64_tr_b16 a[106:107], v14 offset:1056
  ds_read_b64_tr_b16 a[108:109], v14 offset:8224
  ds_read_b64_tr_b16 a[110:111], v14 offset:9248
  s_waitcnt lgkmcnt(0)
  s_waitcnt vmcnt(32)
  s_barrier
  s_mul_i32 s50, s17, 131072
  s_add_u32 s50, s50, s28
  s_lshl_b32 s51, s17, 12
  s_add_u32 s52, s50, 3145728
  s_add_u32 m0, s51, 98304
  s_nop 0
  buffer_load_dwordx4 v10, s[20:23], s52 offen lds
  s_add_u32 s52, s50, 3178496
  s_add_u32 m0, s51, 99328
  s_nop 0
  buffer_load_dwordx4 v10, s[20:23], s52 offen lds
  s_add_u32 s52, s50, 3211264
  s_add_u32 m0, s51, 100352
  s_nop 0
  buffer_load_dwordx4 v10, s[20:23], s52 offen lds
  s_add_u32 s52, s50, 3244032
  s_add_u32 m0, s51, 101376
  s_nop 0
  buffer_load_dwordx4 v10, s[20:23], s52 offen lds
  v_add_u32 v14, 114688, v12
  ds_read_b64_tr_b16 a[112:113], v14 offset:0
  ds_read_b64_tr_b16 a[114:115], v14 offset:1024
  ds_read_b64_tr_b16 a[116:117], v14 offset:8192
  ds_read_b64_tr_b16 a[118:119], v14 offset:9216
  ds_read_b64_tr_b16 a[120:121], v14 offset:32
  ds_read_b64_tr_b16 a[122:123], v14 offset:1056
  ds_read_b64_tr_b16 a[124:125], v14 offset:8224
  ds_read_b64_tr_b16 a[126:127], v14 offset:9248
  s_waitcnt lgkmcnt(0)
  s_waitcnt vmcnt(32)
  s_barrier
  s_mul_i32 s50, s17, 131072
  s_add_u32 s50, s50, s28
  s_lshl_b32 s51, s17, 12
  s_add_u32 s52, s50, 3670016
  s_add_u32 m0, s51, 114688
  s_nop 0
  buffer_load_dwordx4 v10, s[20:23], s52 offen lds
  s_add_u32 s52, s50, 3702784
  s_add_u32 m0, s51, 115712
  s_nop 0
  buffer_load_dwordx4 v10, s[20:23], s52 offen lds
  s_add_u32 s52, s50, 3735552
  s_add_u32 m0, s51, 116736
  s_nop 0
  buffer_load_dwordx4 v10, s[20:23], s52 offen lds
  s_add_u32 s52, s50, 3768320
  s_add_u32 m0, s51, 117760
  s_nop 0
  buffer_load_dwordx4 v10, s[20:23], s52 offen lds
  v_add_u32 v14, 131072, v12
  ds_read_b64_tr_b16 a[128:129], v14 offset:0
  ds_read_b64_tr_b16 a[130:131], v14 offset:1024
  ds_read_b64_tr_b16 a[132:133], v14 offset:8192
  ds_read_b64_tr_b16 a[134:135], v14 offset:9216
  ds_read_b64_tr_b16 a[136:137], v14 offset:32
  ds_read_b64_tr_b16 a[138:139], v14 offset:1056
  ds_read_b64_tr_b16 a[140:141], v14 offset:8224
  ds_read_b64_tr_b16 a[142:143], v14 offset:9248
  s_waitcnt lgkmcnt(0)
  s_waitcnt vmcnt(32)
  s_barrier
  s_mul_i32 s50, s17, 131072
  s_add_u32 s50, s50, s28
  s_lshl_b32 s51, s17, 12
  s_add_u32 s52, s50, 4194304
  s_add_u32 m0, s51, 131072
  s_nop 0
  buffer_load_dwordx4 v10, s[20:23], s52 offen lds
  s_add_u32 s52, s50, 4227072
  s_add_u32 m0, s51, 132096
  s_nop 0
  buffer_load_dwordx4 v10, s[20:23], s52 offen lds
  s_add_u32 s52, s50, 4259840
  s_add_u32 m0, s51, 133120
  s_nop 0
  buffer_load_dwordx4 v10, s[20:23], s52 offen lds
  s_add_u32 s52, s50, 4292608
  s_add_u32 m0, s51, 134144
  s_nop 0
  buffer_load_dwordx4 v10, s[20:23], s52 offen lds
  v_add_u32 v14, 147456, v12
  ds_read_b64_tr_b16 a[144:145], v14 offset:0
  ds_read_b64_tr_b16 a[146:147], v14 offset:1024
  ds_read_b64_tr_b16 a[148:149], v14 offset:8192
  ds_read_b64_tr_b16 a[150:151], v14 offset:9216
  ds_read_b64_tr_b16 a[152:153], v14 offset:32
  ds_read_b64_tr_b16 a[154:155], v14 offset:1056
  ds_read_b64_tr_b16 a[156:157], v14 offset:8224
  ds_read_b64_tr_b16 a[158:159], v14 offset:9248
  s_waitcnt lgkmcnt(0)
  s_waitcnt vmcnt(32)
  s_barrier
  s_mul_i32 s50, s17, 131072
  s_add_u32 s50, s50, s28
  s_lshl_b32 s51, s17, 12
  s_add_u32 s52, s50, 4718592
  s_add_u32 m0, s51, 147456
  s_nop 0
  buffer_load_dwordx4 v10, s[20:23], s52 offen lds
  s_add_u32 s52, s50, 4751360
  s_add_u32 m0, s51, 148480
  s_nop 0
  buffer_load_dwordx4 v10, s[20:23], s52 offen lds
  s_add_u32 s52, s50, 4784128
  s_add_u32 m0, s51, 149504
  s_nop 0
  buffer_load_dwordx4 v10, s[20:23], s52 offen lds
  s_add_u32 s52, s50, 4816896
  s_add_u32 m0, s51, 150528
  s_nop 0
  buffer_load_dwordx4 v10, s[20:23], s52 offen lds
  v_add_u32 v14, 0, v12
  ds_read_b64_tr_b16 a[160:161], v14 offset:0
  ds_read_b64_tr_b16 a[162:163], v14 offset:1024
  ds_read_b64_tr_b16 a[164:165], v14 offset:8192
  ds_read_b64_tr_b16 a[166:167], v14 offset:9216
  ds_read_b64_tr_b16 a[168:169], v14 offset:32
  ds_read_b64_tr_b16 a[170:171], v14 offset:1056
  ds_read_b64_tr_b16 a[172:173], v14 offset:8224
  ds_read_b64_tr_b16 a[174:175], v14 offset:9248
  s_waitcnt lgkmcnt(0)
  s_waitcnt vmcnt(32)
  s_barrier
  s_mul_i32 s50, s17, 20480
  s_add_u32 s50, s50, s29
  s_lshl_b32 s51, s17, 12
  s_add_u32 s52, s50, 0
  s_add_u32 m0, s51, 0
  s_nop 0
  buffer_load_dwordx4 v11, s[24:27], s52 offen lds
  s_add_u32 s52, s50, 5120
  s_add_u32 m0, s51, 1024
  s_nop 0
  buffer_load_dwordx4 v11, s[24:27], s52 offen lds
  s_add_u32 s52, s50, 10240
  s_add_u32 m0, s51, 2048
  s_nop 0
  buffer_load_dwordx4 v11, s[24:27], s52 offen lds
  s_add_u32 s52, s50, 15360
  s_add_u32 m0, s51, 3072
  s_nop 0
  buffer_load_dwordx4 v11, s[24:27], s52 offen lds
  v_add_u32 v14, 16384, v12
  ds_read_b64_tr_b16 a[176:177], v14 offset:0
  ds_read_b64_tr_b16 a[178:179], v14 offset:1024
  ds_read_b64_tr_b16 a[180:181], v14 offset:8192
  ds_read_b64_tr_b16 a[182:183], v14 offset:9216
  ds_read_b64_tr_b16 a[184:185], v14 offset:32
  ds_read_b64_tr_b16 a[186:187], v14 offset:1056
  ds_read_b64_tr_b16 a[188:189], v14 offset:8224
  ds_read_b64_tr_b16 a[190:191], v14 offset:9248
  s_waitcnt lgkmcnt(0)
  s_waitcnt vmcnt(32)
  s_barrier
  s_mul_i32 s50, s17, 20480
  s_add_u32 s50, s50, s29
  s_lshl_b32 s51, s17, 12
  s_add_u32 s52, s50, 256
  s_add_u32 m0, s51, 16384
  s_nop 0
  buffer_load_dwordx4 v11, s[24:27], s52 offen lds
  s_add_u32 s52, s50, 5376
  s_add_u32 m0, s51, 17408
  s_nop 0
  buffer_load_dwordx4 v11, s[24:27], s52 offen lds
  s_add_u32 s52, s50, 10496
  s_add_u32 m0, s51, 18432
  s_nop 0
  buffer_load_dwordx4 v11, s[24:27], s52 offen lds
  s_add_u32 s52, s50, 15616
  s_add_u32 m0, s51, 19456
  s_nop 0
  buffer_load_dwordx4 v11, s[24:27], s52 offen lds
  v_add_u32 v14, 32768, v12
  ds_read_b64_tr_b16 a[192:193], v14 offset:0
  ds_read_b64_tr_b16 a[194:195], v14 offset:1024
  ds_read_b64_tr_b16 a[196:197], v14 offset:8192
  ds_read_b64_tr_b16 a[198:199], v14 offset:9216
  ds_read_b64_tr_b16 a[200:201], v14 offset:32
  ds_read_b64_tr_b16 a[202:203], v14 offset:1056
  ds_read_b64_tr_b16 a[204:205], v14 offset:8224
  ds_read_b64_tr_b16 a[206:207], v14 offset:9248
  s_waitcnt lgkmcnt(0)
  s_waitcnt vmcnt(32)
  s_barrier
  s_mul_i32 s50, s17, 20480
  s_add_u32 s50, s50, s29
  s_lshl_b32 s51, s17, 12
  s_add_u32 s52, s50, 512
  s_add_u32 m0, s51, 32768
  s_nop 0
  buffer_load_dwordx4 v11, s[24:27], s52 offen lds
  s_add_u32 s52, s50, 5632
  s_add_u32 m0, s51, 33792
  s_nop 0
  buffer_load_dwordx4 v11, s[24:27], s52 offen lds
  s_add_u32 s52, s50, 10752
  s_add_u32 m0, s51, 34816
  s_nop 0
  buffer_load_dwordx4 v11, s[24:27], s52 offen lds
  s_add_u32 s52, s50, 15872
  s_add_u32 m0, s51, 35840
  s_nop 0
  buffer_load_dwordx4 v11, s[24:27], s52 offen lds
  v_add_u32 v14, 49152, v12
  ds_read_b64_tr_b16 a[208:209], v14 offset:0
  ds_read_b64_tr_b16 a[210:211], v14 offset:1024
  ds_read_b64_tr_b16 a[212:213], v14 offset:8192
  ds_read_b64_tr_b16 a[214:215], v14 offset:9216
  ds_read_b64_tr_b16 a[216:217], v14 offset:32
  ds_read_b64_tr_b16 a[218:219], v14 offset:1056
  ds_read_b64_tr_b16 a[220:221], v14 offset:8224
  ds_read_b64_tr_b16 a[222:223], v14 offset:9248
  s_waitcnt lgkmcnt(0)
  s_waitcnt vmcnt(32)
  s_barrier
  s_mul_i32 s50, s17, 20480
  s_add_u32 s50, s50, s29
  s_lshl_b32 s51, s17, 12
  s_add_u32 s52, s50, 768
  s_add_u32 m0, s51, 49152
  s_nop 0
  buffer_load_dwordx4 v11, s[24:27], s52 offen lds
  s_add_u32 s52, s50, 5888
  s_add_u32 m0, s51, 50176
  s_nop 0
  buffer_load_dwordx4 v11, s[24:27], s52 offen lds
  s_add_u32 s52, s50, 11008
  s_add_u32 m0, s51, 51200
  s_nop 0
  buffer_load_dwordx4 v11, s[24:27], s52 offen lds
  s_add_u32 s52, s50, 16128
  s_add_u32 m0, s51, 52224
  s_nop 0
  buffer_load_dwordx4 v11, s[24:27], s52 offen lds
  v_add_u32 v14, 65536, v12
  ds_read_b64_tr_b16 a[224:225], v14 offset:0
  ds_read_b64_tr_b16 a[226:227], v14 offset:1024
  ds_read_b64_tr_b16 a[228:229], v14 offset:8192
  ds_read_b64_tr_b16 a[230:231], v14 offset:9216
  ds_read_b64_tr_b16 a[232:233], v14 offset:32
  ds_read_b64_tr_b16 a[234:235], v14 offset:1056
  ds_read_b64_tr_b16 a[236:237], v14 offset:8224
  ds_read_b64_tr_b16 a[238:239], v14 offset:9248
  s_waitcnt lgkmcnt(0)
  s_waitcnt vmcnt(32)
  s_barrier
  s_mul_i32 s50, s17, 20480
  s_add_u32 s50, s50, s29
  s_lshl_b32 s51, s17, 12
  s_add_u32 s52, s50, 1024
  s_add_u32 m0, s51, 65536
  s_nop 0
  buffer_load_dwordx4 v11, s[24:27], s52 offen lds
  s_add_u32 s52, s50, 6144
  s_add_u32 m0, s51, 66560
  s_nop 0
  buffer_load_dwordx4 v11, s[24:27], s52 offen lds
  s_add_u32 s52, s50, 11264
  s_add_u32 m0, s51, 67584
  s_nop 0
  buffer_load_dwordx4 v11, s[24:27], s52 offen lds
  s_add_u32 s52, s50, 16384
  s_add_u32 m0, s51, 68608
  s_nop 0
  buffer_load_dwordx4 v11, s[24:27], s52 offen lds
  v_add_u32 v14, 81920, v12
  ds_read_b64_tr_b16 a[240:241], v14 offset:0
  ds_read_b64_tr_b16 a[242:243], v14 offset:1024
  ds_read_b64_tr_b16 a[244:245], v14 offset:8192
  ds_read_b64_tr_b16 a[246:247], v14 offset:9216
  ds_read_b64_tr_b16 a[248:249], v14 offset:32
  ds_read_b64_tr_b16 a[250:251], v14 offset:1056
  ds_read_b64_tr_b16 a[252:253], v14 offset:8224
  ds_read_b64_tr_b16 a[254:255], v14 offset:9248
  s_waitcnt lgkmcnt(0)
  s_waitcnt vmcnt(32)
  s_barrier
  s_mul_i32 s50, s17, 20480
  s_add_u32 s50, s50, s29
  s_lshl_b32 s51, s17, 12
  s_add_u32 s52, s50, 81920
  s_add_u32 m0, s51, 81920
  s_nop 0
  buffer_load_dwordx4 v11, s[24:27], s52 offen lds
  s_add_u32 s52, s50, 87040
  s_add_u32 m0, s51, 82944
  s_nop 0
  buffer_load_dwordx4 v11, s[24:27], s52 offen lds
  s_add_u32 s52, s50, 92160
  s_add_u32 m0, s51, 83968
  s_nop 0
  buffer_load_dwordx4 v11, s[24:27], s52 offen lds
  s_add_u32 s52, s50, 97280
  s_add_u32 m0, s51, 84992
  s_nop 0
  buffer_load_dwordx4 v11, s[24:27], s52 offen lds
  v_add_u32 v14, 98304, v12
  ds_read_b64_tr_b16 v[128:129], v14 offset:0
  ds_read_b64_tr_b16 v[130:131], v14 offset:1024
  ds_read_b64_tr_b16 v[132:133], v14 offset:8192
  ds_read_b64_tr_b16 v[134:135], v14 offset:9216
  ds_read_b64_tr_b16 v[136:137], v14 offset:32
  ds_read_b64_tr_b16 v[138:139], v14 offset:1056
  ds_read_b64_tr_b16 v[140:141], v14 offset:8224
  ds_read_b64_tr_b16 v[142:143], v14 offset:9248
  s_waitcnt lgkmcnt(0)
  s_waitcnt vmcnt(32)
  s_barrier
  s_mul_i32 s50, s17, 20480
  s_add_u32 s50, s50, s29
  s_lshl_b32 s51, s17, 12
  s_add_u32 s52, s50, 82176
  s_add_u32 m0, s51, 98304
  s_nop 0
  buffer_load_dwordx4 v11, s[24:27], s52 offen lds
  s_add_u32 s52, s50, 87296
  s_add_u32 m0, s51, 99328
  s_nop 0
  buffer_load_dwordx4 v11, s[24:27], s52 offen lds
  s_add_u32 s52, s50, 92416
  s_add_u32 m0, s51, 100352
  s_nop 0
  buffer_load_dwordx4 v11, s[24:27], s52 offen lds
  s_add_u32 s52, s50, 97536
  s_add_u32 m0, s51, 101376
  s_nop 0
  buffer_load_dwordx4 v11, s[24:27], s52 offen lds
  v_add_u32 v14, 114688, v12
  ds_read_b64_tr_b16 v[144:145], v14 offset:0
  ds_read_b64_tr_b16 v[146:147], v14 offset:1024
  ds_read_b64_tr_b16 v[148:149], v14 offset:8192
  ds_read_b64_tr_b16 v[150:151], v14 offset:9216
  ds_read_b64_tr_b16 v[152:153], v14 offset:32
  ds_read_b64_tr_b16 v[154:155], v14 offset:1056
  ds_read_b64_tr_b16 v[156:157], v14 offset:8224
  ds_read_b64_tr_b16 v[158:159], v14 offset:9248
  s_waitcnt lgkmcnt(0)
  s_waitcnt vmcnt(32)
  s_barrier
  s_mul_i32 s50, s17, 20480
  s_add_u32 s50, s50, s29
  s_lshl_b32 s51, s17, 12
  s_add_u32 s52, s50, 82432
  s_add_u32 m0, s51, 114688
  s_nop 0
  buffer_load_dwordx4 v11, s[24:27], s52 offen lds
  s_add_u32 s52, s50, 87552
  s_add_u32 m0, s51, 115712
  s_nop 0
  buffer_load_dwordx4 v11, s[24:27], s52 offen lds
  s_add_u32 s52, s50, 92672
  s_add_u32 m0, s51, 116736
  s_nop 0
  buffer_load_dwordx4 v11, s[24:27], s52 offen lds
  s_add_u32 s52, s50, 97792
  s_add_u32 m0, s51, 117760
  s_nop 0
  buffer_load_dwordx4 v11, s[24:27], s52 offen lds
  v_add_u32 v14, 131072, v12
  ds_read_b64_tr_b16 v[160:161], v14 offset:0
  ds_read_b64_tr_b16 v[162:163], v14 offset:1024
  ds_read_b64_tr_b16 v[164:165], v14 offset:8192
  ds_read_b64_tr_b16 v[166:167], v14 offset:9216
  ds_read_b64_tr_b16 v[168:169], v14 offset:32
  ds_read_b64_tr_b16 v[170:171], v14 offset:1056
  ds_read_b64_tr_b16 v[172:173], v14 offset:8224
  ds_read_b64_tr_b16 v[174:175], v14 offset:9248
  s_waitcnt lgkmcnt(0)
  s_waitcnt vmcnt(32)
  s_barrier
  s_mul_i32 s50, s17, 20480
  s_add_u32 s50, s50, s29
  s_lshl_b32 s51, s17, 12
  s_add_u32 s52, s50, 82688
  s_add_u32 m0, s51, 131072
  s_nop 0
  buffer_load_dwordx4 v11, s[24:27], s52 offen lds
  s_add_u32 s52, s50, 87808
  s_add_u32 m0, s51, 132096
  s_nop 0
  buffer_load_dwordx4 v11, s[24:27], s52 offen lds
  s_add_u32 s52, s50, 92928
  s_add_u32 m0, s51, 133120
  s_nop 0
  buffer_load_dwordx4 v11, s[24:27], s52 offen lds
  s_add_u32 s52, s50, 98048
  s_add_u32 m0, s51, 134144
  s_nop 0
  buffer_load_dwordx4 v11, s[24:27], s52 offen lds
  v_add_u32 v14, 147456, v12
  ds_read_b64_tr_b16 v[176:177], v14 offset:0
  ds_read_b64_tr_b16 v[178:179], v14 offset:1024
  ds_read_b64_tr_b16 v[180:181], v14 offset:8192
  ds_read_b64_tr_b16 v[182:183], v14 offset:9216
  ds_read_b64_tr_b16 v[184:185], v14 offset:32
  ds_read_b64_tr_b16 v[186:187], v14 offset:1056
  ds_read_b64_tr_b16 v[188:189], v14 offset:8224
  ds_read_b64_tr_b16 v[190:191], v14 offset:9248
  s_waitcnt lgkmcnt(0)
  s_waitcnt vmcnt(32)
  s_barrier
  s_mul_i32 s50, s17, 20480
  s_add_u32 s50, s50, s29
  s_lshl_b32 s51, s17, 12
  s_add_u32 s52, s50, 82944
  s_add_u32 m0, s51, 147456
  s_nop 0
  buffer_load_dwordx4 v11, s[24:27], s52 offen lds
  s_add_u32 s52, s50, 88064
  s_add_u32 m0, s51, 148480
  s_nop 0
  buffer_load_dwordx4 v11, s[24:27], s52 offen lds
  s_add_u32 s52, s50, 93184
  s_add_u32 m0, s51, 149504
  s_nop 0
  buffer_load_dwordx4 v11, s[24:27], s52 offen lds
  s_add_u32 s52, s50, 98304
  s_add_u32 m0, s51, 150528
  s_nop 0
  buffer_load_dwordx4 v11, s[24:27], s52 offen lds
  v_add_u32 v14, 0, v13
  ds_read_b64_tr_b16 v[192:193], v14 offset:0
  ds_read_b64_tr_b16 v[194:195], v14 offset:4096
  ds_read_b64_tr_b16 v[196:197], v14 offset:2048
  ds_read_b64_tr_b16 v[198:199], v14 offset:6144
  ds_read_b64_tr_b16 v[200:201], v14 offset:128
  ds_read_b64_tr_b16 v[202:203], v14 offset:4224
  ds_read_b64_tr_b16 v[204:205], v14 offset:2176
  ds_read_b64_tr_b16 v[206:207], v14 offset:6272
  s_waitcnt lgkmcnt(0)
  s_waitcnt vmcnt(32)
  s_barrier
  v_add_u32 v14, 16384, v13
  ds_read_b64_tr_b16 v[208:209], v14 offset:0
  ds_read_b64_tr_b16 v[210:211], v14 offset:4096
  ds_read_b64_tr_b16 v[212:213], v14 offset:2048
  ds_read_b64_tr_b16 v[214:215], v14 offset:6144
  ds_read_b64_tr_b16 v[216:217], v14 offset:128
  ds_read_b64_tr_b16 v[218:219], v14 offset:4224
  ds_read_b64_tr_b16 v[220:221], v14 offset:2176
  ds_read_b64_tr_b16 v[222:223], v14 offset:6272
  s_waitcnt lgkmcnt(0)
  s_waitcnt vmcnt(28)
  s_barrier
  v_add_u32 v14, 32768, v13
  ds_read_b64_tr_b16 v[224:225], v14 offset:0
  ds_read_b64_tr_b16 v[226:227], v14 offset:4096
  ds_read_b64_tr_b16 v[228:229], v14 offset:2048
  ds_read_b64_tr_b16 v[230:231], v14 offset:6144
  ds_read_b64_tr_b16 v[232:233], v14 offset:128
  ds_read_b64_tr_b16 v[234:235], v14 offset:4224
  ds_read_b64_tr_b16 v[236:237], v14 offset:2176
  ds_read_b64_tr_b16 v[238:239], v14 offset:6272
  s_waitcnt lgkmcnt(0)
  s_waitcnt vmcnt(24)
  s_barrier
  v_add_u32 v14, 49152, v13
  ds_read_b64_tr_b16 v[240:241], v14 offset:0
  ds_read_b64_tr_b16 v[242:243], v14 offset:4096
  ds_read_b64_tr_b16 v[244:245], v14 offset:2048
  ds_read_b64_tr_b16 v[246:247], v14 offset:6144
  ds_read_b64_tr_b16 v[248:249], v14 offset:128
  ds_read_b64_tr_b16 v[250:251], v14 offset:4224
  ds_read_b64_tr_b16 v[252:253], v14 offset:2176
  ds_read_b64_tr_b16 v[254:255], v14 offset:6272
  s_waitcnt lgkmcnt(0)
  s_waitcnt vmcnt(20)
  s_barrier
  v_add_u32 v14, 65536, v13
  ds_read_b64_tr_b16 v[84:85], v14 offset:0
  ds_read_b64_tr_b16 v[86:87], v14 offset:4096
  ds_read_b64_tr_b16 v[88:89], v14 offset:2048
  ds_read_b64_tr_b16 v[90:91], v14 offset:6144
  ds_read_b64_tr_b16 v[92:93], v14 offset:128
  ds_read_b64_tr_b16 v[94:95], v14 offset:4224
  ds_read_b64_tr_b16 v[96:97], v14 offset:2176
  ds_read_b64_tr_b16 v[98:99], v14 offset:6272
  s_waitcnt lgkmcnt(0)
  s_waitcnt vmcnt(16)
  s_barrier
  v_add_u32 v14, 81920, v13
  ds_read_b64_tr_b16 v[20:21], v14 offset:0
  ds_read_b64_tr_b16 v[22:23], v14 offset:4096
  ds_read_b64_tr_b16 v[24:25], v14 offset:2048
  ds_read_b64_tr_b16 v[26:27], v14 offset:6144
  ds_read_b64_tr_b16 v[28:29], v14 offset:128
  ds_read_b64_tr_b16 v[30:31], v14 offset:4224
  ds_read_b64_tr_b16 v[32:33], v14 offset:2176
  ds_read_b64_tr_b16 v[34:35], v14 offset:6272
  s_waitcnt lgkmcnt(0)
  s_waitcnt vmcnt(12)
  s_barrier
  v_add_u32 v14, 98304, v13
  ds_read_b64_tr_b16 v[36:37], v14 offset:0
  ds_read_b64_tr_b16 v[38:39], v14 offset:4096
  ds_read_b64_tr_b16 v[40:41], v14 offset:2048
  ds_read_b64_tr_b16 v[42:43], v14 offset:6144
  ds_read_b64_tr_b16 v[44:45], v14 offset:128
  ds_read_b64_tr_b16 v[46:47], v14 offset:4224
  ds_read_b64_tr_b16 v[48:49], v14 offset:2176
  ds_read_b64_tr_b16 v[50:51], v14 offset:6272
  s_waitcnt lgkmcnt(0)
  s_waitcnt vmcnt(8)
  s_barrier
  v_add_u32 v14, 114688, v13
  ds_read_b64_tr_b16 v[52:53], v14 offset:0
  ds_read_b64_tr_b16 v[54:55], v14 offset:4096
  ds_read_b64_tr_b16 v[56:57], v14 offset:2048
  ds_read_b64_tr_b16 v[58:59], v14 offset:6144
  ds_read_b64_tr_b16 v[60:61], v14 offset:128
  ds_read_b64_tr_b16 v[62:63], v14 offset:4224
  ds_read_b64_tr_b16 v[64:65], v14 offset:2176
  ds_read_b64_tr_b16 v[66:67], v14 offset:6272
  s_waitcnt lgkmcnt(0)
  s_waitcnt vmcnt(4)
  s_barrier
  v_add_u32 v14, 131072, v13
  ds_read_b64_tr_b16 v[68:69], v14 offset:0
  ds_read_b64_tr_b16 v[70:71], v14 offset:4096
  ds_read_b64_tr_b16 v[72:73], v14 offset:2048
  ds_read_b64_tr_b16 v[74:75], v14 offset:6144
  ds_read_b64_tr_b16 v[76:77], v14 offset:128
  ds_read_b64_tr_b16 v[78:79], v14 offset:4224
  ds_read_b64_tr_b16 v[80:81], v14 offset:2176
  ds_read_b64_tr_b16 v[82:83], v14 offset:6272
  s_waitcnt lgkmcnt(0)
  s_waitcnt vmcnt(0)
  s_barrier
  v_add_u32 v14, 147456, v13
  ds_read_b64_tr_b16 v[100:101], v14 offset:0
  ds_read_b64_tr_b16 v[102:103], v14 offset:4096
  ds_read_b64_tr_b16 v[104:105], v14 offset:2048
  ds_read_b64_tr_b16 v[106:107], v14 offset:6144
  ds_read_b64_tr_b16 v[108:109], v14 offset:128
  ds_read_b64_tr_b16 v[110:111], v14 offset:4224
  ds_read_b64_tr_b16 v[112:113], v14 offset:2176
  ds_read_b64_tr_b16 v[114:115], v14 offset:6272
  s_waitcnt lgkmcnt(0)
  s_barrier
  s_mul_i32 s50, s17, 24576
  s_add_u32 s50, s50, 65536
  v_add_u32 v15, s50, v2
  ds_write_b128 v15, v[20:23] offset:0
  ds_write_b128 v15, v[24:27] offset:1024
  ds_write_b128 v15, v[28:31] offset:2048
  ds_write_b128 v15, v[32:35] offset:3072
  ds_write_b128 v15, v[36:39] offset:4096
  ds_write_b128 v15, v[40:43] offset:5120
  ds_write_b128 v15, v[44:47] offset:6144
  ds_write_b128 v15, v[48:51] offset:7168
  ds_write_b128 v15, v[52:55] offset:8192
  ds_write_b128 v15, v[56:59] offset:9216
  ds_write_b128 v15, v[60:63] offset:10240
  ds_write_b128 v15, v[64:67] offset:11264
  ds_write_b128 v15, v[68:71] offset:12288
  ds_write_b128 v15, v[72:75] offset:13312
  ds_write_b128 v15, v[76:79] offset:14336
  ds_write_b128 v15, v[80:83] offset:15360
  ds_write_b128 v15, v[84:87] offset:16384
  ds_write_b128 v15, v[88:91] offset:17408
  ds_write_b128 v15, v[92:95] offset:18432
  ds_write_b128 v15, v[96:99] offset:19456
  ds_write_b128 v15, v[100:103] offset:20480
  ds_write_b128 v15, v[104:107] offset:21504
  ds_write_b128 v15, v[108:111] offset:22528
  ds_write_b128 v15, v[112:115] offset:23552
  s_waitcnt lgkmcnt(0)
  s_lshl_b32 s52, s17, 10
  v_add_u32 v38, s52, v4
  ds_write_b128 v38, v[116:119] offset:0
  ds_write_b128 v38, v[120:123] offset:4096
  ds_write_b128 v38, v[124:127] offset:8192
  s_waitcnt lgkmcnt(0)
  s_sub_u32 s50, s17, 2
  s_mul_i32 s50, s50, 5120
  v_add_u32 v3, s50, v4
  v_and_b32 v36, 15, v0
  v_lshlrev_b32 v36, 5, v36
  v_lshrrev_b32 v37, 4, v0
  v_lshlrev_b32 v37, 3, v37
  v_add_u32 v36, v36, v37
  s_lshl_b32 s50, s17, 10
  s_add_u32 s50, s50, 45056
  v_add_u32 v5, s50, v36
  v_lshrrev_b32 v36, 4, v0
  v_lshlrev_b32 v36, 3, v36
  v_bfe_u32 v37, v0, 2, 2
  v_add_u32 v36, v36, v37
  v_lshlrev_b32 v36, 5, v36
  v_and_b32 v37, 3, v0
  v_lshlrev_b32 v37, 3, v37
  v_add_u32 v36, v36, v37
  v_add_u32 v6, 45056, v36
  v_lshrrev_b32 v36, 4, v0
  v_lshlrev_b32 v36, 13, v36
  v_and_b32 v37, 15, v0
  v_lshlrev_b32 v37, 4, v37
  v_add_u32 v7, v36, v37
  v_bfe_u32 v36, v0, 2, 2
  v_lshlrev_b32 v36, 10, v36
  v_and_b32 v37, 3, v0
  v_lshlrev_b32 v37, 4, v37
  v_add_u32 v36, v36, v37
  v_lshrrev_b32 v37, 4, v0
  v_lshlrev_b32 v37, 2, v37
  v_add_u32 v8, v36, v37
  v_lshlrev_b32 v9, 3, v0
  s_lshr_b32 s50, s17, 1
  s_lshl_b32 s50, s50, 10
  s_and_b32 s51, s17, 1
  s_lshl_b32 s51, s51, 3
  s_add_u32 s50, s50, s51
  s_add_u32 s50, s50, 53248
  v_add_u32 v11, s50, v2
  v_bfe_u32 v36, v0, 2, 1
  v_lshlrev_b32 v36, 4, v36
  v_bfe_u32 v37, v0, 3, 1
  v_lshlrev_b32 v37, 2, v37
  v_add_u32 v36, v36, v37
  v_and_b32 v37, 3, v0
  v_add_u32 v36, v36, v37
  v_lshlrev_b32 v36, 13, v36
  v_lshrrev_b32 v37, 4, v0
  v_lshlrev_b32 v37, 4, v37
  v_add_u32 v10, v36, v37
  v_mov_b32 v12, -1
  v_bfe_u32 v36, v0, 2, 2
  v_lshlrev_b32 v36, 1, v36
  v_and_b32 v37, 1, v0
  v_add_u32 v36, v36, v37
  v_mov_b32 v16, 0
  v_mov_b32 v37, 0x3F80
  v_cmp_eq_u32 vcc, 0, v36
  s_nop 1
  v_cndmask_b32 v16, v16, v37, vcc
  v_mov_b32 v37, 0x3F800000
  v_cmp_eq_u32 vcc, 1, v36
  s_nop 1
  v_cndmask_b32 v16, v16, v37, vcc
  v_mov_b32 v17, 0
  v_mov_b32 v37, 0x3F80
  v_cmp_eq_u32 vcc, 2, v36
  s_nop 1
  v_cndmask_b32 v17, v17, v37, vcc
  v_mov_b32 v37, 0x3F800000
  v_cmp_eq_u32 vcc, 3, v36
  s_nop 1
  v_cndmask_b32 v17, v17, v37, vcc
  v_mov_b32 v18, 0
  v_mov_b32 v37, 0x3F80
  v_cmp_eq_u32 vcc, 4, v36
  s_nop 1
  v_cndmask_b32 v18, v18, v37, vcc
  v_mov_b32 v37, 0x3F800000
  v_cmp_eq_u32 vcc, 5, v36
  s_nop 1
  v_cndmask_b32 v18, v18, v37, vcc
  v_mov_b32 v19, 0
  v_mov_b32 v37, 0x3F80
  v_cmp_eq_u32 vcc, 6, v36
  s_nop 1
  v_cndmask_b32 v19, v19, v37, vcc
  v_mov_b32 v37, 0x3F800000
  v_cmp_eq_u32 vcc, 7, v36
  s_nop 1
  v_cndmask_b32 v19, v19, v37, vcc
  v_add_u32 v13, 55296, v2
  ds_write_b128 v13, v[16:19]
  s_waitcnt lgkmcnt(0)
  v_mov_b32 v16, 0x3F803F80
  v_mov_b32 v17, 0x3F803F80
  v_mov_b32 v18, 0x3F803F80
  v_mov_b32 v19, 0x3F803F80
  v_add_u32 v14, 0, v2
  v_mov_b32 v121, 0
  v_mov_b32 v122, 0
  v_mov_b32 v124, s44
  s_mov_b32 s53, -1
  s_cmp_eq_u32 s17, 0
  s_cselect_b32 s53, s16, s53
  s_add_u32 s50, s16, 32
  s_cmp_lt_u32 s50, 48
  s_cselect_b32 s50, s50, -1
  s_cmp_eq_u32 s17, 1
  s_cselect_b32 s53, s50, s53
  s_lshr_b32 s50, s53, 2
  s_and_b32 s50, s50, 15
  s_mul_i32 s51, s50, 11
  s_lshr_b32 s51, s51, 5
  s_mul_i32 s52, s51, 3
  s_sub_u32 s52, s50, s52
  s_lshl_b32 s31, s52, 12
  s_lshl_b32 s51, s51, 8
  s_add_u32 s31, s31, s51
  s_and_b32 s50, s53, 3
  s_lshl_b32 s50, s50, 6
  s_add_u32 s31, s31, s50
  s_cmp_eq_u32 s53, -1
  s_cselect_b32 s31, 24576, s31
  s_mul_i32 s45, s17, 98304
  s_lshl_b32 s50, s16, 8
  s_add_u32 s45, s45, s50
  s_add_u32 s45, s45, 83886080
  s_add_u32 s46, s45, 393216
  s_barrier
  s_lshl_b32 s58, s16, 8
  s_add_u32 s58, s58, 20971520
  s_lshl_b32 s59, s16, 13
  s_add_u32 s59, s59, 37748736
  s_lshl_b32 s55, s16, 11
  s_add_u32 s55, s55, 79691776
  s_lshl_b32 s50, s17, 9
  s_add_u32 s55, s55, s50
  s_lshl_b32 s56, s16, 12
  s_add_u32 s56, s56, 71303168
  s_lshl_b32 s50, s17, 10
  s_add_u32 s56, s56, s50
  v_mov_b32 v36, 0
kvw_4400002:
  buffer_load_dwordx4 v[40:43], v36, s[12:15], 0 offen sc1
  buffer_load_dword v44, v36, s[12:15], 0 offen offset:16 sc1
  s_add_u32 s19, s19, 1
  s_cmp_gt_u32 s19, 4194304
  s_cbranch_scc1 fz_fail
  s_waitcnt vmcnt(0)
  v_readfirstlane_b32 s50, v40
  s_nop 0
  s_cmp_lt_u32 s50, 64
  s_nop 0
  s_cbranch_scc1 kvw_4400002
  v_readfirstlane_b32 s50, v44
  s_nop 0
  s_cmp_lt_u32 s50, 64
  s_nop 0
  s_cbranch_scc1 kvw_4400002
  v_readfirstlane_b32 s50, v43
  s_nop 0
  s_cmp_lt_u32 s50, 1
  s_cbranch_scc1 kvw_4400002
  v_readfirstlane_b32 s50, v41
  s_nop 0
  s_bcnt1_i32_b32 s50, s50
  s_cmp_eq_u32 s50, 1
  s_cselect_b32 s60, 1, 0
  s_mov_b32 s51, 85065728
kvw2_4400003:
  buffer_load_dword v41, v36, s[4:7], s51 offen sc1
  s_add_u32 s19, s19, 1
  s_cmp_gt_u32 s19, 4194304
  s_cbranch_scc1 fz_fail
  s_waitcnt vmcnt(0)
  v_readfirstlane_b32 s50, v41
  s_nop 0
  s_cmp_ge_u32 s50, 64
  s_nop 0
  s_cbranch_scc1 kvw2_4400003_ok
  s_sleep 3
  s_branch kvw2_4400003
kvw2_4400003_ok:
  s_mov_b32 s39, 64
  v_subrev_u32 v13, 960, v10
  s_lshr_b32 s50, s17, 1
  s_lshl_b32 s50, s50, 16
  s_and_b32 s51, s17, 1
  s_lshl_b32 s51, s51, 7
  s_add_u32 s50, s50, s51
  s_add_u32 s58, s58, s50
  s_lshl_b32 s50, s17, 11
  s_add_u32 s59, s59, s50
  s_add_u32 s35, s50, 0
  s_mov_b32 m0, s35
  s_nop 0
  buffer_load_dwordx4 v10, s[4:7], s58 offen lds
  buffer_load_dwordx4 v13, s[4:7], s58 offen offset:1024 lds
  s_add_u32 m0, s35, 8192
  s_nop 0
  buffer_load_dwordx4 v2, s[4:7], s59 offen lds
  buffer_load_dwordx4 v2, s[4:7], s59 offen offset:1024 lds
  s_add_u32 s58, s58, 262144
  s_add_u32 s59, s59, 262144
  s_xor_b32 s35, s35, 16384
  s_waitcnt vmcnt(0)
  s_mov_b32 s18, 0
  s_mov_b32 s48, 12288
  s_mov_b32 s33, 12288
  s_mov_b32 s49, 0
  s_mov_b32 s34, 1
  v_mov_b64 v[20:21], 0
  v_mov_b64 v[22:23], 0
  v_mov_b64 v[24:25], 0
  v_mov_b64 v[26:27], 0
  v_mov_b64 v[28:29], 0
  v_mov_b64 v[30:31], 0
  v_mov_b64 v[32:33], 0
  v_mov_b64 v[34:35], 0
  s_barrier
  s_cmp_eq_u32 s60, 0
  s_nop 0
  s_cbranch_scc1 main_loop_safe
main_loop_fast:
  ds_read_b128 v[72:75], v4 offset:0
  ds_read_b128 v[76:79], v4 offset:1024
  ds_read_b128 v[80:83], v4 offset:2048
  ds_read_b128 v[84:87], v4 offset:3072
  ds_read_b128 v[88:91], v4 offset:4096
  ds_read_b128 v[92:95], v4 offset:5120
  ds_read_b128 v[96:99], v4 offset:6144
  ds_read_b128 v[100:103], v4 offset:7168
  ds_read_b128 v[104:107], v4 offset:8192
  ds_read_b128 v[108:111], v4 offset:9216
  s_cmp_lt_u32 s39, 64
  s_nop 0
  s_cbranch_scc1 rs_4400006
rok_4400004:
  s_mov_b32 m0, s35
  s_nop 0
  buffer_load_dwordx4 v10, s[4:7], s58 offen lds
  buffer_load_dwordx4 v13, s[4:7], s58 offen offset:1024 lds
  s_add_u32 m0, s35, 8192
  s_nop 0
  buffer_load_dwordx4 v2, s[4:7], s59 offen lds
  buffer_load_dwordx4 v2, s[4:7], s59 offen offset:1024 lds
  s_waitcnt lgkmcnt(9)
  v_smfmac_f32_16x16x64_bf16 v[20:23], v[72:75], a[0:7], v1
  v_smfmac_f32_16x16x64_bf16 v[24:27], v[72:75], a[8:15], v1
  s_waitcnt lgkmcnt(8)
  v_smfmac_f32_16x16x64_bf16 v[20:23], v[76:79], a[16:23], v1
  v_smfmac_f32_16x16x64_bf16 v[24:27], v[76:79], a[24:31], v1
  s_waitcnt lgkmcnt(7)
  v_smfmac_f32_16x16x64_bf16 v[20:23], v[80:83], a[32:39], v1
  v_smfmac_f32_16x16x64_bf16 v[24:27], v[80:83], a[40:47], v1
  s_waitcnt lgkmcnt(6)
  v_smfmac_f32_16x16x64_bf16 v[20:23], v[84:87], a[48:55], v1
  v_smfmac_f32_16x16x64_bf16 v[24:27], v[84:87], a[56:63], v1
  s_waitcnt lgkmcnt(5)
  v_smfmac_f32_16x16x64_bf16 v[20:23], v[88:91], a[64:71], v1
  v_smfmac_f32_16x16x64_bf16 v[24:27], v[88:91], a[72:79], v1
  s_waitcnt lgkmcnt(4)
  v_smfmac_f32_16x16x64_bf16 v[20:23], v[92:95], a[80:87], v1
  v_smfmac_f32_16x16x64_bf16 v[24:27], v[92:95], a[88:95], v1
  s_waitcnt lgkmcnt(3)
  v_smfmac_f32_16x16x64_bf16 v[20:23], v[96:99], a[96:103], v1
  ds_read_b128 v[40:43], v14 offset:0
  v_smfmac_f32_16x16x64_bf16 v[24:27], v[96:99], a[104:111], v1
  ds_read_b128 v[44:47], v14 offset:1024
  s_waitcnt lgkmcnt(4)
  v_smfmac_f32_16x16x64_bf16 v[20:23], v[100:103], a[112:119], v1
  ds_read_b128 v[48:51], v14 offset:2048
  v_smfmac_f32_16x16x64_bf16 v[24:27], v[100:103], a[120:127], v1
  ds_read_b128 v[52:55], v14 offset:3072
  s_waitcnt lgkmcnt(5)
  v_smfmac_f32_16x16x64_bf16 v[20:23], v[104:107], a[128:135], v1
  ds_read_b128 v[56:59], v14 offset:4096
  v_smfmac_f32_16x16x64_bf16 v[24:27], v[104:107], a[136:143], v1
  ds_read_b128 v[60:63], v14 offset:5120
  s_waitcnt lgkmcnt(6)
  v_smfmac_f32_16x16x64_bf16 v[20:23], v[108:111], a[144:151], v1
  ds_read_b128 v[64:67], v14 offset:6144
  v_smfmac_f32_16x16x64_bf16 v[24:27], v[108:111], a[152:159], v1
  ds_read_b128 v[68:71], v14 offset:7168
  v_smfmac_f32_16x16x64_bf16 v[28:31], v[72:75], a[160:167], v1
  v_smfmac_f32_16x16x64_bf16 v[32:35], v[72:75], a[168:175], v1
  v_smfmac_f32_16x16x64_bf16 v[28:31], v[76:79], a[176:183], v1
  s_nop 1
  v_add_f32 v20, v20, v22
  v_smfmac_f32_16x16x64_bf16 v[32:35], v[76:79], a[184:191], v1
  v_add_f32 v21, v21, v23
  v_smfmac_f32_16x16x64_bf16 v[28:31], v[80:83], a[192:199], v1
  v_add_f32 v24, v24, v26
  v_smfmac_f32_16x16x64_bf16 v[32:35], v[80:83], a[200:207], v1
  v_add_f32 v25, v25, v27
  v_smfmac_f32_16x16x64_bf16 v[28:31], v[84:87], a[208:215], v1
  v_cvt_pk_bf16_f32 v36, v20, v21
  v_smfmac_f32_16x16x64_bf16 v[32:35], v[84:87], a[216:223], v1
  v_cvt_pk_bf16_f32 v37, v24, v25
  v_smfmac_f32_16x16x64_bf16 v[28:31], v[88:91], a[224:231], v1
  ds_write2_b32 v5, v36, v36 offset0:0 offset1:1
  v_smfmac_f32_16x16x64_bf16 v[32:35], v[88:91], a[232:239], v1
  ds_write2_b32 v5, v37, v37 offset0:128 offset1:129
  v_smfmac_f32_16x16x64_bf16 v[28:31], v[92:95], a[240:247], v1
  v_add_u32 v39, 4096, v5
  v_smfmac_f32_16x16x64_bf16 v[32:35], v[92:95], a[248:255], v1
  v_smfmac_f32_16x16x64_bf16 v[28:31], v[96:99], v[128:135], v1
  s_waitcnt lgkmcnt(0)
  s_barrier
  v_smfmac_f32_16x16x64_bf16 v[32:35], v[96:99], v[136:143], v1
  ds_read_b64_tr_b16 v[72:73], v6 offset:0
  ds_read_b64_tr_b16 v[74:75], v6 offset:128
  v_smfmac_f32_16x16x64_bf16 v[28:31], v[100:103], v[144:151], v1
  ds_read_b64_tr_b16 v[76:77], v6 offset:1024
  ds_read_b64_tr_b16 v[78:79], v6 offset:1152
  v_smfmac_f32_16x16x64_bf16 v[32:35], v[100:103], v[152:159], v1
  ds_read_b64_tr_b16 v[80:81], v6 offset:2048
  ds_read_b64_tr_b16 v[82:83], v6 offset:2176
  v_smfmac_f32_16x16x64_bf16 v[28:31], v[104:107], v[160:167], v1
  ds_read_b64_tr_b16 v[84:85], v6 offset:3072
  ds_read_b64_tr_b16 v[86:87], v6 offset:3200
  v_smfmac_f32_16x16x64_bf16 v[32:35], v[104:107], v[168:175], v1
  v_smfmac_f32_16x16x64_bf16 v[28:31], v[108:111], v[176:183], v1
  v_smfmac_f32_16x16x64_bf16 v[32:35], v[108:111], v[184:191], v1
  s_waitcnt lgkmcnt(0)
  v_mfma_f32_16x16x32_bf16 v[20:23], v[40:43], v[72:75], 0
  s_lshl_b32 s50, s17, 11
  v_mfma_f32_16x16x32_bf16 v[24:27], v[56:59], v[72:75], 0
  s_nop 2
  v_add_f32 v28, v28, v30
  v_add_f32 v29, v29, v31
  v_mfma_f32_16x16x32_bf16 v[20:23], v[44:47], v[76:79], v[20:23]
  v_add_f32 v32, v32, v34
  v_add_f32 v33, v33, v35
  v_mfma_f32_16x16x32_bf16 v[24:27], v[60:63], v[76:79], v[24:27]
  v_cvt_pk_bf16_f32 v36, v28, v29
  v_cvt_pk_bf16_f32 v37, v32, v33
  v_mfma_f32_16x16x32_bf16 v[20:23], v[48:51], v[80:83], v[20:23]
  ds_write2_b32 v39, v36, v36 offset0:0 offset1:1
  ds_write2_b32 v39, v37, v37 offset0:128 offset1:129
  v_mfma_f32_16x16x32_bf16 v[24:27], v[64:67], v[80:83], v[24:27]
  v_add_u32 v127, s50, v14
  v_mfma_f32_16x16x32_bf16 v[20:23], v[52:55], v[84:87], v[20:23]
  v_mfma_f32_16x16x32_bf16 v[24:27], v[68:71], v[84:87], v[24:27]
  s_waitcnt lgkmcnt(0)
  s_barrier
  s_cmp_ge_u32 s18, 63
  s_cbranch_scc1 main_last
  ds_read_b64_tr_b16 v[88:89], v6 offset:4096
  ds_read_b64_tr_b16 v[90:91], v6 offset:4224
  ds_read_b64_tr_b16 v[92:93], v6 offset:5120
  ds_read_b64_tr_b16 v[94:95], v6 offset:5248
  ds_read_b64_tr_b16 v[96:97], v6 offset:6144
  ds_read_b64_tr_b16 v[98:99], v6 offset:6272
  ds_read_b64_tr_b16 v[100:101], v6 offset:7168
  ds_read_b64_tr_b16 v[102:103], v6 offset:7296
  v_max3_f32 v126, v20, v21, v22
  v_max3_f32 v125, v23, v24, v25
  ds_read_b128 v[104:107], v127 offset:8192
  ds_read_b128 v[108:111], v127 offset:9216
  buffer_load_dwordx2 v[112:113], v9, s[4:7], s55 offen sc1
  v_max3_f32 v126, v126, v26, v27
  v_max_f32 v126, v126, v125
  v_mov_b32 v125, v126
  s_add_u32 s50, s18, 2
  s_lshr_b32 s50, s50, 2
  s_min_u32 s50, s50, 15
  s_lshl_b32 s50, s50, 7
  s_add_u32 s50, s50, 85065728
  v_permlane32_swap_b32 v126, v125
  v_max_f32 v126, v126, v125
  v_mov_b32 v125, v126
  buffer_load_dword v12, v121, s[4:7], s50 offen sc1
  s_nop 0
  v_permlane16_swap_b32 v126, v125
  v_max_f32 v126, v126, v125
  v_mul_f32 v127, v124, v126
  v_sub_f32 v127, 0, v127
  v_fma_f32 v20, v20, v124, v127
  v_fma_f32 v21, v21, v124, v127
  v_fma_f32 v22, v22, v124, v127
  v_fma_f32 v23, v23, v124, v127
  v_fma_f32 v24, v24, v124, v127
  v_fma_f32 v25, v25, v124, v127
  v_fma_f32 v26, v26, v124, v127
  v_fma_f32 v27, v27, v124, v127
  s_waitcnt lgkmcnt(8)
  v_mfma_f32_16x16x32_bf16 v[28:31], v[88:91], v[72:75], 0
  v_exp_f32 v20, v20
  v_exp_f32 v21, v21
  s_waitcnt lgkmcnt(6)
  v_mfma_f32_16x16x32_bf16 v[28:31], v[92:95], v[76:79], v[28:31]
  v_exp_f32 v22, v22
  v_exp_f32 v23, v23
  s_waitcnt lgkmcnt(4)
  v_mfma_f32_16x16x32_bf16 v[28:31], v[96:99], v[80:83], v[28:31]
  v_exp_f32 v24, v24
  v_exp_f32 v25, v25
  s_waitcnt lgkmcnt(2)
  v_mfma_f32_16x16x32_bf16 v[28:31], v[100:103], v[84:87], v[28:31]
  v_exp_f32 v26, v26
  v_exp_f32 v27, v27
  buffer_load_dwordx2 v[114:115], v9, s[4:7], s55 offen sc1
  v_cvt_pk_bf16_f32 v116, v20, v21
  v_cvt_pk_bf16_f32 v117, v22, v23
  v_cvt_pk_bf16_f32 v118, v24, v25
  v_cvt_pk_bf16_f32 v119, v26, v27
  s_nop 0
  v_fma_f32 v28, v28, v124, v127
  v_fma_f32 v29, v29, v124, v127
  s_waitcnt lgkmcnt(0)
  v_mfma_f32_16x16x32_bf16 v[32:35], v[104:107], v[116:119], 0
  v_max_f32 v126, v28, v29
  v_mfma_f32_16x16x32_bf16 v[36:39], v[108:111], v[116:119], 0
  v_cmp_lt_f32 vcc, s61, v126
  v_mfma_f32_16x16x32_bf16 v[20:23], v[16:19], v[116:119], 0
  ds_read_b128 v[40:43], v15 offset:0
  ds_read_b128 v[44:47], v15 offset:1024
  ds_read_b128 v[48:51], v15 offset:2048
  ds_read_b128 v[52:55], v15 offset:3072
  s_nop 1
  s_cbranch_vccnz thc_4400008
thr_4400007:
  v_exp_f32 v28, v28
  v_exp_f32 v29, v29
  ds_read_b128 v[56:59], v15 offset:4096
  ds_read_b128 v[60:63], v15 offset:5120
  ds_read_b128 v[64:67], v15 offset:6144
  ds_read_b128 v[68:71], v15 offset:7168
  v_cvt_pk_bf16_f32 v120, v28, v29
  v_cvt_pk_bf16_f32 v123, v28, v29
  s_nop 0
  v_mfma_f32_16x16x16_bf16 v[20:23], v[16:17], v[120:121], v[20:23]
  s_lshl_b32 s52, s17, 10
  v_add_u32 v125, s52, v6
  ds_read_b64_tr_b16 v[116:117], v125 offset:4096
  ds_read_b64_tr_b16 v[118:119], v125 offset:4224
  v_mov_b64 v[72:73], 0
  v_mov_b64 v[74:75], 0
  v_mov_b64 v[76:77], 0
  v_mov_b64 v[78:79], 0
  v_mov_b64 v[80:81], 0
  v_mov_b64 v[82:83], 0
  v_mov_b64 v[84:85], 0
  v_mov_b64 v[86:87], 0
  s_waitcnt vmcnt(1)
  v_max_u32 v126, v112, v113
  v_cmp_eq_u32 vcc, -1, v126
  s_nop 1
  s_cbranch_vccnz vmc_4400011
vmok_4400010:
  v_mfma_f32_16x16x16_bf16 v[32:35], v[112:113], v[120:121], v[32:35]
  v_mfma_f32_16x16x16_bf16 v[36:39], v[112:113], v[122:123], v[36:39]
  v_rcp_f32 v126, v20
  s_nop 0
  v_mov_b32 v127, v126
  s_nop 3
  v_cndmask_b32 v24, v32, v34, s[40:41]
  v_cndmask_b32 v25, v33, v35, s[40:41]
  v_pk_mul_f32 v[24:25], v[24:25], v[126:127]
  v_cvt_pk_bf16_f32 v28, v24, v25
  v_cndmask_b32 v26, v36, v38, s[40:41]
  v_cndmask_b32 v27, v37, v39, s[40:41]
  v_pk_mul_f32 v[26:27], v[26:27], v[126:127]
  v_cvt_pk_bf16_f32 v29, v26, v27
  ds_write_b64 v11, v[28:29]
  s_waitcnt lgkmcnt(1)
  buffer_store_dwordx4 v[116:119], v2, s[4:7], s56 offen sc1
  v_mov_b64 v[88:89], 0
  v_mov_b64 v[90:91], 0
  v_mov_b64 v[92:93], 0
  v_mov_b64 v[94:95], 0
  v_mov_b64 v[96:97], 0
  s_waitcnt lgkmcnt(0)
  s_barrier
  v_add_u32 v127, 53248, v2
  ds_read_b128 v[20:23], v127
  ds_read_b128 v[24:27], v127 offset:1024
  v_mov_b64 v[98:99], 0
  v_mov_b64 v[100:101], 0
  v_mov_b64 v[102:103], 0
  v_mov_b64 v[104:105], 0
  v_mov_b64 v[106:107], 0
  v_mov_b64 v[108:109], 0
  v_mov_b64 v[110:111], 0
  v_mov_b64 v[38:39], 0
  s_waitcnt lgkmcnt(0)
  v_smfmac_f32_16x16x64_bf16 v[72:75], v[20:23], v[192:199], v1
  v_smfmac_f32_16x16x64_bf16 v[76:79], v[20:23], v[200:207], v1
  v_smfmac_f32_16x16x64_bf16 v[72:75], v[24:27], v[40:47], v1
  v_smfmac_f32_16x16x64_bf16 v[76:79], v[24:27], v[48:55], v1
  ds_read_b128 v[40:43], v15 offset:8192
  ds_read_b128 v[44:47], v15 offset:9216
  ds_read_b128 v[48:51], v15 offset:10240
  ds_read_b128 v[52:55], v15 offset:11264
  v_smfmac_f32_16x16x64_bf16 v[80:83], v[20:23], v[208:215], v1
  v_smfmac_f32_16x16x64_bf16 v[84:87], v[20:23], v[216:223], v1
  v_smfmac_f32_16x16x64_bf16 v[80:83], v[24:27], v[56:63], v1
  v_add_f32 v72, v72, v74
  v_add_f32 v73, v73, v75
  v_smfmac_f32_16x16x64_bf16 v[84:87], v[24:27], v[64:71], v1
  ds_read_b128 v[56:59], v15 offset:12288
  ds_read_b128 v[60:63], v15 offset:13312
  ds_read_b128 v[64:67], v15 offset:14336
  ds_read_b128 v[68:71], v15 offset:15360
  v_cvt_pk_bf16_f32 v28, v72, v73
  v_smfmac_f32_16x16x64_bf16 v[88:91], v[20:23], v[224:231], v1
  v_add_f32 v76, v76, v78
  v_add_f32 v77, v77, v79
  v_smfmac_f32_16x16x64_bf16 v[92:95], v[20:23], v[232:239], v1
  v_cvt_pk_bf16_f32 v29, v76, v77
  s_waitcnt lgkmcnt(4)
  v_smfmac_f32_16x16x64_bf16 v[88:91], v[24:27], v[40:47], v1
  v_add_f32 v80, v80, v82
  v_add_f32 v81, v81, v83
  v_smfmac_f32_16x16x64_bf16 v[92:95], v[24:27], v[48:55], v1
  ds_read_b128 v[40:43], v15 offset:16384
  ds_read_b128 v[44:47], v15 offset:17408
  ds_read_b128 v[48:51], v15 offset:18432
  ds_read_b128 v[52:55], v15 offset:19456
  v_cvt_pk_bf16_f32 v30, v80, v81
  v_smfmac_f32_16x16x64_bf16 v[96:99], v[20:23], v[240:247], v1
  v_add_f32 v84, v84, v86
  v_add_f32 v85, v85, v87
  v_smfmac_f32_16x16x64_bf16 v[100:103], v[20:23], v[248:255], v1
  v_cvt_pk_bf16_f32 v31, v84, v85
  v_and_or_b32 v28, v28, -2, s49
  s_waitcnt lgkmcnt(4)
  v_smfmac_f32_16x16x64_bf16 v[96:99], v[24:27], v[56:63], v1
  s_add_u32 s50, s45, 0
  buffer_store_dwordx4 v[28:31], v7, s[4:7], s50 offen
  v_add_f32 v88, v88, v90
  v_smfmac_f32_16x16x64_bf16 v[100:103], v[24:27], v[64:71], v1
  ds_read_b128 v[56:59], v15 offset:20480
  ds_read_b128 v[60:63], v15 offset:21504
  ds_read_b128 v[64:67], v15 offset:22528
  ds_read_b128 v[68:71], v15 offset:23552
  v_add_f32 v89, v89, v91
  s_waitcnt lgkmcnt(4)
  v_smfmac_f32_16x16x64_bf16 v[104:107], v[20:23], v[40:47], v1
  v_cvt_pk_bf16_f32 v32, v88, v89
  v_add_f32 v92, v92, v94
  v_smfmac_f32_16x16x64_bf16 v[108:111], v[20:23], v[48:55], v1
  v_add_f32 v93, v93, v95
  v_cvt_pk_bf16_f32 v33, v92, v93
  s_waitcnt lgkmcnt(0)
  v_smfmac_f32_16x16x64_bf16 v[104:107], v[24:27], v[56:63], v1
  v_add_f32 v96, v96, v98
  v_add_f32 v97, v97, v99
  v_smfmac_f32_16x16x64_bf16 v[108:111], v[24:27], v[64:71], v1
  v_cvt_pk_bf16_f32 v34, v96, v97
  v_add_f32 v100, v100, v102
  v_add_f32 v101, v101, v103
  v_cvt_pk_bf16_f32 v35, v100, v101
  v_and_or_b32 v32, v32, -2, s49
  s_add_u32 s50, s45, 32768
  buffer_store_dwordx4 v[32:35], v7, s[4:7], s50 offen
  v_add_f32 v104, v104, v106
  v_add_f32 v105, v105, v107
  v_cvt_pk_bf16_f32 v36, v104, v105
  v_add_f32 v108, v108, v110
  v_add_f32 v109, v109, v111
  v_cvt_pk_bf16_f32 v37, v108, v109
  v_and_or_b32 v36, v36, -2, s49
  s_add_u32 s50, s45, 65536
  buffer_store_dwordx4 v[36:39], v7, s[4:7], s50 offen
  s_cmp_ge_u32 s17, 2
  s_cbranch_scc1 gat_4400012
  s_cmp_eq_u32 s53, -1
  s_cbranch_scc1 nown_4400015
  v_add_u32 v127, 55296, v2
  ds_read_b128 v[36:39], v127
  s_and_b32 s50, s18, 1
  s_mul_i32 s50, s50, 393216
  s_lshl_b32 s51, s53, 13
  s_add_u32 s50, s50, s51
  s_add_u32 s50, s50, 83886080
  s_add_u32 s51, s50, 4096
  s_add_u32 s37, s31, s48
  s_add_u32 s37, s37, 168820736
  s_add_u32 s36, s31, s33
  s_add_u32 s36, s36, 167772160
  s_sleep 4
  s_waitcnt lgkmcnt(0)
ownp_4400014:
  buffer_load_dwordx4 v[40:43], v2, s[4:7], s50 offen offset:0 sc1
  buffer_load_dwordx4 v[44:47], v2, s[4:7], s50 offen offset:1024 sc1
  buffer_load_dwordx4 v[48:51], v2, s[4:7], s50 offen offset:2048 sc1
  buffer_load_dwordx4 v[52:55], v2, s[4:7], s50 offen offset:3072 sc1
  buffer_load_dwordx4 v[56:59], v2, s[4:7], s51 offen offset:0 sc1
  buffer_load_dwordx4 v[60:63], v2, s[4:7], s51 offen offset:1024 sc1
  buffer_load_dwordx4 v[64:67], v2, s[4:7], s51 offen offset:2048 sc1
  buffer_load_dwordx4 v[68:71], v2, s[4:7], s51 offen offset:3072 sc1
  s_waitcnt vmcnt(7)
  v_mfma_f32_16x16x32_bf16 v[20:23], v[40:43], v[36:39], 0
  v_xor_b32 v28, s34, v40
  s_waitcnt vmcnt(6)
  v_mfma_f32_16x16x32_bf16 v[20:23], v[44:47], v[36:39], v[20:23]
  v_bitop3_b32 v28, v28, v44, s34 bitop3:0x60
  s_waitcnt vmcnt(5)
  v_mfma_f32_16x16x32_bf16 v[20:23], v[48:51], v[36:39], v[20:23]
  v_bitop3_b32 v28, v28, v48, s34 bitop3:0x60
  s_waitcnt vmcnt(4)
  v_mfma_f32_16x16x32_bf16 v[20:23], v[52:55], v[36:39], v[20:23]
  v_bitop3_b32 v28, v28, v52, s34 bitop3:0x60
  s_waitcnt vmcnt(3)
  v_mfma_f32_16x16x32_bf16 v[20:23], v[56:59], v[36:39], v[20:23]
  v_bitop3_b32 v28, v28, v56, s34 bitop3:0x60
  s_waitcnt vmcnt(2)
  v_mfma_f32_16x16x32_bf16 v[20:23], v[60:63], v[36:39], v[20:23]
  v_bitop3_b32 v28, v28, v60, s34 bitop3:0x60
  s_waitcnt vmcnt(1)
  v_mfma_f32_16x16x32_bf16 v[20:23], v[64:67], v[36:39], v[20:23]
  v_bitop3_b32 v28, v28, v64, s34 bitop3:0x60
  s_waitcnt vmcnt(0)
  v_mfma_f32_16x16x32_bf16 v[20:23], v[68:71], v[36:39], v[20:23]
  v_bitop3_b32 v28, v28, v68, s34 bitop3:0x60
  v_and_b32 v28, 1, v28
  v_cmp_eq_u32 vcc, 0, v28
  s_nop 0
  s_cbranch_vccnz opc_4400017
  s_nop 2
  v_cndmask_b32 v24, v20, v22, s[40:41]
  v_cndmask_b32 v25, v21, v23, s[40:41]
  v_cvt_pk_bf16_f32 v24, v24, v25
  v_mov_b32 v25, v24
  s_nop 1
  v_permlane16_swap_b32 v24, v25
  v_mov_b32 v26, v24
  v_mov_b32 v27, v25
  s_nop 0
  v_permlane32_swap_b32 v24, v26
  v_permlane32_swap_b32 v25, v27
  s_mov_b64 exec, 0xffff
  buffer_store_dwordx4 v[24:27], v8, s[4:7], s36 offen
  s_mov_b64 exec, -1
  s_barrier
  s_mov_b64 exec, 0xffff
  buffer_store_dwordx4 v[24:27], v8, s[4:7], s37 offen sc1
  s_mov_b64 exec, -1
  s_xor_b32 s50, s33, 12288
  s_add_u32 s50, s50, s31
  s_add_u32 s50, s50, 167772160
  v_mov_b32 v28, -1
  buffer_store_dword v28, v8, s[4:7], s50 offen
  s_branch post_4400016
nown_4400015:
  s_barrier
post_4400016:
  v_readfirstlane_b32 s39, v12
  v_mov_b32 v12, -1
  s_add_u32 s58, s58, 262144
  s_add_u32 s59, s59, 262144
  s_xor_b32 s35, s35, 16384
  v_xor_b32 v14, 16384, v14
  s_add_u32 s18, s18, 1
  s_add_u32 s55, s55, 65536
  s_add_u32 s56, s56, 131072
  s_mov_b32 s52, s45
  s_mov_b32 s45, s46
  s_mov_b32 s46, s52
  s_add_u32 s48, s48, 12288
  s_xor_b32 s33, s33, 12288
  s_bfe_u32 s49, s18, 65537
  s_xor_b32 s34, s49, 1
  v_mov_b64 v[20:21], 0
  v_mov_b64 v[22:23], 0
  v_mov_b64 v[24:25], 0
  v_mov_b64 v[26:27], 0
  v_mov_b64 v[28:29], 0
  v_mov_b64 v[30:31], 0
  v_mov_b64 v[32:33], 0
  v_mov_b64 v[34:35], 0
  s_branch join_4400013
gat_4400012:
  s_add_u32 s57, s33, 167772160
  v_readfirstlane_b32 s39, v12
  v_mov_b32 v12, -1
  s_add_u32 s58, s58, 262144
  s_add_u32 s59, s59, 262144
  s_xor_b32 s35, s35, 16384
  v_xor_b32 v14, 16384, v14
  s_add_u32 s18, s18, 1
  s_add_u32 s55, s55, 65536
  s_add_u32 s56, s56, 131072
  s_mov_b32 s52, s45
  s_mov_b32 s45, s46
  s_mov_b32 s46, s52
  s_add_u32 s48, s48, 12288
  s_xor_b32 s33, s33, 12288
  s_bfe_u32 s49, s18, 65537
  s_xor_b32 s34, s49, 1
  s_sub_u32 s50, s17, 2
  s_mul_i32 s50, s50, 5120
  s_add_u32 s50, s50, s57
  s_add_u32 s51, s50, 4096
  v_mov_b64 v[20:21], 0
  v_mov_b64 v[22:23], 0
  v_mov_b64 v[24:25], 0
  v_mov_b64 v[26:27], 0
  v_mov_b64 v[28:29], 0
  v_mov_b64 v[30:31], 0
  v_mov_b64 v[32:33], 0
  v_mov_b64 v[34:35], 0
  s_barrier
  s_sleep 4
g5_4400018:
  buffer_load_dwordx4 v[72:75], v2, s[4:7], s50 offen offset:0 sc1
  buffer_load_dwordx4 v[76:79], v2, s[4:7], s50 offen offset:1024 sc1
  buffer_load_dwordx4 v[80:83], v2, s[4:7], s50 offen offset:2048 sc1
  buffer_load_dwordx4 v[84:87], v2, s[4:7], s50 offen offset:3072 sc1
  buffer_load_dwordx4 v[88:91], v2, s[4:7], s51 offen sc1
  s_add_u32 s19, s19, 1
  s_cmp_gt_u32 s19, 4194304
  s_cbranch_scc1 fz_fail
  s_waitcnt vmcnt(4)
  ds_write_b128 v3, v[72:75] offset:0
  v_max3_u32 v92, v72, v73, v74
  v_max_u32 v92, v92, v75
  s_waitcnt vmcnt(3)
  ds_write_b128 v3, v[76:79] offset:1024
  v_max3_u32 v92, v92, v76, v77
  v_max3_u32 v92, v92, v78, v79
  s_waitcnt vmcnt(2)
  ds_write_b128 v3, v[80:83] offset:2048
  v_max3_u32 v92, v92, v80, v81
  v_max3_u32 v92, v92, v82, v83
  s_waitcnt vmcnt(1)
  ds_write_b128 v3, v[84:87] offset:3072
  v_max3_u32 v92, v92, v84, v85
  v_max3_u32 v92, v92, v86, v87
  s_waitcnt vmcnt(0)
  ds_write_b128 v3, v[88:91] offset:4096
  v_max3_u32 v92, v92, v88, v89
  v_max3_u32 v92, v92, v90, v91
  v_cmp_eq_u32 vcc, -1, v92
  s_nop 0
  s_cbranch_vccnz g5_4400018
join_4400013:
  s_waitcnt lgkmcnt(0)
  s_barrier
  s_branch main_loop_fast
rs_4400006:
  s_add_u32 s50, s18, 1
  s_lshr_b32 s50, s50, 2
  s_min_u32 s50, s50, 15
  s_lshl_b32 s50, s50, 7
  s_add_u32 s50, s50, 85065728
rl_4400005:
  buffer_load_dword v36, v121, s[4:7], s50 offen sc1
  s_add_u32 s19, s19, 1
  s_cmp_gt_u32 s19, 4194304
  s_cbranch_scc1 fz_fail
  s_waitcnt vmcnt(0)
  v_readfirstlane_b32 s39, v36
  s_nop 0
  s_cmp_lt_u32 s39, 64
  s_cbranch_scc1 rl_4400005
  s_branch rok_4400004
thc_4400008:
  v_max_f32 v126, 0, v126
  v_mov_b32 v125, v126
  s_nop 1
  v_permlane32_swap_b32 v126, v125
  v_max_f32 v126, v126, v125
  v_mov_b32 v125, v126
  s_nop 1
  v_permlane16_swap_b32 v126, v125
  v_max_f32 v126, v126, v125
  v_sub_f32 v28, v28, v126
  v_sub_f32 v29, v29, v126
  v_sub_f32 v126, 0, v126
  v_exp_f32 v126, v126
  s_nop 7
  v_mul_f32 v32, v32, v126
  v_mul_f32 v33, v33, v126
  v_mul_f32 v34, v34, v126
  v_mul_f32 v35, v35, v126
  v_mul_f32 v36, v36, v126
  v_mul_f32 v37, v37, v126
  v_mul_f32 v38, v38, v126
  v_mul_f32 v39, v39, v126
  v_mul_f32 v20, v20, v126
  v_mul_f32 v21, v21, v126
  v_mul_f32 v22, v22, v126
  v_mul_f32 v23, v23, v126
  s_nop 1
  s_branch thr_4400007
vmc_4400011:
  s_waitcnt vmcnt(0)
  v_mov_b64 v[112:113], v[114:115]
vmp_4400009:
  v_max_u32 v126, v112, v113
  v_cmp_eq_u32 vcc, -1, v126
  s_nop 0
  s_cbranch_vccz vmok_4400010
  buffer_load_dwordx2 v[112:113], v9, s[4:7], s55 offen sc1
  s_add_u32 s19, s19, 1
  s_cmp_gt_u32 s19, 4194304
  s_cbranch_scc1 fz_fail
  s_waitcnt vmcnt(0)
  s_branch vmp_4400009
opc_4400017:
  s_add_u32 s19, s19, 1
  s_cmp_gt_u32 s19, 4194304
  s_cbranch_scc1 fz_fail
  s_branch ownp_4400014
main_loop_safe:
  ds_read_b128 v[72:75], v4 offset:0
  ds_read_b128 v[76:79], v4 offset:1024
  ds_read_b128 v[80:83], v4 offset:2048
  ds_read_b128 v[84:87], v4 offset:3072
  ds_read_b128 v[88:91], v4 offset:4096
  ds_read_b128 v[92:95], v4 offset:5120
  ds_read_b128 v[96:99], v4 offset:6144
  ds_read_b128 v[100:103], v4 offset:7168
  ds_read_b128 v[104:107], v4 offset:8192
  ds_read_b128 v[108:111], v4 offset:9216
  s_cmp_lt_u32 s39, 64
  s_nop 0
  s_cbranch_scc1 rs_4400021
rok_4400019:
  s_mov_b32 m0, s35
  s_nop 0
  buffer_load_dwordx4 v10, s[4:7], s58 offen lds
  buffer_load_dwordx4 v13, s[4:7], s58 offen offset:1024 lds
  s_add_u32 m0, s35, 8192
  s_nop 0
  buffer_load_dwordx4 v2, s[4:7], s59 offen lds
  buffer_load_dwordx4 v2, s[4:7], s59 offen offset:1024 lds
  s_waitcnt lgkmcnt(9)
  v_smfmac_f32_16x16x64_bf16 v[20:23], v[72:75], a[0:7], v1
  v_smfmac_f32_16x16x64_bf16 v[24:27], v[72:75], a[8:15], v1
  s_waitcnt lgkmcnt(8)
  v_smfmac_f32_16x16x64_bf16 v[20:23], v[76:79], a[16:23], v1
  v_smfmac_f32_16x16x64_bf16 v[24:27], v[76:79], a[24:31], v1
  s_waitcnt lgkmcnt(7)
  v_smfmac_f32_16x16x64_bf16 v[20:23], v[80:83], a[32:39], v1
  v_smfmac_f32_16x16x64_bf16 v[24:27], v[80:83], a[40:47], v1
  s_waitcnt lgkmcnt(6)
  v_smfmac_f32_16x16x64_bf16 v[20:23], v[84:87], a[48:55], v1
  v_smfmac_f32_16x16x64_bf16 v[24:27], v[84:87], a[56:63], v1
  s_waitcnt lgkmcnt(5)
  v_smfmac_f32_16x16x64_bf16 v[20:23], v[88:91], a[64:71], v1
  v_smfmac_f32_16x16x64_bf16 v[24:27], v[88:91], a[72:79], v1
  s_waitcnt lgkmcnt(4)
  v_smfmac_f32_16x16x64_bf16 v[20:23], v[92:95], a[80:87], v1
  v_smfmac_f32_16x16x64_bf16 v[24:27], v[92:95], a[88:95], v1
  s_waitcnt lgkmcnt(3)
  v_smfmac_f32_16x16x64_bf16 v[20:23], v[96:99], a[96:103], v1
  ds_read_b128 v[40:43], v14 offset:0
  v_smfmac_f32_16x16x64_bf16 v[24:27], v[96:99], a[104:111], v1
  ds_read_b128 v[44:47], v14 offset:1024
  s_waitcnt lgkmcnt(4)
  v_smfmac_f32_16x16x64_bf16 v[20:23], v[100:103], a[112:119], v1
  ds_read_b128 v[48:51], v14 offset:2048
  v_smfmac_f32_16x16x64_bf16 v[24:27], v[100:103], a[120:127], v1
  ds_read_b128 v[52:55], v14 offset:3072
  s_waitcnt lgkmcnt(5)
  v_smfmac_f32_16x16x64_bf16 v[20:23], v[104:107], a[128:135], v1
  ds_read_b128 v[56:59], v14 offset:4096
  v_smfmac_f32_16x16x64_bf16 v[24:27], v[104:107], a[136:143], v1
  ds_read_b128 v[60:63], v14 offset:5120
  s_waitcnt lgkmcnt(6)
  v_smfmac_f32_16x16x64_bf16 v[20:23], v[108:111], a[144:151], v1
  ds_read_b128 v[64:67], v14 offset:6144
  v_smfmac_f32_16x16x64_bf16 v[24:27], v[108:111], a[152:159], v1
  ds_read_b128 v[68:71], v14 offset:7168
  v_smfmac_f32_16x16x64_bf16 v[28:31], v[72:75], a[160:167], v1
  v_smfmac_f32_16x16x64_bf16 v[32:35], v[72:75], a[168:175], v1
  v_smfmac_f32_16x16x64_bf16 v[28:31], v[76:79], a[176:183], v1
  s_nop 1
  v_add_f32 v20, v20, v22
  v_smfmac_f32_16x16x64_bf16 v[32:35], v[76:79], a[184:191], v1
  v_add_f32 v21, v21, v23
  v_smfmac_f32_16x16x64_bf16 v[28:31], v[80:83], a[192:199], v1
  v_add_f32 v24, v24, v26
  v_smfmac_f32_16x16x64_bf16 v[32:35], v[80:83], a[200:207], v1
  v_add_f32 v25, v25, v27
  v_smfmac_f32_16x16x64_bf16 v[28:31], v[84:87], a[208:215], v1
  v_cvt_pk_bf16_f32 v36, v20, v21
  v_smfmac_f32_16x16x64_bf16 v[32:35], v[84:87], a[216:223], v1
  v_cvt_pk_bf16_f32 v37, v24, v25
  v_smfmac_f32_16x16x64_bf16 v[28:31], v[88:91], a[224:231], v1
  ds_write2_b32 v5, v36, v36 offset0:0 offset1:1
  v_smfmac_f32_16x16x64_bf16 v[32:35], v[88:91], a[232:239], v1
  ds_write2_b32 v5, v37, v37 offset0:128 offset1:129
  v_smfmac_f32_16x16x64_bf16 v[28:31], v[92:95], a[240:247], v1
  v_add_u32 v39, 4096, v5
  v_smfmac_f32_16x16x64_bf16 v[32:35], v[92:95], a[248:255], v1
  v_smfmac_f32_16x16x64_bf16 v[28:31], v[96:99], v[128:135], v1
  s_waitcnt lgkmcnt(0)
  s_barrier
  v_smfmac_f32_16x16x64_bf16 v[32:35], v[96:99], v[136:143], v1
  ds_read_b64_tr_b16 v[72:73], v6 offset:0
  ds_read_b64_tr_b16 v[74:75], v6 offset:128
  v_smfmac_f32_16x16x64_bf16 v[28:31], v[100:103], v[144:151], v1
  ds_read_b64_tr_b16 v[76:77], v6 offset:1024
  ds_read_b64_tr_b16 v[78:79], v6 offset:1152
  v_smfmac_f32_16x16x64_bf16 v[32:35], v[100:103], v[152:159], v1
  ds_read_b64_tr_b16 v[80:81], v6 offset:2048
  ds_read_b64_tr_b16 v[82:83], v6 offset:2176
  v_smfmac_f32_16x16x64_bf16 v[28:31], v[104:107], v[160:167], v1
  ds_read_b64_tr_b16 v[84:85], v6 offset:3072
  ds_read_b64_tr_b16 v[86:87], v6 offset:3200
  v_smfmac_f32_16x16x64_bf16 v[32:35], v[104:107], v[168:175], v1
  v_smfmac_f32_16x16x64_bf16 v[28:31], v[108:111], v[176:183], v1
  v_smfmac_f32_16x16x64_bf16 v[32:35], v[108:111], v[184:191], v1
  s_waitcnt lgkmcnt(0)
  v_mfma_f32_16x16x32_bf16 v[20:23], v[40:43], v[72:75], 0
  s_lshl_b32 s50, s17, 11
  v_mfma_f32_16x16x32_bf16 v[24:27], v[56:59], v[72:75], 0
  s_nop 2
  v_add_f32 v28, v28, v30
  v_add_f32 v29, v29, v31
  v_mfma_f32_16x16x32_bf16 v[20:23], v[44:47], v[76:79], v[20:23]
  v_add_f32 v32, v32, v34
  v_add_f32 v33, v33, v35
  v_mfma_f32_16x16x32_bf16 v[24:27], v[60:63], v[76:79], v[24:27]
  v_cvt_pk_bf16_f32 v36, v28, v29
  v_cvt_pk_bf16_f32 v37, v32, v33
  v_mfma_f32_16x16x32_bf16 v[20:23], v[48:51], v[80:83], v[20:23]
  ds_write2_b32 v39, v36, v36 offset0:0 offset1:1
  ds_write2_b32 v39, v37, v37 offset0:128 offset1:129
  v_mfma_f32_16x16x32_bf16 v[24:27], v[64:67], v[80:83], v[24:27]
  v_add_u32 v127, s50, v14
  v_mfma_f32_16x16x32_bf16 v[20:23], v[52:55], v[84:87], v[20:23]
  v_mfma_f32_16x16x32_bf16 v[24:27], v[68:71], v[84:87], v[24:27]
  s_waitcnt lgkmcnt(0)
  s_barrier
  s_cmp_ge_u32 s18, 63
  s_cbranch_scc1 main_last
  ds_read_b64_tr_b16 v[88:89], v6 offset:4096
  ds_read_b64_tr_b16 v[90:91], v6 offset:4224
  ds_read_b64_tr_b16 v[92:93], v6 offset:5120
  ds_read_b64_tr_b16 v[94:95], v6 offset:5248
  ds_read_b64_tr_b16 v[96:97], v6 offset:6144
  ds_read_b64_tr_b16 v[98:99], v6 offset:6272
  ds_read_b64_tr_b16 v[100:101], v6 offset:7168
  ds_read_b64_tr_b16 v[102:103], v6 offset:7296
  v_max3_f32 v126, v20, v21, v22
  v_max3_f32 v125, v23, v24, v25
  ds_read_b128 v[104:107], v127 offset:8192
  ds_read_b128 v[108:111], v127 offset:9216
  buffer_load_dwordx2 v[112:113], v9, s[4:7], s55 offen sc1
  v_max3_f32 v126, v126, v26, v27
  v_max_f32 v126, v126, v125
  v_mov_b32 v125, v126
  s_add_u32 s50, s18, 2
  s_lshr_b32 s50, s50, 2
  s_min_u32 s50, s50, 15
  s_lshl_b32 s50, s50, 7
  s_add_u32 s50, s50, 85065728
  v_permlane32_swap_b32 v126, v125
  v_max_f32 v126, v126, v125
  v_mov_b32 v125, v126
  buffer_load_dword v12, v121, s[4:7], s50 offen sc1
  s_nop 0
  v_permlane16_swap_b32 v126, v125
  v_max_f32 v126, v126, v125
  v_mul_f32 v127, v124, v126
  v_sub_f32 v127, 0, v127
  v_fma_f32 v20, v20, v124, v127
  v_fma_f32 v21, v21, v124, v127
  v_fma_f32 v22, v22, v124, v127
  v_fma_f32 v23, v23, v124, v127
  v_fma_f32 v24, v24, v124, v127
  v_fma_f32 v25, v25, v124, v127
  v_fma_f32 v26, v26, v124, v127
  v_fma_f32 v27, v27, v124, v127
  s_waitcnt lgkmcnt(8)
  v_mfma_f32_16x16x32_bf16 v[28:31], v[88:91], v[72:75], 0
  v_exp_f32 v20, v20
  v_exp_f32 v21, v21
  s_waitcnt lgkmcnt(6)
  v_mfma_f32_16x16x32_bf16 v[28:31], v[92:95], v[76:79], v[28:31]
  v_exp_f32 v22, v22
  v_exp_f32 v23, v23
  s_waitcnt lgkmcnt(4)
  v_mfma_f32_16x16x32_bf16 v[28:31], v[96:99], v[80:83], v[28:31]
  v_exp_f32 v24, v24
  v_exp_f32 v25, v25
  s_waitcnt lgkmcnt(2)
  v_mfma_f32_16x16x32_bf16 v[28:31], v[100:103], v[84:87], v[28:31]
  v_exp_f32 v26, v26
  v_exp_f32 v27, v27
  buffer_load_dwordx2 v[114:115], v9, s[4:7], s55 offen sc1
  v_cvt_pk_bf16_f32 v116, v20, v21
  v_cvt_pk_bf16_f32 v117, v22, v23
  v_cvt_pk_bf16_f32 v118, v24, v25
  v_cvt_pk_bf16_f32 v119, v26, v27
  s_nop 0
  v_fma_f32 v28, v28, v124, v127
  v_fma_f32 v29, v29, v124, v127
  s_waitcnt lgkmcnt(0)
  v_mfma_f32_16x16x32_bf16 v[32:35], v[104:107], v[116:119], 0
  v_max_f32 v126, v28, v29
  v_mfma_f32_16x16x32_bf16 v[36:39], v[108:111], v[116:119], 0
  v_cmp_lt_f32 vcc, s61, v126
  v_mfma_f32_16x16x32_bf16 v[20:23], v[16:19], v[116:119], 0
  ds_read_b128 v[40:43], v15 offset:0
  ds_read_b128 v[44:47], v15 offset:1024
  ds_read_b128 v[48:51], v15 offset:2048
  ds_read_b128 v[52:55], v15 offset:3072
  s_nop 1
  s_cbranch_vccnz thc_4400023
thr_4400022:
  v_exp_f32 v28, v28
  v_exp_f32 v29, v29
  ds_read_b128 v[56:59], v15 offset:4096
  ds_read_b128 v[60:63], v15 offset:5120
  ds_read_b128 v[64:67], v15 offset:6144
  ds_read_b128 v[68:71], v15 offset:7168
  v_cvt_pk_bf16_f32 v120, v28, v29
  v_cvt_pk_bf16_f32 v123, v28, v29
  s_nop 0
  v_mfma_f32_16x16x16_bf16 v[20:23], v[16:17], v[120:121], v[20:23]
  s_lshl_b32 s52, s17, 10
  v_add_u32 v125, s52, v6
  ds_read_b64_tr_b16 v[116:117], v125 offset:4096
  ds_read_b64_tr_b16 v[118:119], v125 offset:4224
  v_mov_b64 v[72:73], 0
  v_mov_b64 v[74:75], 0
  v_mov_b64 v[76:77], 0
  v_mov_b64 v[78:79], 0
  v_mov_b64 v[80:81], 0
  v_mov_b64 v[82:83], 0
  v_mov_b64 v[84:85], 0
  v_mov_b64 v[86:87], 0
  s_waitcnt vmcnt(1)
  v_max_u32 v126, v112, v113
  v_cmp_eq_u32 vcc, -1, v126
  s_nop 1
  s_cbranch_vccnz vmc_4400026
vmok_4400025:
  v_mfma_f32_16x16x16_bf16 v[32:35], v[112:113], v[120:121], v[32:35]
  v_mfma_f32_16x16x16_bf16 v[36:39], v[112:113], v[122:123], v[36:39]
  v_rcp_f32 v126, v20
  s_nop 0
  v_mov_b32 v127, v126
  s_nop 3
  v_cndmask_b32 v24, v32, v34, s[40:41]
  v_cndmask_b32 v25, v33, v35, s[40:41]
  v_pk_mul_f32 v[24:25], v[24:25], v[126:127]
  v_cvt_pk_bf16_f32 v28, v24, v25
  v_cndmask_b32 v26, v36, v38, s[40:41]
  v_cndmask_b32 v27, v37, v39, s[40:41]
  v_pk_mul_f32 v[26:27], v[26:27], v[126:127]
  v_cvt_pk_bf16_f32 v29, v26, v27
  ds_write_b64 v11, v[28:29]
  s_waitcnt lgkmcnt(1)
  buffer_store_dwordx4 v[116:119], v2, s[4:7], s56 offen sc1
  v_mov_b64 v[88:89], 0
  v_mov_b64 v[90:91], 0
  v_mov_b64 v[92:93], 0
  v_mov_b64 v[94:95], 0
  v_mov_b64 v[96:97], 0
  s_waitcnt lgkmcnt(0)
  s_barrier
  v_add_u32 v127, 53248, v2
  ds_read_b128 v[20:23], v127
  ds_read_b128 v[24:27], v127 offset:1024
  v_mov_b64 v[98:99], 0
  v_mov_b64 v[100:101], 0
  v_mov_b64 v[102:103], 0
  v_mov_b64 v[104:105], 0
  v_mov_b64 v[106:107], 0
  v_mov_b64 v[108:109], 0
  v_mov_b64 v[110:111], 0
  v_mov_b64 v[38:39], 0
  s_waitcnt lgkmcnt(0)
  v_smfmac_f32_16x16x64_bf16 v[72:75], v[20:23], v[192:199], v1
  v_smfmac_f32_16x16x64_bf16 v[76:79], v[20:23], v[200:207], v1
  v_smfmac_f32_16x16x64_bf16 v[72:75], v[24:27], v[40:47], v1
  v_smfmac_f32_16x16x64_bf16 v[76:79], v[24:27], v[48:55], v1
  ds_read_b128 v[40:43], v15 offset:8192
  ds_read_b128 v[44:47], v15 offset:9216
  ds_read_b128 v[48:51], v15 offset:10240
  ds_read_b128 v[52:55], v15 offset:11264
  v_smfmac_f32_16x16x64_bf16 v[80:83], v[20:23], v[208:215], v1
  v_smfmac_f32_16x16x64_bf16 v[84:87], v[20:23], v[216:223], v1
  v_smfmac_f32_16x16x64_bf16 v[80:83], v[24:27], v[56:63], v1
  v_add_f32 v72, v72, v74
  v_add_f32 v73, v73, v75
  v_smfmac_f32_16x16x64_bf16 v[84:87], v[24:27], v[64:71], v1
  ds_read_b128 v[56:59], v15 offset:12288
  ds_read_b128 v[60:63], v15 offset:13312
  ds_read_b128 v[64:67], v15 offset:14336
  ds_read_b128 v[68:71], v15 offset:15360
  v_cvt_pk_bf16_f32 v28, v72, v73
  v_smfmac_f32_16x16x64_bf16 v[88:91], v[20:23], v[224:231], v1
  v_add_f32 v76, v76, v78
  v_add_f32 v77, v77, v79
  v_smfmac_f32_16x16x64_bf16 v[92:95], v[20:23], v[232:239], v1
  v_cvt_pk_bf16_f32 v29, v76, v77
  s_waitcnt lgkmcnt(4)
  v_smfmac_f32_16x16x64_bf16 v[88:91], v[24:27], v[40:47], v1
  v_add_f32 v80, v80, v82
  v_add_f32 v81, v81, v83
  v_smfmac_f32_16x16x64_bf16 v[92:95], v[24:27], v[48:55], v1
  ds_read_b128 v[40:43], v15 offset:16384
  ds_read_b128 v[44:47], v15 offset:17408
  ds_read_b128 v[48:51], v15 offset:18432
  ds_read_b128 v[52:55], v15 offset:19456
  v_cvt_pk_bf16_f32 v30, v80, v81
  v_smfmac_f32_16x16x64_bf16 v[96:99], v[20:23], v[240:247], v1
  v_add_f32 v84, v84, v86
  v_add_f32 v85, v85, v87
  v_smfmac_f32_16x16x64_bf16 v[100:103], v[20:23], v[248:255], v1
  v_cvt_pk_bf16_f32 v31, v84, v85
  v_and_or_b32 v28, v28, -2, s49
  s_waitcnt lgkmcnt(4)
  v_smfmac_f32_16x16x64_bf16 v[96:99], v[24:27], v[56:63], v1
  s_add_u32 s50, s45, 0
  buffer_store_dwordx4 v[28:31], v7, s[4:7], s50 offen sc1
  v_add_f32 v88, v88, v90
  v_smfmac_f32_16x16x64_bf16 v[100:103], v[24:27], v[64:71], v1
  ds_read_b128 v[56:59], v15 offset:20480
  ds_read_b128 v[60:63], v15 offset:21504
  ds_read_b128 v[64:67], v15 offset:22528
  ds_read_b128 v[68:71], v15 offset:23552
  v_add_f32 v89, v89, v91
  s_waitcnt lgkmcnt(4)
  v_smfmac_f32_16x16x64_bf16 v[104:107], v[20:23], v[40:47], v1
  v_cvt_pk_bf16_f32 v32, v88, v89
  v_add_f32 v92, v92, v94
  v_smfmac_f32_16x16x64_bf16 v[108:111], v[20:23], v[48:55], v1
  v_add_f32 v93, v93, v95
  v_cvt_pk_bf16_f32 v33, v92, v93
  s_waitcnt lgkmcnt(0)
  v_smfmac_f32_16x16x64_bf16 v[104:107], v[24:27], v[56:63], v1
  v_add_f32 v96, v96, v98
  v_add_f32 v97, v97, v99
  v_smfmac_f32_16x16x64_bf16 v[108:111], v[24:27], v[64:71], v1
  v_cvt_pk_bf16_f32 v34, v96, v97
  v_add_f32 v100, v100, v102
  v_add_f32 v101, v101, v103
  v_cvt_pk_bf16_f32 v35, v100, v101
  v_and_or_b32 v32, v32, -2, s49
  s_add_u32 s50, s45, 32768
  buffer_store_dwordx4 v[32:35], v7, s[4:7], s50 offen sc1
  v_add_f32 v104, v104, v106
  v_add_f32 v105, v105, v107
  v_cvt_pk_bf16_f32 v36, v104, v105
  v_add_f32 v108, v108, v110
  v_add_f32 v109, v109, v111
  v_cvt_pk_bf16_f32 v37, v108, v109
  v_and_or_b32 v36, v36, -2, s49
  s_add_u32 s50, s45, 65536
  buffer_store_dwordx4 v[36:39], v7, s[4:7], s50 offen sc1
  s_cmp_ge_u32 s17, 2
  s_cbranch_scc1 gat_4400027
  s_cmp_eq_u32 s53, -1
  s_cbranch_scc1 nown_4400030
  v_add_u32 v127, 55296, v2
  ds_read_b128 v[36:39], v127
  s_and_b32 s50, s18, 1
  s_mul_i32 s50, s50, 393216
  s_lshl_b32 s51, s53, 13
  s_add_u32 s50, s50, s51
  s_add_u32 s50, s50, 83886080
  s_add_u32 s51, s50, 4096
  s_add_u32 s37, s31, s48
  s_add_u32 s37, s37, 168820736
  s_add_u32 s36, s31, s33
  s_add_u32 s36, s36, 167772160
  s_sleep 4
  s_waitcnt lgkmcnt(0)
ownp_4400029:
  buffer_load_dwordx4 v[40:43], v2, s[4:7], s50 offen offset:0 sc1
  buffer_load_dwordx4 v[44:47], v2, s[4:7], s50 offen offset:1024 sc1
  buffer_load_dwordx4 v[48:51], v2, s[4:7], s50 offen offset:2048 sc1
  buffer_load_dwordx4 v[52:55], v2, s[4:7], s50 offen offset:3072 sc1
  buffer_load_dwordx4 v[56:59], v2, s[4:7], s51 offen offset:0 sc1
  buffer_load_dwordx4 v[60:63], v2, s[4:7], s51 offen offset:1024 sc1
  buffer_load_dwordx4 v[64:67], v2, s[4:7], s51 offen offset:2048 sc1
  buffer_load_dwordx4 v[68:71], v2, s[4:7], s51 offen offset:3072 sc1
  s_waitcnt vmcnt(7)
  v_mfma_f32_16x16x32_bf16 v[20:23], v[40:43], v[36:39], 0
  v_xor_b32 v28, s34, v40
  s_waitcnt vmcnt(6)
  v_mfma_f32_16x16x32_bf16 v[20:23], v[44:47], v[36:39], v[20:23]
  v_bitop3_b32 v28, v28, v44, s34 bitop3:0x60
  s_waitcnt vmcnt(5)
  v_mfma_f32_16x16x32_bf16 v[20:23], v[48:51], v[36:39], v[20:23]
  v_bitop3_b32 v28, v28, v48, s34 bitop3:0x60
  s_waitcnt vmcnt(4)
  v_mfma_f32_16x16x32_bf16 v[20:23], v[52:55], v[36:39], v[20:23]
  v_bitop3_b32 v28, v28, v52, s34 bitop3:0x60
  s_waitcnt vmcnt(3)
  v_mfma_f32_16x16x32_bf16 v[20:23], v[56:59], v[36:39], v[20:23]
  v_bitop3_b32 v28, v28, v56, s34 bitop3:0x60
  s_waitcnt vmcnt(2)
  v_mfma_f32_16x16x32_bf16 v[20:23], v[60:63], v[36:39], v[20:23]
  v_bitop3_b32 v28, v28, v60, s34 bitop3:0x60
  s_waitcnt vmcnt(1)
  v_mfma_f32_16x16x32_bf16 v[20:23], v[64:67], v[36:39], v[20:23]
  v_bitop3_b32 v28, v28, v64, s34 bitop3:0x60
  s_waitcnt vmcnt(0)
  v_mfma_f32_16x16x32_bf16 v[20:23], v[68:71], v[36:39], v[20:23]
  v_bitop3_b32 v28, v28, v68, s34 bitop3:0x60
  v_and_b32 v28, 1, v28
  v_cmp_eq_u32 vcc, 0, v28
  s_nop 0
  s_cbranch_vccnz opc_4400032
  s_nop 2
  v_cndmask_b32 v24, v20, v22, s[40:41]
  v_cndmask_b32 v25, v21, v23, s[40:41]
  v_cvt_pk_bf16_f32 v24, v24, v25
  v_mov_b32 v25, v24
  s_nop 1
  v_permlane16_swap_b32 v24, v25
  v_mov_b32 v26, v24
  v_mov_b32 v27, v25
  s_nop 0
  v_permlane32_swap_b32 v24, v26
  v_permlane32_swap_b32 v25, v27
  s_mov_b64 exec, 0xffff
  buffer_store_dwordx4 v[24:27], v8, s[4:7], s36 offen sc1
  s_mov_b64 exec, -1
  s_barrier
  s_mov_b64 exec, 0xffff
  buffer_store_dwordx4 v[24:27], v8, s[4:7], s37 offen sc1
  s_mov_b64 exec, -1
  s_xor_b32 s50, s33, 12288
  s_add_u32 s50, s50, s31
  s_add_u32 s50, s50, 167772160
  v_mov_b32 v28, -1
  buffer_store_dword v28, v8, s[4:7], s50 offen sc1
  s_branch post_4400031
nown_4400030:
  s_barrier
post_4400031:
  v_readfirstlane_b32 s39, v12
  v_mov_b32 v12, -1
  s_add_u32 s58, s58, 262144
  s_add_u32 s59, s59, 262144
  s_xor_b32 s35, s35, 16384
  v_xor_b32 v14, 16384, v14
  s_add_u32 s18, s18, 1
  s_add_u32 s55, s55, 65536
  s_add_u32 s56, s56, 131072
  s_mov_b32 s52, s45
  s_mov_b32 s45, s46
  s_mov_b32 s46, s52
  s_add_u32 s48, s48, 12288
  s_xor_b32 s33, s33, 12288
  s_bfe_u32 s49, s18, 65537
  s_xor_b32 s34, s49, 1
  v_mov_b64 v[20:21], 0
  v_mov_b64 v[22:23], 0
  v_mov_b64 v[24:25], 0
  v_mov_b64 v[26:27], 0
  v_mov_b64 v[28:29], 0
  v_mov_b64 v[30:31], 0
  v_mov_b64 v[32:33], 0
  v_mov_b64 v[34:35], 0
  s_branch join_4400028
gat_4400027:
  s_add_u32 s57, s33, 167772160
  v_readfirstlane_b32 s39, v12
  v_mov_b32 v12, -1
  s_add_u32 s58, s58, 262144
  s_add_u32 s59, s59, 262144
  s_xor_b32 s35, s35, 16384
  v_xor_b32 v14, 16384, v14
  s_add_u32 s18, s18, 1
  s_add_u32 s55, s55, 65536
  s_add_u32 s56, s56, 131072
  s_mov_b32 s52, s45
  s_mov_b32 s45, s46
  s_mov_b32 s46, s52
  s_add_u32 s48, s48, 12288
  s_xor_b32 s33, s33, 12288
  s_bfe_u32 s49, s18, 65537
  s_xor_b32 s34, s49, 1
  s_sub_u32 s50, s17, 2
  s_mul_i32 s50, s50, 5120
  s_add_u32 s50, s50, s57
  s_add_u32 s51, s50, 4096
  v_mov_b64 v[20:21], 0
  v_mov_b64 v[22:23], 0
  v_mov_b64 v[24:25], 0
  v_mov_b64 v[26:27], 0
  v_mov_b64 v[28:29], 0
  v_mov_b64 v[30:31], 0
  v_mov_b64 v[32:33], 0
  v_mov_b64 v[34:35], 0
  s_barrier
  s_sleep 4
g5_4400033:
  buffer_load_dwordx4 v[72:75], v2, s[4:7], s50 offen offset:0 sc1
  buffer_load_dwordx4 v[76:79], v2, s[4:7], s50 offen offset:1024 sc1
  buffer_load_dwordx4 v[80:83], v2, s[4:7], s50 offen offset:2048 sc1
  buffer_load_dwordx4 v[84:87], v2, s[4:7], s50 offen offset:3072 sc1
  buffer_load_dwordx4 v[88:91], v2, s[4:7], s51 offen sc1
  s_add_u32 s19, s19, 1
  s_cmp_gt_u32 s19, 4194304
  s_cbranch_scc1 fz_fail
  s_waitcnt vmcnt(4)
  ds_write_b128 v3, v[72:75] offset:0
  v_max3_u32 v92, v72, v73, v74
  v_max_u32 v92, v92, v75
  s_waitcnt vmcnt(3)
  ds_write_b128 v3, v[76:79] offset:1024
  v_max3_u32 v92, v92, v76, v77
  v_max3_u32 v92, v92, v78, v79
  s_waitcnt vmcnt(2)
  ds_write_b128 v3, v[80:83] offset:2048
  v_max3_u32 v92, v92, v80, v81
  v_max3_u32 v92, v92, v82, v83
  s_waitcnt vmcnt(1)
  ds_write_b128 v3, v[84:87] offset:3072
  v_max3_u32 v92, v92, v84, v85
  v_max3_u32 v92, v92, v86, v87
  s_waitcnt vmcnt(0)
  ds_write_b128 v3, v[88:91] offset:4096
  v_max3_u32 v92, v92, v88, v89
  v_max3_u32 v92, v92, v90, v91
  v_cmp_eq_u32 vcc, -1, v92
  s_nop 0
  s_cbranch_vccnz g5_4400033
join_4400028:
  s_waitcnt lgkmcnt(0)
  s_barrier
  s_branch main_loop_safe
rs_4400021:
  s_add_u32 s50, s18, 1
  s_lshr_b32 s50, s50, 2
  s_min_u32 s50, s50, 15
  s_lshl_b32 s50, s50, 7
  s_add_u32 s50, s50, 85065728
rl_4400020:
  buffer_load_dword v36, v121, s[4:7], s50 offen sc1
  s_add_u32 s19, s19, 1
  s_cmp_gt_u32 s19, 4194304
  s_cbranch_scc1 fz_fail
  s_waitcnt vmcnt(0)
  v_readfirstlane_b32 s39, v36
  s_nop 0
  s_cmp_lt_u32 s39, 64
  s_cbranch_scc1 rl_4400020
  s_branch rok_4400019
thc_4400023:
  v_max_f32 v126, 0, v126
  v_mov_b32 v125, v126
  s_nop 1
  v_permlane32_swap_b32 v126, v125
  v_max_f32 v126, v126, v125
  v_mov_b32 v125, v126
  s_nop 1
  v_permlane16_swap_b32 v126, v125
  v_max_f32 v126, v126, v125
  v_sub_f32 v28, v28, v126
  v_sub_f32 v29, v29, v126
  v_sub_f32 v126, 0, v126
  v_exp_f32 v126, v126
  s_nop 7
  v_mul_f32 v32, v32, v126
  v_mul_f32 v33, v33, v126
  v_mul_f32 v34, v34, v126
  v_mul_f32 v35, v35, v126
  v_mul_f32 v36, v36, v126
  v_mul_f32 v37, v37, v126
  v_mul_f32 v38, v38, v126
  v_mul_f32 v39, v39, v126
  v_mul_f32 v20, v20, v126
  v_mul_f32 v21, v21, v126
  v_mul_f32 v22, v22, v126
  v_mul_f32 v23, v23, v126
  s_nop 1
  s_branch thr_4400022
vmc_4400026:
  s_waitcnt vmcnt(0)
  v_mov_b64 v[112:113], v[114:115]
vmp_4400024:
  v_max_u32 v126, v112, v113
  v_cmp_eq_u32 vcc, -1, v126
  s_nop 0
  s_cbranch_vccz vmok_4400025
  buffer_load_dwordx2 v[112:113], v9, s[4:7], s55 offen sc1
  s_add_u32 s19, s19, 1
  s_cmp_gt_u32 s19, 4194304
  s_cbranch_scc1 fz_fail
  s_waitcnt vmcnt(0)
  s_branch vmp_4400024
opc_4400032:
  s_add_u32 s19, s19, 1
  s_cmp_gt_u32 s19, 4194304
  s_cbranch_scc1 fz_fail
  s_branch ownp_4400029
main_last:
  s_lshl_b32 s56, s16, 12
  s_add_u32 s56, s56, 79560704
  s_lshl_b32 s50, s17, 10
  s_add_u32 s56, s56, s50
  s_lshl_b32 s52, s17, 10
  v_add_u32 v44, s52, v6
  ds_read_b64_tr_b16 v[40:41], v44 offset:4096
  ds_read_b64_tr_b16 v[42:43], v44 offset:4224
  s_waitcnt lgkmcnt(0)
  buffer_store_dwordx4 v[40:43], v2, s[4:7], s56 offen sc1
  s_add_u32 s56, s56, 131072
  s_branch fz_end
chain_helper:
  s_load_dwordx2 s[20:21], s[0:1], 32
  s_mov_b32 s22, 5242880
  s_mov_b32 s23, 0x00020000
  v_lshrrev_b32 v36, 4, v0
  v_and_b32 v37, 15, v0
  v_lshlrev_b32 v37, 4, v37
  v_lshlrev_b32 v10, 13, v36
  v_add_u32 v10, v10, v37
  v_lshrrev_b32 v36, 4, v0
  v_bfe_u32 v37, v0, 2, 2
  v_lshlrev_b32 v38, 3, v36
  v_add_u32 v38, v38, v37
  v_lshlrev_b32 v38, 8, v38
  v_and_b32 v39, 3, v0
  v_lshlrev_b32 v39, 3, v39
  v_add_u32 v12, v38, v39
  s_lshl_b32 s50, s17, 6
  v_add_u32 v12, s50, v12
  s_lshl_b32 s30, s16, 8
  s_waitcnt lgkmcnt(0)
  s_mul_i32 s50, s17, 131072
  s_add_u32 s50, s50, s30
  s_lshl_b32 s51, s17, 12
  s_add_u32 s52, s50, 0
  s_add_u32 m0, s51, 0
  s_nop 0
  buffer_load_dwordx4 v10, s[20:23], s52 offen lds
  s_add_u32 s52, s50, 32768
  s_add_u32 m0, s51, 1024
  s_nop 0
  buffer_load_dwordx4 v10, s[20:23], s52 offen lds
  s_add_u32 s52, s50, 65536
  s_add_u32 m0, s51, 2048
  s_nop 0
  buffer_load_dwordx4 v10, s[20:23], s52 offen lds
  s_add_u32 s52, s50, 98304
  s_add_u32 m0, s51, 3072
  s_nop 0
  buffer_load_dwordx4 v10, s[20:23], s52 offen lds
  s_mul_i32 s50, s17, 131072
  s_add_u32 s50, s50, s30
  s_lshl_b32 s51, s17, 12
  s_add_u32 s52, s50, 524288
  s_add_u32 m0, s51, 16384
  s_nop 0
  buffer_load_dwordx4 v10, s[20:23], s52 offen lds
  s_add_u32 s52, s50, 557056
  s_add_u32 m0, s51, 17408
  s_nop 0
  buffer_load_dwordx4 v10, s[20:23], s52 offen lds
  s_add_u32 s52, s50, 589824
  s_add_u32 m0, s51, 18432
  s_nop 0
  buffer_load_dwordx4 v10, s[20:23], s52 offen lds
  s_add_u32 s52, s50, 622592
  s_add_u32 m0, s51, 19456
  s_nop 0
  buffer_load_dwordx4 v10, s[20:23], s52 offen lds
  s_mul_i32 s50, s17, 131072
  s_add_u32 s50, s50, s30
  s_lshl_b32 s51, s17, 12
  s_add_u32 s52, s50, 1048576
  s_add_u32 m0, s51, 32768
  s_nop 0
  buffer_load_dwordx4 v10, s[20:23], s52 offen lds
  s_add_u32 s52, s50, 1081344
  s_add_u32 m0, s51, 33792
  s_nop 0
  buffer_load_dwordx4 v10, s[20:23], s52 offen lds
  s_add_u32 s52, s50, 1114112
  s_add_u32 m0, s51, 34816
  s_nop 0
  buffer_load_dwordx4 v10, s[20:23], s52 offen lds
  s_add_u32 s52, s50, 1146880
  s_add_u32 m0, s51, 35840
  s_nop 0
  buffer_load_dwordx4 v10, s[20:23], s52 offen lds
  s_mul_i32 s50, s17, 131072
  s_add_u32 s50, s50, s30
  s_lshl_b32 s51, s17, 12
  s_add_u32 s52, s50, 1572864
  s_add_u32 m0, s51, 49152
  s_nop 0
  buffer_load_dwordx4 v10, s[20:23], s52 offen lds
  s_add_u32 s52, s50, 1605632
  s_add_u32 m0, s51, 50176
  s_nop 0
  buffer_load_dwordx4 v10, s[20:23], s52 offen lds
  s_add_u32 s52, s50, 1638400
  s_add_u32 m0, s51, 51200
  s_nop 0
  buffer_load_dwordx4 v10, s[20:23], s52 offen lds
  s_add_u32 s52, s50, 1671168
  s_add_u32 m0, s51, 52224
  s_nop 0
  buffer_load_dwordx4 v10, s[20:23], s52 offen lds
  s_mul_i32 s50, s17, 131072
  s_add_u32 s50, s50, s30
  s_lshl_b32 s51, s17, 12
  s_add_u32 s52, s50, 2097152
  s_add_u32 m0, s51, 65536
  s_nop 0
  buffer_load_dwordx4 v10, s[20:23], s52 offen lds
  s_add_u32 s52, s50, 2129920
  s_add_u32 m0, s51, 66560
  s_nop 0
  buffer_load_dwordx4 v10, s[20:23], s52 offen lds
  s_add_u32 s52, s50, 2162688
  s_add_u32 m0, s51, 67584
  s_nop 0
  buffer_load_dwordx4 v10, s[20:23], s52 offen lds
  s_add_u32 s52, s50, 2195456
  s_add_u32 m0, s51, 68608
  s_nop 0
  buffer_load_dwordx4 v10, s[20:23], s52 offen lds
  s_mul_i32 s50, s17, 131072
  s_add_u32 s50, s50, s30
  s_lshl_b32 s51, s17, 12
  s_add_u32 s52, s50, 2621440
  s_add_u32 m0, s51, 81920
  s_nop 0
  buffer_load_dwordx4 v10, s[20:23], s52 offen lds
  s_add_u32 s52, s50, 2654208
  s_add_u32 m0, s51, 82944
  s_nop 0
  buffer_load_dwordx4 v10, s[20:23], s52 offen lds
  s_add_u32 s52, s50, 2686976
  s_add_u32 m0, s51, 83968
  s_nop 0
  buffer_load_dwordx4 v10, s[20:23], s52 offen lds
  s_add_u32 s52, s50, 2719744
  s_add_u32 m0, s51, 84992
  s_nop 0
  buffer_load_dwordx4 v10, s[20:23], s52 offen lds
  s_mul_i32 s50, s17, 131072
  s_add_u32 s50, s50, s30
  s_lshl_b32 s51, s17, 12
  s_add_u32 s52, s50, 3145728
  s_add_u32 m0, s51, 98304
  s_nop 0
  buffer_load_dwordx4 v10, s[20:23], s52 offen lds
  s_add_u32 s52, s50, 3178496
  s_add_u32 m0, s51, 99328
  s_nop 0
  buffer_load_dwordx4 v10, s[20:23], s52 offen lds
  s_add_u32 s52, s50, 3211264
  s_add_u32 m0, s51, 100352
  s_nop 0
  buffer_load_dwordx4 v10, s[20:23], s52 offen lds
  s_add_u32 s52, s50, 3244032
  s_add_u32 m0, s51, 101376
  s_nop 0
  buffer_load_dwordx4 v10, s[20:23], s52 offen lds
  s_mul_i32 s50, s17, 131072
  s_add_u32 s50, s50, s30
  s_lshl_b32 s51, s17, 12
  s_add_u32 s52, s50, 3670016
  s_add_u32 m0, s51, 114688
  s_nop 0
  buffer_load_dwordx4 v10, s[20:23], s52 offen lds
  s_add_u32 s52, s50, 3702784
  s_add_u32 m0, s51, 115712
  s_nop 0
  buffer_load_dwordx4 v10, s[20:23], s52 offen lds
  s_add_u32 s52, s50, 3735552
  s_add_u32 m0, s51, 116736
  s_nop 0
  buffer_load_dwordx4 v10, s[20:23], s52 offen lds
  s_add_u32 s52, s50, 3768320
  s_add_u32 m0, s51, 117760
  s_nop 0
  buffer_load_dwordx4 v10, s[20:23], s52 offen lds
  s_mul_i32 s50, s17, 131072
  s_add_u32 s50, s50, s30
  s_lshl_b32 s51, s17, 12
  s_add_u32 s52, s50, 4194304
  s_add_u32 m0, s51, 131072
  s_nop 0
  buffer_load_dwordx4 v10, s[20:23], s52 offen lds
  s_add_u32 s52, s50, 4227072
  s_add_u32 m0, s51, 132096
  s_nop 0
  buffer_load_dwordx4 v10, s[20:23], s52 offen lds
  s_add_u32 s52, s50, 4259840
  s_add_u32 m0, s51, 133120
  s_nop 0
  buffer_load_dwordx4 v10, s[20:23], s52 offen lds
  s_add_u32 s52, s50, 4292608
  s_add_u32 m0, s51, 134144
  s_nop 0
  buffer_load_dwordx4 v10, s[20:23], s52 offen lds
  s_waitcnt vmcnt(32)
  s_barrier
  s_mul_i32 s50, s17, 131072
  s_add_u32 s50, s50, s30
  s_lshl_b32 s51, s17, 12
  s_add_u32 s52, s50, 4718592
  s_add_u32 m0, s51, 147456
  s_nop 0
  buffer_load_dwordx4 v10, s[20:23], s52 offen lds
  s_add_u32 s52, s50, 4751360
  s_add_u32 m0, s51, 148480
  s_nop 0
  buffer_load_dwordx4 v10, s[20:23], s52 offen lds
  s_add_u32 s52, s50, 4784128
  s_add_u32 m0, s51, 149504
  s_nop 0
  buffer_load_dwordx4 v10, s[20:23], s52 offen lds
  s_add_u32 s52, s50, 4816896
  s_add_u32 m0, s51, 150528
  s_nop 0
  buffer_load_dwordx4 v10, s[20:23], s52 offen lds
  v_add_u32 v14, 0, v12
  ds_read_b64_tr_b16 a[0:1], v14 offset:0
  ds_read_b64_tr_b16 a[2:3], v14 offset:1024
  ds_read_b64_tr_b16 a[4:5], v14 offset:8192
  ds_read_b64_tr_b16 a[6:7], v14 offset:9216
  ds_read_b64_tr_b16 a[8:9], v14 offset:32
  ds_read_b64_tr_b16 a[10:11], v14 offset:1056
  ds_read_b64_tr_b16 a[12:13], v14 offset:8224
  ds_read_b64_tr_b16 a[14:15], v14 offset:9248
  s_waitcnt lgkmcnt(0)
  s_waitcnt vmcnt(32)
  s_barrier
  v_add_u32 v14, 16384, v12
  ds_read_b64_tr_b16 a[16:17], v14 offset:0
  ds_read_b64_tr_b16 a[18:19], v14 offset:1024
  ds_read_b64_tr_b16 a[20:21], v14 offset:8192
  ds_read_b64_tr_b16 a[22:23], v14 offset:9216
  ds_read_b64_tr_b16 a[24:25], v14 offset:32
  ds_read_b64_tr_b16 a[26:27], v14 offset:1056
  ds_read_b64_tr_b16 a[28:29], v14 offset:8224
  ds_read_b64_tr_b16 a[30:31], v14 offset:9248
  s_waitcnt lgkmcnt(0)
  s_waitcnt vmcnt(28)
  s_barrier
  v_add_u32 v14, 32768, v12
  ds_read_b64_tr_b16 a[32:33], v14 offset:0
  ds_read_b64_tr_b16 a[34:35], v14 offset:1024
  ds_read_b64_tr_b16 a[36:37], v14 offset:8192
  ds_read_b64_tr_b16 a[38:39], v14 offset:9216
  ds_read_b64_tr_b16 a[40:41], v14 offset:32
  ds_read_b64_tr_b16 a[42:43], v14 offset:1056
  ds_read_b64_tr_b16 a[44:45], v14 offset:8224
  ds_read_b64_tr_b16 a[46:47], v14 offset:9248
  s_waitcnt lgkmcnt(0)
  s_waitcnt vmcnt(24)
  s_barrier
  v_add_u32 v14, 49152, v12
  ds_read_b64_tr_b16 a[48:49], v14 offset:0
  ds_read_b64_tr_b16 a[50:51], v14 offset:1024
  ds_read_b64_tr_b16 a[52:53], v14 offset:8192
  ds_read_b64_tr_b16 a[54:55], v14 offset:9216
  ds_read_b64_tr_b16 a[56:57], v14 offset:32
  ds_read_b64_tr_b16 a[58:59], v14 offset:1056
  ds_read_b64_tr_b16 a[60:61], v14 offset:8224
  ds_read_b64_tr_b16 a[62:63], v14 offset:9248
  s_waitcnt lgkmcnt(0)
  s_waitcnt vmcnt(20)
  s_barrier
  v_add_u32 v14, 65536, v12
  ds_read_b64_tr_b16 a[64:65], v14 offset:0
  ds_read_b64_tr_b16 a[66:67], v14 offset:1024
  ds_read_b64_tr_b16 a[68:69], v14 offset:8192
  ds_read_b64_tr_b16 a[70:71], v14 offset:9216
  ds_read_b64_tr_b16 a[72:73], v14 offset:32
  ds_read_b64_tr_b16 a[74:75], v14 offset:1056
  ds_read_b64_tr_b16 a[76:77], v14 offset:8224
  ds_read_b64_tr_b16 a[78:79], v14 offset:9248
  s_waitcnt lgkmcnt(0)
  s_waitcnt vmcnt(16)
  s_barrier
  v_add_u32 v14, 81920, v12
  ds_read_b64_tr_b16 a[80:81], v14 offset:0
  ds_read_b64_tr_b16 a[82:83], v14 offset:1024
  ds_read_b64_tr_b16 a[84:85], v14 offset:8192
  ds_read_b64_tr_b16 a[86:87], v14 offset:9216
  ds_read_b64_tr_b16 a[88:89], v14 offset:32
  ds_read_b64_tr_b16 a[90:91], v14 offset:1056
  ds_read_b64_tr_b16 a[92:93], v14 offset:8224
  ds_read_b64_tr_b16 a[94:95], v14 offset:9248
  s_waitcnt lgkmcnt(0)
  s_waitcnt vmcnt(12)
  s_barrier
  v_add_u32 v14, 98304, v12
  ds_read_b64_tr_b16 a[96:97], v14 offset:0
  ds_read_b64_tr_b16 a[98:99], v14 offset:1024
  ds_read_b64_tr_b16 a[100:101], v14 offset:8192
  ds_read_b64_tr_b16 a[102:103], v14 offset:9216
  ds_read_b64_tr_b16 a[104:105], v14 offset:32
  ds_read_b64_tr_b16 a[106:107], v14 offset:1056
  ds_read_b64_tr_b16 a[108:109], v14 offset:8224
  ds_read_b64_tr_b16 a[110:111], v14 offset:9248
  s_waitcnt lgkmcnt(0)
  s_waitcnt vmcnt(8)
  s_barrier
  v_add_u32 v14, 114688, v12
  ds_read_b64_tr_b16 a[112:113], v14 offset:0
  ds_read_b64_tr_b16 a[114:115], v14 offset:1024
  ds_read_b64_tr_b16 a[116:117], v14 offset:8192
  ds_read_b64_tr_b16 a[118:119], v14 offset:9216
  ds_read_b64_tr_b16 a[120:121], v14 offset:32
  ds_read_b64_tr_b16 a[122:123], v14 offset:1056
  ds_read_b64_tr_b16 a[124:125], v14 offset:8224
  ds_read_b64_tr_b16 a[126:127], v14 offset:9248
  s_waitcnt lgkmcnt(0)
  s_waitcnt vmcnt(4)
  s_barrier
  v_add_u32 v14, 131072, v12
  ds_read_b64_tr_b16 a[128:129], v14 offset:0
  ds_read_b64_tr_b16 a[130:131], v14 offset:1024
  ds_read_b64_tr_b16 a[132:133], v14 offset:8192
  ds_read_b64_tr_b16 a[134:135], v14 offset:9216
  ds_read_b64_tr_b16 a[136:137], v14 offset:32
  ds_read_b64_tr_b16 a[138:139], v14 offset:1056
  ds_read_b64_tr_b16 a[140:141], v14 offset:8224
  ds_read_b64_tr_b16 a[142:143], v14 offset:9248
  s_waitcnt lgkmcnt(0)
  s_waitcnt vmcnt(0)
  s_barrier
  v_add_u32 v14, 147456, v12
  ds_read_b64_tr_b16 a[144:145], v14 offset:0
  ds_read_b64_tr_b16 a[146:147], v14 offset:1024
  ds_read_b64_tr_b16 a[148:149], v14 offset:8192
  ds_read_b64_tr_b16 a[150:151], v14 offset:9216
  ds_read_b64_tr_b16 a[152:153], v14 offset:32
  ds_read_b64_tr_b16 a[154:155], v14 offset:1056
  ds_read_b64_tr_b16 a[156:157], v14 offset:8224
  ds_read_b64_tr_b16 a[158:159], v14 offset:9248
  s_waitcnt lgkmcnt(0)
  s_barrier
  v_mov_b64 v[12:13], -1
  v_mov_b64 v[14:15], -1
  v_lshlrev_b32 v9, 3, v0
  s_lshl_b32 s55, s16, 11
  s_add_u32 s55, s55, 79691776
  s_load_dwordx2 s[8:9], s[0:1], 8
  s_mov_b32 s10, 10240
  s_mov_b32 s11, 0x00020000
  v_bfe_u32 v36, v0, 2, 2
  v_lshlrev_b32 v36, 1, v36
  v_and_b32 v37, 1, v0
  v_add_u32 v36, v36, v37
  v_mul_u32_u24 v36, 1280, v36
  v_lshrrev_b32 v37, 4, v0
  v_lshlrev_b32 v37, 5, v37
  v_add_u32 v36, v36, v37
  v_bfe_u32 v37, v0, 1, 1
  v_lshlrev_b32 v37, 2, v37
  v_add_u32 v36, v36, v37
  s_lshl_b32 s50, s17, 7
  s_waitcnt lgkmcnt(0)
  s_add_u32 s51, s50, 0
  buffer_load_dword v40, v36, s[8:11], s51 offen offset:0
  buffer_load_dword v41, v36, s[8:11], s51 offen offset:8
  buffer_load_dword v42, v36, s[8:11], s51 offen offset:16
  buffer_load_dword v43, v36, s[8:11], s51 offen offset:24
  s_add_u32 s51, s50, 512
  buffer_load_dword v44, v36, s[8:11], s51 offen offset:0
  buffer_load_dword v45, v36, s[8:11], s51 offen offset:8
  buffer_load_dword v46, v36, s[8:11], s51 offen offset:16
  buffer_load_dword v47, v36, s[8:11], s51 offen offset:24
  s_add_u32 s51, s50, 1024
  buffer_load_dword v48, v36, s[8:11], s51 offen offset:0
  buffer_load_dword v49, v36, s[8:11], s51 offen offset:8
  buffer_load_dword v50, v36, s[8:11], s51 offen offset:16
  buffer_load_dword v51, v36, s[8:11], s51 offen offset:24
  s_waitcnt vmcnt(0)
  s_lshl_b32 s52, s17, 10
  v_add_u32 v38, s52, v4
  ds_write_b128 v38, v[40:43] offset:0
  ds_write_b128 v38, v[44:47] offset:4096
  ds_write_b128 v38, v[48:51] offset:8192
  s_waitcnt lgkmcnt(0)
  s_sub_u32 s50, s17, 2
  s_mul_i32 s50, s50, 5120
  v_add_u32 v3, s50, v4
  s_waitcnt vmcnt(0)
  s_barrier
  s_cmp_lg_u32 s17, 0
  s_nop 0
  s_cbranch_scc1 rz_4400034
  s_mov_b64 s[62:63], exec
  s_mov_b64 exec, 1
  v_mov_b32 v36, 0
  v_mov_b32 v37, 1
  buffer_atomic_add v37, v36, s[12:15], 0 offen
rzp_4400035:
  buffer_load_dwordx4 v[40:43], v36, s[12:15], 0 offen sc1
  buffer_load_dword v44, v36, s[12:15], 0 offen offset:16 sc1
  s_add_u32 s19, s19, 1
  s_cmp_gt_u32 s19, 4194304
  s_cbranch_scc1 fz_fail
  s_waitcnt vmcnt(0)
  v_readfirstlane_b32 s50, v40
  v_readfirstlane_b32 s51, v44
  v_readfirstlane_b32 s52, v43
  s_cmp_lt_u32 s50, 64
  s_cbranch_scc1 rzp_4400035
  s_cmp_lt_u32 s51, 64
  s_cbranch_scc1 rzp_4400035
  s_cmp_lt_u32 s52, 1
  s_cbranch_scc1 rzp_4400035
  v_mov_b32 v39, v41
  v_mov_b32 v36, 45056
  ds_write_b32 v36, v39
  s_waitcnt lgkmcnt(0)
  s_mov_b64 exec, s[62:63]
rz_4400034:
  s_barrier
  v_mov_b32 v36, 45056
  ds_read_b32 v39, v36
  s_waitcnt lgkmcnt(0)
  v_readfirstlane_b32 s50, v39
  s_nop 0
  s_bcnt1_i32_b32 s50, s50
  s_cmp_eq_u32 s50, 1
  s_cselect_b32 s60, 1, 0
  s_lshl_b32 s50, s17, 9
  s_add_u32 s55, s55, s50
  s_mov_b32 s18, 0
  s_mov_b32 s47, 168833024
  s_mov_b32 s36, 140
  s_mov_b32 s38, 1
  v_mov_b64 v[28:29], 0
  v_mov_b64 v[30:31], 0
  v_mov_b64 v[32:33], 0
  v_mov_b64 v[34:35], 0
  s_barrier
helper_loop:
  ds_read_b128 v[72:75], v4 offset:0
  ds_read_b128 v[76:79], v4 offset:1024
  ds_read_b128 v[80:83], v4 offset:2048
  ds_read_b128 v[84:87], v4 offset:3072
  ds_read_b128 v[88:91], v4 offset:4096
  ds_read_b128 v[92:95], v4 offset:5120
  ds_read_b128 v[96:99], v4 offset:6144
  ds_read_b128 v[100:103], v4 offset:7168
  ds_read_b128 v[104:107], v4 offset:8192
  ds_read_b128 v[108:111], v4 offset:9216
  s_waitcnt lgkmcnt(9)
  v_smfmac_f32_16x16x64_bf16 v[28:31], v[72:75], a[0:7], v1
  v_smfmac_f32_16x16x64_bf16 v[32:35], v[72:75], a[8:15], v1
  s_waitcnt lgkmcnt(8)
  v_smfmac_f32_16x16x64_bf16 v[28:31], v[76:79], a[16:23], v1
  v_smfmac_f32_16x16x64_bf16 v[32:35], v[76:79], a[24:31], v1
  s_waitcnt lgkmcnt(7)
  v_smfmac_f32_16x16x64_bf16 v[28:31], v[80:83], a[32:39], v1
  v_smfmac_f32_16x16x64_bf16 v[32:35], v[80:83], a[40:47], v1
  s_waitcnt lgkmcnt(6)
  v_smfmac_f32_16x16x64_bf16 v[28:31], v[84:87], a[48:55], v1
  v_smfmac_f32_16x16x64_bf16 v[32:35], v[84:87], a[56:63], v1
  s_waitcnt lgkmcnt(5)
  v_smfmac_f32_16x16x64_bf16 v[28:31], v[88:91], a[64:71], v1
  v_smfmac_f32_16x16x64_bf16 v[32:35], v[88:91], a[72:79], v1
  s_waitcnt lgkmcnt(4)
  v_smfmac_f32_16x16x64_bf16 v[28:31], v[92:95], a[80:87], v1
  v_smfmac_f32_16x16x64_bf16 v[32:35], v[92:95], a[88:95], v1
  s_waitcnt lgkmcnt(3)
  v_smfmac_f32_16x16x64_bf16 v[28:31], v[96:99], a[96:103], v1
  v_smfmac_f32_16x16x64_bf16 v[32:35], v[96:99], a[104:111], v1
  s_waitcnt lgkmcnt(2)
  v_smfmac_f32_16x16x64_bf16 v[28:31], v[100:103], a[112:119], v1
  v_smfmac_f32_16x16x64_bf16 v[32:35], v[100:103], a[120:127], v1
  s_waitcnt lgkmcnt(1)
  v_smfmac_f32_16x16x64_bf16 v[28:31], v[104:107], a[128:135], v1
  v_smfmac_f32_16x16x64_bf16 v[32:35], v[104:107], a[136:143], v1
  s_waitcnt lgkmcnt(0)
  v_smfmac_f32_16x16x64_bf16 v[28:31], v[108:111], a[144:151], v1
  v_smfmac_f32_16x16x64_bf16 v[32:35], v[108:111], a[152:159], v1
  s_nop 6
  v_add_f32 v28, v28, v30
  v_add_f32 v29, v29, v31
  v_cvt_pk_bf16_f32 v44, v28, v29
  v_add_f32 v32, v32, v34
  v_add_f32 v33, v33, v35
  v_cvt_pk_bf16_f32 v45, v32, v33
  buffer_store_dwordx2 v[44:45], v9, s[4:7], s55 offen sc1
  s_or_b32 s52, s16, s17
  s_cmp_lg_u32 s52, 0
  s_cbranch_scc1 np_4400036
  s_add_u32 s52, s18, 1
  v_mov_b32 v46, s52
  v_mov_b32 v47, 0
  s_mov_b32 s52, 85094400
  s_mov_b64 exec, 1
  buffer_store_dword v46, v47, s[4:7], s52 offen sc1
  s_mov_b64 exec, -1
np_4400036:
  s_add_u32 s55, s55, 65536
  s_cmp_ge_u32 s18, 63
  s_cbranch_scc1 helper_done
  v_mov_b64 v[28:29], 0
  v_mov_b64 v[30:31], 0
  v_mov_b64 v[32:33], 0
  v_mov_b64 v[34:35], 0
  s_barrier
  s_cmp_lt_u32 s17, 2
  s_cbranch_scc1 hj_4400037
  s_sub_u32 s50, s17, 2
  s_mul_i32 s50, s50, 5120
  s_add_u32 s50, s50, s47
  s_add_u32 s51, s50, 4096
  s_cmp_gt_u32 s38, 1
  s_cselect_b32 s52, 13, 0
  s_add_u32 s36, s36, s52
  s_max_u32 s36, s36, 1
  s_sub_u32 s36, s36, 1
  s_min_u32 s36, s36, 600
  s_lshr_b32 s52, s36, 2
hsl_4400038:
  s_cmp_eq_u32 s52, 0
  s_cbranch_scc1 hse_4400039
  s_sleep 1
  s_sub_u32 s52, s52, 1
  s_branch hsl_4400038
hse_4400039:
  s_mov_b32 s37, s19
g5_4400040:
  buffer_load_dwordx4 v[72:75], v2, s[4:7], s50 offen offset:0 sc1
  buffer_load_dwordx4 v[76:79], v2, s[4:7], s50 offen offset:1024 sc1
  buffer_load_dwordx4 v[80:83], v2, s[4:7], s50 offen offset:2048 sc1
  buffer_load_dwordx4 v[84:87], v2, s[4:7], s50 offen offset:3072 sc1
  buffer_load_dwordx4 v[88:91], v2, s[4:7], s51 offen sc1
  s_add_u32 s19, s19, 1
  s_cmp_gt_u32 s19, 4194304
  s_cbranch_scc1 fz_fail
  s_waitcnt vmcnt(4)
  ds_write_b128 v3, v[72:75] offset:0
  v_max3_u32 v92, v72, v73, v74
  v_max_u32 v92, v92, v75
  s_waitcnt vmcnt(3)
  ds_write_b128 v3, v[76:79] offset:1024
  v_max3_u32 v92, v92, v76, v77
  v_max3_u32 v92, v92, v78, v79
  s_waitcnt vmcnt(2)
  ds_write_b128 v3, v[80:83] offset:2048
  v_max3_u32 v92, v92, v80, v81
  v_max3_u32 v92, v92, v82, v83
  s_waitcnt vmcnt(1)
  ds_write_b128 v3, v[84:87] offset:3072
  v_max3_u32 v92, v92, v84, v85
  v_max3_u32 v92, v92, v86, v87
  s_waitcnt vmcnt(0)
  ds_write_b128 v3, v[88:91] offset:4096
  v_max3_u32 v92, v92, v88, v89
  v_max3_u32 v92, v92, v90, v91
  v_cmp_eq_u32 vcc, -1, v92
  s_nop 0
  s_cbranch_vccnz g5_4400040
  s_sub_u32 s38, s19, s37
hj_4400037:
  s_waitcnt lgkmcnt(0)
  s_barrier
  s_add_u32 s18, s18, 1
  s_add_u32 s47, s47, 12288
  s_branch helper_loop
helper_done:
  s_branch fz_end
worker:
  v_mov_b32 v254, v0
  s_load_dwordx2 s[4:5], s[0:1], 104
  s_mov_b32 s6, 268435456
  s_mov_b32 s7, 0x00020000
  s_load_dwordx2 s[84:85], s[0:1], 96
  s_mov_b32 s86, 256
  s_mov_b32 s87, 0x00020000
  s_mov_b32 s63, 0
  s_waitcnt lgkmcnt(0)
  s_cmp_lg_u32 s60, 0
  s_cbranch_scc1 nz_4400041
  v_lshlrev_b32 v1, 4, v0
  v_mov_b64 v[4:5], 0
  v_mov_b64 v[6:7], 0
  s_mov_b32 s41, 85065728
  buffer_store_dwordx4 v[4:7], v1, s[4:7], s41 offen sc1
  s_mov_b32 s41, 85069824
  buffer_store_dwordx4 v[4:7], v1, s[4:7], s41 offen sc1
  s_mov_b32 s41, 85073920
  buffer_store_dwordx4 v[4:7], v1, s[4:7], s41 offen sc1
  s_mov_b32 s41, 85078016
  buffer_store_dwordx4 v[4:7], v1, s[4:7], s41 offen sc1
  s_mov_b32 s41, 85082112
  buffer_store_dwordx4 v[4:7], v1, s[4:7], s41 offen sc1
  s_mov_b32 s41, 85086208
  buffer_store_dwordx4 v[4:7], v1, s[4:7], s41 offen sc1
  s_mov_b32 s41, 85090304
  buffer_store_dwordx4 v[4:7], v1, s[4:7], s41 offen sc1
  s_mov_b32 s41, 85094400
  buffer_store_dwordx4 v[4:7], v1, s[4:7], s41 offen sc1
  s_waitcnt vmcnt(0)
  s_barrier
  v_cmp_eq_u32 vcc, 0, v254
  s_nop 0
  s_and_saveexec_b64 s[56:57], vcc
  s_cbranch_execz sig_4400042
  v_mov_b32 v250, 1
  v_mov_b32 v251, 0
  buffer_atomic_add v250, v251, s[84:87], 0 offen offset:12
sig_4400042:
  s_mov_b64 exec, s[56:57]
nz_4400041:
  s_cmp_ge_u32 s60, 128
  s_cbranch_scc1 nl_4400043
  s_mov_b32 s40, s60
  v_mov_b32 v0, v254
  s_load_dwordx2 s[8:9], s[0:1], 0
  s_mov_b32 s10, 2621440
  s_mov_b32 s11, 0x00020000
  v_lshrrev_b32 v1, 4, v0
  s_lshl_b32 s41, s40, 4
  v_add_u32 v1, s41, v1
  v_mul_u32_u24 v1, 1280, v1
  v_and_b32 v5, 15, v0
  v_lshlrev_b32 v5, 4, v5
  v_add_u32 v1, v1, v5
  s_waitcnt lgkmcnt(0)
  buffer_load_dwordx4 v[8:11], v1, s[8:11], 0 offen offset:0
  buffer_load_dwordx4 v[12:15], v1, s[8:11], 0 offen offset:256
  buffer_load_dwordx4 v[16:19], v1, s[8:11], 0 offen offset:512
  buffer_load_dwordx4 v[20:23], v1, s[8:11], 0 offen offset:768
  buffer_load_dwordx4 v[24:27], v1, s[8:11], 0 offen offset:1024
  s_waitcnt vmcnt(0)
  v_lshlrev_b32 v32, 16, v8
  v_and_b32 v33, 0xffff0000, v8
  v_lshlrev_b32 v34, 16, v9
  v_and_b32 v35, 0xffff0000, v9
  v_lshlrev_b32 v36, 16, v10
  v_and_b32 v37, 0xffff0000, v10
  v_lshlrev_b32 v38, 16, v11
  v_and_b32 v39, 0xffff0000, v11
  v_lshlrev_b32 v40, 16, v12
  v_and_b32 v41, 0xffff0000, v12
  v_lshlrev_b32 v42, 16, v13
  v_and_b32 v43, 0xffff0000, v13
  v_lshlrev_b32 v44, 16, v14
  v_and_b32 v45, 0xffff0000, v14
  v_lshlrev_b32 v46, 16, v15
  v_and_b32 v47, 0xffff0000, v15
  v_lshlrev_b32 v48, 16, v16
  v_and_b32 v49, 0xffff0000, v16
  v_lshlrev_b32 v50, 16, v17
  v_and_b32 v51, 0xffff0000, v17
  v_lshlrev_b32 v52, 16, v18
  v_and_b32 v53, 0xffff0000, v18
  v_lshlrev_b32 v54, 16, v19
  v_and_b32 v55, 0xffff0000, v19
  v_lshlrev_b32 v56, 16, v20
  v_and_b32 v57, 0xffff0000, v20
  v_lshlrev_b32 v58, 16, v21
  v_and_b32 v59, 0xffff0000, v21
  v_lshlrev_b32 v60, 16, v22
  v_and_b32 v61, 0xffff0000, v22
  v_lshlrev_b32 v62, 16, v23
  v_and_b32 v63, 0xffff0000, v23
  v_lshlrev_b32 v64, 16, v24
  v_and_b32 v65, 0xffff0000, v24
  v_lshlrev_b32 v66, 16, v25
  v_and_b32 v67, 0xffff0000, v25
  v_lshlrev_b32 v68, 16, v26
  v_and_b32 v69, 0xffff0000, v26
  v_lshlrev_b32 v70, 16, v27
  v_and_b32 v71, 0xffff0000, v27
  v_add_f32 v2, v32, v33
  v_add_f32 v2, v2, v34
  v_add_f32 v2, v2, v35
  v_add_f32 v2, v2, v36
  v_add_f32 v2, v2, v37
  v_add_f32 v2, v2, v38
  v_add_f32 v2, v2, v39
  v_add_f32 v2, v2, v40
  v_add_f32 v2, v2, v41
  v_add_f32 v2, v2, v42
  v_add_f32 v2, v2, v43
  v_add_f32 v2, v2, v44
  v_add_f32 v2, v2, v45
  v_add_f32 v2, v2, v46
  v_add_f32 v2, v2, v47
  v_add_f32 v2, v2, v48
  v_add_f32 v2, v2, v49
  v_add_f32 v2, v2, v50
  v_add_f32 v2, v2, v51
  v_add_f32 v2, v2, v52
  v_add_f32 v2, v2, v53
  v_add_f32 v2, v2, v54
  v_add_f32 v2, v2, v55
  v_add_f32 v2, v2, v56
  v_add_f32 v2, v2, v57
  v_add_f32 v2, v2, v58
  v_add_f32 v2, v2, v59
  v_add_f32 v2, v2, v60
  v_add_f32 v2, v2, v61
  v_add_f32 v2, v2, v62
  v_add_f32 v2, v2, v63
  v_add_f32 v2, v2, v64
  v_add_f32 v2, v2, v65
  v_add_f32 v2, v2, v66
  v_add_f32 v2, v2, v67
  v_add_f32 v2, v2, v68
  v_add_f32 v2, v2, v69
  v_add_f32 v2, v2, v70
  v_add_f32 v2, v2, v71
  s_nop 1
  v_add_f32_dpp v2, v2, v2 row_ror:8 row_mask:0xf bank_mask:0xf
  s_nop 1
  v_add_f32_dpp v2, v2, v2 row_ror:4 row_mask:0xf bank_mask:0xf
  s_nop 1
  v_add_f32_dpp v2, v2, v2 row_ror:2 row_mask:0xf bank_mask:0xf
  s_nop 1
  v_add_f32_dpp v2, v2, v2 row_ror:1 row_mask:0xf bank_mask:0xf
  v_mul_f32 v2, 0x3acccccd, v2
  v_sub_f32 v32, v32, v2
  v_sub_f32 v33, v33, v2
  v_sub_f32 v34, v34, v2
  v_sub_f32 v35, v35, v2
  v_sub_f32 v36, v36, v2
  v_sub_f32 v37, v37, v2
  v_sub_f32 v38, v38, v2
  v_sub_f32 v39, v39, v2
  v_sub_f32 v40, v40, v2
  v_sub_f32 v41, v41, v2
  v_sub_f32 v42, v42, v2
  v_sub_f32 v43, v43, v2
  v_sub_f32 v44, v44, v2
  v_sub_f32 v45, v45, v2
  v_sub_f32 v46, v46, v2
  v_sub_f32 v47, v47, v2
  v_sub_f32 v48, v48, v2
  v_sub_f32 v49, v49, v2
  v_sub_f32 v50, v50, v2
  v_sub_f32 v51, v51, v2
  v_sub_f32 v52, v52, v2
  v_sub_f32 v53, v53, v2
  v_sub_f32 v54, v54, v2
  v_sub_f32 v55, v55, v2
  v_sub_f32 v56, v56, v2
  v_sub_f32 v57, v57, v2
  v_sub_f32 v58, v58, v2
  v_sub_f32 v59, v59, v2
  v_sub_f32 v60, v60, v2
  v_sub_f32 v61, v61, v2
  v_sub_f32 v62, v62, v2
  v_sub_f32 v63, v63, v2
  v_sub_f32 v64, v64, v2
  v_sub_f32 v65, v65, v2
  v_sub_f32 v66, v66, v2
  v_sub_f32 v67, v67, v2
  v_sub_f32 v68, v68, v2
  v_sub_f32 v69, v69, v2
  v_sub_f32 v70, v70, v2
  v_sub_f32 v71, v71, v2
  v_mul_f32 v3, v32, v32
  v_fmac_f32 v3, v33, v33
  v_fmac_f32 v3, v34, v34
  v_fmac_f32 v3, v35, v35
  v_fmac_f32 v3, v36, v36
  v_fmac_f32 v3, v37, v37
  v_fmac_f32 v3, v38, v38
  v_fmac_f32 v3, v39, v39
  v_fmac_f32 v3, v40, v40
  v_fmac_f32 v3, v41, v41
  v_fmac_f32 v3, v42, v42
  v_fmac_f32 v3, v43, v43
  v_fmac_f32 v3, v44, v44
  v_fmac_f32 v3, v45, v45
  v_fmac_f32 v3, v46, v46
  v_fmac_f32 v3, v47, v47
  v_fmac_f32 v3, v48, v48
  v_fmac_f32 v3, v49, v49
  v_fmac_f32 v3, v50, v50
  v_fmac_f32 v3, v51, v51
  v_fmac_f32 v3, v52, v52
  v_fmac_f32 v3, v53, v53
  v_fmac_f32 v3, v54, v54
  v_fmac_f32 v3, v55, v55
  v_fmac_f32 v3, v56, v56
  v_fmac_f32 v3, v57, v57
  v_fmac_f32 v3, v58, v58
  v_fmac_f32 v3, v59, v59
  v_fmac_f32 v3, v60, v60
  v_fmac_f32 v3, v61, v61
  v_fmac_f32 v3, v62, v62
  v_fmac_f32 v3, v63, v63
  v_fmac_f32 v3, v64, v64
  v_fmac_f32 v3, v65, v65
  v_fmac_f32 v3, v66, v66
  v_fmac_f32 v3, v67, v67
  v_fmac_f32 v3, v68, v68
  v_fmac_f32 v3, v69, v69
  v_fmac_f32 v3, v70, v70
  v_fmac_f32 v3, v71, v71
  s_nop 1
  v_add_f32_dpp v3, v3, v3 row_ror:8 row_mask:0xf bank_mask:0xf
  s_nop 1
  v_add_f32_dpp v3, v3, v3 row_ror:4 row_mask:0xf bank_mask:0xf
  s_nop 1
  v_add_f32_dpp v3, v3, v3 row_ror:2 row_mask:0xf bank_mask:0xf
  s_nop 1
  v_add_f32_dpp v3, v3, v3 row_ror:1 row_mask:0xf bank_mask:0xf
  v_mov_b32 v4, 0x3727c5ac
  v_mul_f32 v3, 0x3acccccd, v3
  v_add_f32 v3, v3, v4
  v_rsq_f32 v3, v3
  s_nop 0
  v_mul_f32 v32, v32, v3
  v_mul_f32 v33, v33, v3
  v_mul_f32 v34, v34, v3
  v_mul_f32 v35, v35, v3
  v_mul_f32 v36, v36, v3
  v_mul_f32 v37, v37, v3
  v_mul_f32 v38, v38, v3
  v_mul_f32 v39, v39, v3
  v_mul_f32 v40, v40, v3
  v_mul_f32 v41, v41, v3
  v_mul_f32 v42, v42, v3
  v_mul_f32 v43, v43, v3
  v_mul_f32 v44, v44, v3
  v_mul_f32 v45, v45, v3
  v_mul_f32 v46, v46, v3
  v_mul_f32 v47, v47, v3
  v_mul_f32 v48, v48, v3
  v_mul_f32 v49, v49, v3
  v_mul_f32 v50, v50, v3
  v_mul_f32 v51, v51, v3
  v_mul_f32 v52, v52, v3
  v_mul_f32 v53, v53, v3
  v_mul_f32 v54, v54, v3
  v_mul_f32 v55, v55, v3
  v_mul_f32 v56, v56, v3
  v_mul_f32 v57, v57, v3
  v_mul_f32 v58, v58, v3
  v_mul_f32 v59, v59, v3
  v_mul_f32 v60, v60, v3
  v_mul_f32 v61, v61, v3
  v_mul_f32 v62, v62, v3
  v_mul_f32 v63, v63, v3
  v_mul_f32 v64, v64, v3
  v_mul_f32 v65, v65, v3
  v_mul_f32 v66, v66, v3
  v_mul_f32 v67, v67, v3
  v_mul_f32 v68, v68, v3
  v_mul_f32 v69, v69, v3
  v_mul_f32 v70, v70, v3
  v_mul_f32 v71, v71, v3
  v_cvt_pk_bf16_f32 v8, v32, v33
  v_cvt_pk_bf16_f32 v9, v34, v35
  v_cvt_pk_bf16_f32 v10, v36, v37
  v_cvt_pk_bf16_f32 v11, v38, v39
  v_cvt_pk_bf16_f32 v12, v40, v41
  v_cvt_pk_bf16_f32 v13, v42, v43
  v_cvt_pk_bf16_f32 v14, v44, v45
  v_cvt_pk_bf16_f32 v15, v46, v47
  v_cvt_pk_bf16_f32 v16, v48, v49
  v_cvt_pk_bf16_f32 v17, v50, v51
  v_cvt_pk_bf16_f32 v18, v52, v53
  v_cvt_pk_bf16_f32 v19, v54, v55
  v_cvt_pk_bf16_f32 v20, v56, v57
  v_cvt_pk_bf16_f32 v21, v58, v59
  v_cvt_pk_bf16_f32 v22, v60, v61
  v_cvt_pk_bf16_f32 v23, v62, v63
  v_cvt_pk_bf16_f32 v24, v64, v65
  v_cvt_pk_bf16_f32 v25, v66, v67
  v_cvt_pk_bf16_f32 v26, v68, v69
  v_cvt_pk_bf16_f32 v27, v70, v71
  s_mov_b32 s41, 0
  buffer_store_dwordx4 v[8:11], v1, s[4:7], s41 offen offset:0 sc1
  buffer_store_dwordx4 v[12:15], v1, s[4:7], s41 offen offset:256 sc1
  buffer_store_dwordx4 v[16:19], v1, s[4:7], s41 offen offset:512 sc1
  buffer_store_dwordx4 v[20:23], v1, s[4:7], s41 offen offset:768 sc1
  buffer_store_dwordx4 v[24:27], v1, s[4:7], s41 offen offset:1024 sc1
  s_waitcnt vmcnt(0)
  s_barrier
  v_cmp_eq_u32 vcc, 0, v254
  s_nop 0
  s_and_saveexec_b64 s[56:57], vcc
  s_cbranch_execz l1s_4400045
  s_lshr_b32 s41, s60, 3
  s_lshl_b32 s41, s41, 2
  s_add_u32 s41, s41, 128
  v_mov_b32 v250, 1
  v_mov_b32 v251, 0
  buffer_atomic_add v250, v251, s[84:87], s41 offen
l1s_4400045:
  s_mov_b64 exec, s[56:57]
  s_nop 0
  s_branch nf_4400044
nl_4400043:
  v_lshlrev_b32 v1, 4, v254
  v_mov_b64 v[4:5], -1
  v_mov_b64 v[6:7], -1
  s_sub_u32 s40, s60, 128
fl_4400046:
  s_cmp_ge_u32 s40, 192
  s_cbranch_scc1 fd_4400047
  s_lshl_b32 s41, s40, 12
  s_add_u32 s41, s41, 83886080
  buffer_store_dwordx4 v[4:7], v1, s[4:7], s41 offen sc1
  s_add_u32 s40, s40, 64
  s_branch fl_4400046
fd_4400047:
  s_sub_u32 s40, s60, 128
fl_4400048:
  s_cmp_ge_u32 s40, 6
  s_cbranch_scc1 fd_4400049
  s_lshl_b32 s41, s40, 12
  s_add_u32 s41, s41, 167772160
  buffer_store_dwordx4 v[4:7], v1, s[4:7], s41 offen sc1
  s_add_u32 s40, s40, 64
  s_branch fl_4400048
fd_4400049:
  s_sub_u32 s40, s60, 128
fl_4400050:
  s_cmp_ge_u32 s40, 192
  s_cbranch_scc1 fd_4400051
  s_lshl_b32 s41, s40, 12
  s_add_u32 s41, s41, 168820736
  buffer_store_dwordx4 v[4:7], v1, s[4:7], s41 offen sc1
  s_add_u32 s40, s40, 64
  s_branch fl_4400050
fd_4400051:
  s_sub_u32 s40, s60, 128
fl_4400052:
  s_cmp_ge_u32 s40, 1024
  s_cbranch_scc1 fd_4400053
  s_lshl_b32 s41, s40, 12
  s_add_u32 s41, s41, 79691776
  buffer_store_dwordx4 v[4:7], v1, s[4:7], s41 offen sc1
  s_add_u32 s40, s40, 64
  s_branch fl_4400052
fd_4400053:
  s_sub_u32 s40, s60, 128
fl_4400054:
  s_cmp_ge_u32 s40, 2048
  s_nop 0
  s_cbranch_scc1 fd_4400055
  s_lshl_b32 s41, s40, 12
  s_add_u32 s41, s41, 71303168
  buffer_store_dwordx4 v[4:7], v1, s[4:7], s41 offen sc1
  s_add_u32 s40, s40, 64
  s_branch fl_4400054
fd_4400055:
  s_waitcnt vmcnt(0)
  s_barrier
  v_cmp_eq_u32 vcc, 0, v254
  s_nop 0
  s_and_saveexec_b64 s[56:57], vcc
  s_nop 0
  s_cbranch_execz sig_4400056
  v_mov_b32 v250, 1
  v_mov_b32 v251, 0
  buffer_atomic_add v250, v251, s[84:87], 0 offen offset:16
sig_4400056:
  s_mov_b64 exec, s[56:57]
nf_4400044:
  v_mov_b32 v251, 0
l1w_4400057:
  buffer_load_dword v248, v251, s[84:87], 0 offen offset:12 sc1
  s_waitcnt vmcnt(0)
  v_readfirstlane_b32 s57, v248
  s_nop 0
  s_cmp_ge_u32 s57, 1
  s_nop 0
  s_cbranch_scc1 l1ok_4400058
  s_add_u32 s63, s63, 1
  s_cmp_gt_u32 s63, 4194304
  s_cbranch_scc1 fz_fail
  s_sleep 4
  s_branch l1w_4400057
l1ok_4400058:
  s_cmp_ge_u32 s60, 96
  s_cselect_b32 s40, 1, 0
  s_cselect_b32 s41, 96, 0
  s_sub_u32 s41, s60, s41
  s_and_b32 s43, s41, 31
  s_lshr_b32 s44, s41, 5
  s_cmp_eq_u32 s44, 1
  s_nop 0
  s_cbranch_scc1 qv_4400059
  s_cmp_eq_u32 s44, 2
  s_nop 0
  s_cbranch_scc1 qq_4400060
  s_load_dwordx2 s[8:9], s[0:1], 24
  s_mov_b32 s10, 5242880
  s_mov_b32 s11, 0x00020000
  v_mov_b32 v0, v254
  v_lshrrev_b32 v22, 6, v0
  s_nop 0
  v_readfirstlane_b32 s24, v22
  v_and_b32 v0, 63, v0
  s_lshr_b32 s25, s24, 1
  s_and_b32 s26, s24, 1
  v_lshrrev_b32 v22, 3, v0
  s_mov_b32 s30, 1280
  v_mul_lo_u32 v22, v22, s30
  v_and_b32 v23, 7, v0
  v_lshrrev_b32 v24, 4, v0
  v_xor_b32 v23, v23, v24
  v_lshlrev_b32 v24, 4, v23
  v_add_u32 v1, v22, v24
  v_xor_b32 v23, 4, v23
  v_lshlrev_b32 v24, 4, v23
  v_add_u32 v2, v22, v24
  v_lshrrev_b32 v22, 4, v0
  s_mov_b32 s30, 8192
  v_mul_lo_u32 v23, v22, s30
  v_bfe_u32 v24, v0, 2, 2
  v_xor_b32 v24, v24, v22
  v_lshlrev_b32 v24, 6, v24
  v_add_u32 v23, v23, v24
  v_and_b32 v24, 3, v0
  v_lshlrev_b32 v24, 4, v24
  v_add_u32 v3, v23, v24
  v_and_b32 v22, 31, v0
  s_lshl_b32 s30, s25, 6
  v_add_u32 v23, s30, v22
  v_lshlrev_b32 v23, 7, v23
  v_bfe_u32 v24, v0, 1, 3
  v_lshrrev_b32 v25, 5, v0
  v_add_u32 v26, 0, v25
  v_xor_b32 v26, v26, v24
  v_lshlrev_b32 v26, 4, v26
  v_add_u32 v4, v23, v26
  v_add_u32 v8, 65536, v4
  v_add_u32 v26, 2, v25
  v_xor_b32 v26, v26, v24
  v_lshlrev_b32 v26, 4, v26
  v_add_u32 v5, v23, v26
  v_add_u32 v9, 65536, v5
  v_add_u32 v26, 4, v25
  v_xor_b32 v26, v26, v24
  v_lshlrev_b32 v26, 4, v26
  v_add_u32 v6, v23, v26
  v_add_u32 v10, 65536, v6
  v_add_u32 v26, 6, v25
  v_xor_b32 v26, v26, v24
  v_lshlrev_b32 v26, 4, v26
  v_add_u32 v7, v23, v26
  v_add_u32 v11, 65536, v7
  v_lshrrev_b32 v22, 5, v0
  v_lshlrev_b32 v22, 3, v22
  v_bfe_u32 v23, v0, 2, 2
  v_add_u32 v22, v22, v23
  v_lshlrev_b32 v22, 8, v22
  v_bfe_u32 v24, v0, 4, 1
  v_lshlrev_b32 v24, 5, v24
  v_add_u32 v22, v22, v24
  v_and_b32 v24, 3, v0
  v_lshlrev_b32 v24, 3, v24
  v_add_u32 v22, v22, v24
  s_lshl_b32 s30, s26, 1
  s_add_u32 s31, s30, 0
  v_xor_b32 v24, s31, v23
  v_lshlrev_b32 v24, 6, v24
  v_add_u32 v24, v22, v24
  v_add_u32 v16, 131072, v24
  s_add_u32 s31, s30, 1
  v_xor_b32 v24, s31, v23
  v_lshlrev_b32 v24, 6, v24
  v_add_u32 v24, v22, v24
  v_add_u32 v17, 131072, v24
  s_lshl_b32 s35, s24, 12
  s_lshl_b32 s36, s24, 12
  s_add_u32 s36, s36, 131072
  s_lshl_b32 s28, s43, 8
  s_lshl_b32 s31, s24, 17
  s_add_u32 s28, s28, s31
  s_waitcnt lgkmcnt(0)
  s_barrier
  s_add_u32 s30, s28, 0
  s_sub_u32 m0, s36, 131072
  s_nop 0
  buffer_load_dwordx4 v3, s[8:11], s30 offen lds
  s_add_u32 s30, s28, 32768
  s_sub_u32 m0, s36, 130048
  s_nop 0
  buffer_load_dwordx4 v3, s[8:11], s30 offen lds
  s_add_u32 s30, s28, 65536
  s_sub_u32 m0, s36, 129024
  s_nop 0
  buffer_load_dwordx4 v3, s[8:11], s30 offen lds
  s_add_u32 s30, s28, 98304
  s_sub_u32 m0, s36, 128000
  s_nop 0
  buffer_load_dwordx4 v3, s[8:11], s30 offen lds
  s_add_u32 s30, s28, 524288
  s_sub_u32 m0, s36, 114688
  s_nop 0
  buffer_load_dwordx4 v3, s[8:11], s30 offen lds
  s_add_u32 s30, s28, 557056
  s_sub_u32 m0, s36, 113664
  s_nop 0
  buffer_load_dwordx4 v3, s[8:11], s30 offen lds
  s_add_u32 s30, s28, 589824
  s_sub_u32 m0, s36, 112640
  s_nop 0
  buffer_load_dwordx4 v3, s[8:11], s30 offen lds
  s_add_u32 s30, s28, 622592
  s_sub_u32 m0, s36, 111616
  s_nop 0
  buffer_load_dwordx4 v3, s[8:11], s30 offen lds
  s_add_u32 s30, s28, 1048576
  s_sub_u32 m0, s36, 98304
  s_nop 0
  buffer_load_dwordx4 v3, s[8:11], s30 offen lds
  s_add_u32 s30, s28, 1081344
  s_sub_u32 m0, s36, 97280
  s_nop 0
  buffer_load_dwordx4 v3, s[8:11], s30 offen lds
  s_add_u32 s30, s28, 1114112
  s_sub_u32 m0, s36, 96256
  s_nop 0
  buffer_load_dwordx4 v3, s[8:11], s30 offen lds
  s_add_u32 s30, s28, 1146880
  s_sub_u32 m0, s36, 95232
  s_nop 0
  buffer_load_dwordx4 v3, s[8:11], s30 offen lds
  s_add_u32 s30, s28, 1572864
  s_sub_u32 m0, s36, 81920
  s_nop 0
  buffer_load_dwordx4 v3, s[8:11], s30 offen lds
  s_add_u32 s30, s28, 1605632
  s_sub_u32 m0, s36, 80896
  s_nop 0
  buffer_load_dwordx4 v3, s[8:11], s30 offen lds
  s_add_u32 s30, s28, 1638400
  s_sub_u32 m0, s36, 79872
  s_nop 0
  buffer_load_dwordx4 v3, s[8:11], s30 offen lds
  s_add_u32 s30, s28, 1671168
  s_sub_u32 m0, s36, 78848
  s_nop 0
  buffer_load_dwordx4 v3, s[8:11], s30 offen lds
  s_add_u32 s30, s28, 2097152
  s_sub_u32 m0, s36, 65536
  s_nop 0
  buffer_load_dwordx4 v3, s[8:11], s30 offen lds
  s_add_u32 s30, s28, 2129920
  s_sub_u32 m0, s36, 64512
  s_nop 0
  buffer_load_dwordx4 v3, s[8:11], s30 offen lds
  s_add_u32 s30, s28, 2162688
  s_sub_u32 m0, s36, 63488
  s_nop 0
  buffer_load_dwordx4 v3, s[8:11], s30 offen lds
  s_add_u32 s30, s28, 2195456
  s_sub_u32 m0, s36, 62464
  s_nop 0
  buffer_load_dwordx4 v3, s[8:11], s30 offen lds
  s_add_u32 s30, s28, 2621440
  s_sub_u32 m0, s36, 49152
  s_nop 0
  buffer_load_dwordx4 v3, s[8:11], s30 offen lds
  s_add_u32 s30, s28, 2654208
  s_sub_u32 m0, s36, 48128
  s_nop 0
  buffer_load_dwordx4 v3, s[8:11], s30 offen lds
  s_add_u32 s30, s28, 2686976
  s_sub_u32 m0, s36, 47104
  s_nop 0
  buffer_load_dwordx4 v3, s[8:11], s30 offen lds
  s_add_u32 s30, s28, 2719744
  s_sub_u32 m0, s36, 46080
  s_nop 0
  buffer_load_dwordx4 v3, s[8:11], s30 offen lds
  s_add_u32 s30, s28, 3145728
  s_sub_u32 m0, s36, 32768
  s_nop 0
  buffer_load_dwordx4 v3, s[8:11], s30 offen lds
  s_add_u32 s30, s28, 3178496
  s_sub_u32 m0, s36, 31744
  s_nop 0
  buffer_load_dwordx4 v3, s[8:11], s30 offen lds
  s_add_u32 s30, s28, 3211264
  s_sub_u32 m0, s36, 30720
  s_nop 0
  buffer_load_dwordx4 v3, s[8:11], s30 offen lds
  s_add_u32 s30, s28, 3244032
  s_sub_u32 m0, s36, 29696
  s_nop 0
  buffer_load_dwordx4 v3, s[8:11], s30 offen lds
  s_add_u32 s30, s28, 3670016
  s_sub_u32 m0, s36, 16384
  s_nop 0
  buffer_load_dwordx4 v3, s[8:11], s30 offen lds
  s_add_u32 s30, s28, 3702784
  s_sub_u32 m0, s36, 15360
  s_nop 0
  buffer_load_dwordx4 v3, s[8:11], s30 offen lds
  s_add_u32 s30, s28, 3735552
  s_sub_u32 m0, s36, 14336
  s_nop 0
  buffer_load_dwordx4 v3, s[8:11], s30 offen lds
  s_add_u32 s30, s28, 3768320
  s_sub_u32 m0, s36, 13312
  s_nop 0
  buffer_load_dwordx4 v3, s[8:11], s30 offen lds
  s_add_u32 s30, s28, 4194304
  s_add_u32 m0, s36, 0
  s_nop 0
  buffer_load_dwordx4 v3, s[8:11], s30 offen lds
  s_add_u32 s30, s28, 4227072
  s_add_u32 m0, s36, 1024
  s_nop 0
  buffer_load_dwordx4 v3, s[8:11], s30 offen lds
  s_add_u32 s30, s28, 4259840
  s_add_u32 m0, s36, 2048
  s_nop 0
  buffer_load_dwordx4 v3, s[8:11], s30 offen lds
  s_add_u32 s30, s28, 4292608
  s_add_u32 m0, s36, 3072
  s_nop 0
  buffer_load_dwordx4 v3, s[8:11], s30 offen lds
  s_add_u32 s30, s28, 4718592
  s_add_u32 m0, s36, 16384
  s_nop 0
  buffer_load_dwordx4 v3, s[8:11], s30 offen lds
  s_add_u32 s30, s28, 4751360
  s_add_u32 m0, s36, 17408
  s_nop 0
  buffer_load_dwordx4 v3, s[8:11], s30 offen lds
  s_add_u32 s30, s28, 4784128
  s_add_u32 m0, s36, 18432
  s_nop 0
  buffer_load_dwordx4 v3, s[8:11], s30 offen lds
  s_add_u32 s30, s28, 4816896
  s_add_u32 m0, s36, 19456
  s_nop 0
  buffer_load_dwordx4 v3, s[8:11], s30 offen lds
  s_waitcnt vmcnt(36)
  s_barrier
  v_subrev_u32 v22, 131072, v16
  v_subrev_u32 v23, 131072, v17
  ds_read_b64_tr_b16 a[0:1], v22 offset:0
  ds_read_b64_tr_b16 a[2:3], v22 offset:1024
  ds_read_b64_tr_b16 a[4:5], v23 offset:0
  ds_read_b64_tr_b16 a[6:7], v23 offset:1024
  ds_read_b64_tr_b16 a[8:9], v22 offset:4096
  ds_read_b64_tr_b16 a[10:11], v22 offset:5120
  ds_read_b64_tr_b16 a[12:13], v23 offset:4096
  ds_read_b64_tr_b16 a[14:15], v23 offset:5120
  ds_read_b64_tr_b16 a[16:17], v22 offset:8192
  ds_read_b64_tr_b16 a[18:19], v22 offset:9216
  ds_read_b64_tr_b16 a[20:21], v23 offset:8192
  ds_read_b64_tr_b16 a[22:23], v23 offset:9216
  ds_read_b64_tr_b16 a[24:25], v22 offset:12288
  ds_read_b64_tr_b16 a[26:27], v22 offset:13312
  ds_read_b64_tr_b16 a[28:29], v23 offset:12288
  ds_read_b64_tr_b16 a[30:31], v23 offset:13312
  s_waitcnt vmcnt(32)
  s_barrier
  v_subrev_u32 v22, 114688, v16
  v_subrev_u32 v23, 114688, v17
  ds_read_b64_tr_b16 a[32:33], v22 offset:0
  ds_read_b64_tr_b16 a[34:35], v22 offset:1024
  ds_read_b64_tr_b16 a[36:37], v23 offset:0
  ds_read_b64_tr_b16 a[38:39], v23 offset:1024
  ds_read_b64_tr_b16 a[40:41], v22 offset:4096
  ds_read_b64_tr_b16 a[42:43], v22 offset:5120
  ds_read_b64_tr_b16 a[44:45], v23 offset:4096
  ds_read_b64_tr_b16 a[46:47], v23 offset:5120
  ds_read_b64_tr_b16 a[48:49], v22 offset:8192
  ds_read_b64_tr_b16 a[50:51], v22 offset:9216
  ds_read_b64_tr_b16 a[52:53], v23 offset:8192
  ds_read_b64_tr_b16 a[54:55], v23 offset:9216
  ds_read_b64_tr_b16 a[56:57], v22 offset:12288
  ds_read_b64_tr_b16 a[58:59], v22 offset:13312
  ds_read_b64_tr_b16 a[60:61], v23 offset:12288
  ds_read_b64_tr_b16 a[62:63], v23 offset:13312
  s_waitcnt vmcnt(28)
  s_barrier
  v_subrev_u32 v22, 98304, v16
  v_subrev_u32 v23, 98304, v17
  ds_read_b64_tr_b16 a[64:65], v22 offset:0
  ds_read_b64_tr_b16 a[66:67], v22 offset:1024
  ds_read_b64_tr_b16 a[68:69], v23 offset:0
  ds_read_b64_tr_b16 a[70:71], v23 offset:1024
  ds_read_b64_tr_b16 a[72:73], v22 offset:4096
  ds_read_b64_tr_b16 a[74:75], v22 offset:5120
  ds_read_b64_tr_b16 a[76:77], v23 offset:4096
  ds_read_b64_tr_b16 a[78:79], v23 offset:5120
  ds_read_b64_tr_b16 a[80:81], v22 offset:8192
  ds_read_b64_tr_b16 a[82:83], v22 offset:9216
  ds_read_b64_tr_b16 a[84:85], v23 offset:8192
  ds_read_b64_tr_b16 a[86:87], v23 offset:9216
  ds_read_b64_tr_b16 a[88:89], v22 offset:12288
  ds_read_b64_tr_b16 a[90:91], v22 offset:13312
  ds_read_b64_tr_b16 a[92:93], v23 offset:12288
  ds_read_b64_tr_b16 a[94:95], v23 offset:13312
  s_waitcnt vmcnt(24)
  s_barrier
  v_subrev_u32 v22, 81920, v16
  v_subrev_u32 v23, 81920, v17
  ds_read_b64_tr_b16 a[96:97], v22 offset:0
  ds_read_b64_tr_b16 a[98:99], v22 offset:1024
  ds_read_b64_tr_b16 a[100:101], v23 offset:0
  ds_read_b64_tr_b16 a[102:103], v23 offset:1024
  ds_read_b64_tr_b16 a[104:105], v22 offset:4096
  ds_read_b64_tr_b16 a[106:107], v22 offset:5120
  ds_read_b64_tr_b16 a[108:109], v23 offset:4096
  ds_read_b64_tr_b16 a[110:111], v23 offset:5120
  ds_read_b64_tr_b16 a[112:113], v22 offset:8192
  ds_read_b64_tr_b16 a[114:115], v22 offset:9216
  ds_read_b64_tr_b16 a[116:117], v23 offset:8192
  ds_read_b64_tr_b16 a[118:119], v23 offset:9216
  ds_read_b64_tr_b16 a[120:121], v22 offset:12288
  ds_read_b64_tr_b16 a[122:123], v22 offset:13312
  ds_read_b64_tr_b16 a[124:125], v23 offset:12288
  ds_read_b64_tr_b16 a[126:127], v23 offset:13312
  s_waitcnt vmcnt(20)
  s_barrier
  v_subrev_u32 v22, 65536, v16
  v_subrev_u32 v23, 65536, v17
  ds_read_b64_tr_b16 a[128:129], v22 offset:0
  ds_read_b64_tr_b16 a[130:131], v22 offset:1024
  ds_read_b64_tr_b16 a[132:133], v23 offset:0
  ds_read_b64_tr_b16 a[134:135], v23 offset:1024
  ds_read_b64_tr_b16 a[136:137], v22 offset:4096
  ds_read_b64_tr_b16 a[138:139], v22 offset:5120
  ds_read_b64_tr_b16 a[140:141], v23 offset:4096
  ds_read_b64_tr_b16 a[142:143], v23 offset:5120
  ds_read_b64_tr_b16 a[144:145], v22 offset:8192
  ds_read_b64_tr_b16 a[146:147], v22 offset:9216
  ds_read_b64_tr_b16 a[148:149], v23 offset:8192
  ds_read_b64_tr_b16 a[150:151], v23 offset:9216
  ds_read_b64_tr_b16 a[152:153], v22 offset:12288
  ds_read_b64_tr_b16 a[154:155], v22 offset:13312
  ds_read_b64_tr_b16 a[156:157], v23 offset:12288
  ds_read_b64_tr_b16 a[158:159], v23 offset:13312
  s_waitcnt vmcnt(16)
  s_barrier
  v_subrev_u32 v22, 49152, v16
  v_subrev_u32 v23, 49152, v17
  ds_read_b64_tr_b16 a[160:161], v22 offset:0
  ds_read_b64_tr_b16 a[162:163], v22 offset:1024
  ds_read_b64_tr_b16 a[164:165], v23 offset:0
  ds_read_b64_tr_b16 a[166:167], v23 offset:1024
  ds_read_b64_tr_b16 a[168:169], v22 offset:4096
  ds_read_b64_tr_b16 a[170:171], v22 offset:5120
  ds_read_b64_tr_b16 a[172:173], v23 offset:4096
  ds_read_b64_tr_b16 a[174:175], v23 offset:5120
  ds_read_b64_tr_b16 a[176:177], v22 offset:8192
  ds_read_b64_tr_b16 a[178:179], v22 offset:9216
  ds_read_b64_tr_b16 a[180:181], v23 offset:8192
  ds_read_b64_tr_b16 a[182:183], v23 offset:9216
  ds_read_b64_tr_b16 a[184:185], v22 offset:12288
  ds_read_b64_tr_b16 a[186:187], v22 offset:13312
  ds_read_b64_tr_b16 a[188:189], v23 offset:12288
  ds_read_b64_tr_b16 a[190:191], v23 offset:13312
  s_waitcnt vmcnt(12)
  s_barrier
  v_subrev_u32 v22, 32768, v16
  v_subrev_u32 v23, 32768, v17
  ds_read_b64_tr_b16 a[192:193], v22 offset:0
  ds_read_b64_tr_b16 a[194:195], v22 offset:1024
  ds_read_b64_tr_b16 a[196:197], v23 offset:0
  ds_read_b64_tr_b16 a[198:199], v23 offset:1024
  ds_read_b64_tr_b16 a[200:201], v22 offset:4096
  ds_read_b64_tr_b16 a[202:203], v22 offset:5120
  ds_read_b64_tr_b16 a[204:205], v23 offset:4096
  ds_read_b64_tr_b16 a[206:207], v23 offset:5120
  ds_read_b64_tr_b16 a[208:209], v22 offset:8192
  ds_read_b64_tr_b16 a[210:211], v22 offset:9216
  ds_read_b64_tr_b16 a[212:213], v23 offset:8192
  ds_read_b64_tr_b16 a[214:215], v23 offset:9216
  ds_read_b64_tr_b16 a[216:217], v22 offset:12288
  ds_read_b64_tr_b16 a[218:219], v22 offset:13312
  ds_read_b64_tr_b16 a[220:221], v23 offset:12288
  ds_read_b64_tr_b16 a[222:223], v23 offset:13312
  s_waitcnt vmcnt(8)
  s_barrier
  v_subrev_u32 v22, 16384, v16
  v_subrev_u32 v23, 16384, v17
  ds_read_b64_tr_b16 a[224:225], v22 offset:0
  ds_read_b64_tr_b16 a[226:227], v22 offset:1024
  ds_read_b64_tr_b16 a[228:229], v23 offset:0
  ds_read_b64_tr_b16 a[230:231], v23 offset:1024
  ds_read_b64_tr_b16 a[232:233], v22 offset:4096
  ds_read_b64_tr_b16 a[234:235], v22 offset:5120
  ds_read_b64_tr_b16 a[236:237], v23 offset:4096
  ds_read_b64_tr_b16 a[238:239], v23 offset:5120
  ds_read_b64_tr_b16 a[240:241], v22 offset:8192
  ds_read_b64_tr_b16 a[242:243], v22 offset:9216
  ds_read_b64_tr_b16 a[244:245], v23 offset:8192
  ds_read_b64_tr_b16 a[246:247], v23 offset:9216
  ds_read_b64_tr_b16 a[248:249], v22 offset:12288
  ds_read_b64_tr_b16 a[250:251], v22 offset:13312
  ds_read_b64_tr_b16 a[252:253], v23 offset:12288
  ds_read_b64_tr_b16 a[254:255], v23 offset:13312
  s_waitcnt vmcnt(4)
  s_barrier
  v_add_u32 v22, 0, v16
  v_add_u32 v23, 0, v17
  ds_read_b64_tr_b16 v[128:129], v22 offset:0
  ds_read_b64_tr_b16 v[130:131], v22 offset:1024
  ds_read_b64_tr_b16 v[132:133], v23 offset:0
  ds_read_b64_tr_b16 v[134:135], v23 offset:1024
  ds_read_b64_tr_b16 v[136:137], v22 offset:4096
  ds_read_b64_tr_b16 v[138:139], v22 offset:5120
  ds_read_b64_tr_b16 v[140:141], v23 offset:4096
  ds_read_b64_tr_b16 v[142:143], v23 offset:5120
  ds_read_b64_tr_b16 v[144:145], v22 offset:8192
  ds_read_b64_tr_b16 v[146:147], v22 offset:9216
  ds_read_b64_tr_b16 v[148:149], v23 offset:8192
  ds_read_b64_tr_b16 v[150:151], v23 offset:9216
  ds_read_b64_tr_b16 v[152:153], v22 offset:12288
  ds_read_b64_tr_b16 v[154:155], v22 offset:13312
  ds_read_b64_tr_b16 v[156:157], v23 offset:12288
  ds_read_b64_tr_b16 v[158:159], v23 offset:13312
  s_waitcnt vmcnt(0)
  s_barrier
  v_add_u32 v22, 16384, v16
  v_add_u32 v23, 16384, v17
  ds_read_b64_tr_b16 v[160:161], v22 offset:0
  ds_read_b64_tr_b16 v[162:163], v22 offset:1024
  ds_read_b64_tr_b16 v[164:165], v23 offset:0
  ds_read_b64_tr_b16 v[166:167], v23 offset:1024
  ds_read_b64_tr_b16 v[168:169], v22 offset:4096
  ds_read_b64_tr_b16 v[170:171], v22 offset:5120
  ds_read_b64_tr_b16 v[172:173], v23 offset:4096
  ds_read_b64_tr_b16 v[174:175], v23 offset:5120
  ds_read_b64_tr_b16 v[176:177], v22 offset:8192
  ds_read_b64_tr_b16 v[178:179], v22 offset:9216
  ds_read_b64_tr_b16 v[180:181], v23 offset:8192
  ds_read_b64_tr_b16 v[182:183], v23 offset:9216
  ds_read_b64_tr_b16 v[184:185], v22 offset:12288
  ds_read_b64_tr_b16 v[186:187], v22 offset:13312
  ds_read_b64_tr_b16 v[188:189], v23 offset:12288
  ds_read_b64_tr_b16 v[190:191], v23 offset:13312
  s_waitcnt lgkmcnt(0)
  s_barrier
  v_and_b32 v251, 15, v0
  v_lshlrev_b32 v251, 2, v251
l1b_4400062:
  buffer_load_dword v250, v251, s[84:87], 0 offen offset:128 sc1
  s_waitcnt vmcnt(0)
  v_cmp_gt_u32 vcc, 8, v250
  s_nop 1
  s_cbranch_vccz l1bok_4400063
  s_add_u32 s63, s63, 1
  s_cmp_gt_u32 s63, 4194304
  s_cbranch_scc1 fz_fail
  s_sleep 3
  s_branch l1b_4400062
l1bok_4400063:
  s_barrier
  s_lshl_b32 s30, s40, 7
  s_lshl_b32 s31, s24, 5
  s_add_u32 s30, s30, s31
  s_mul_i32 s27, s30, 1280
  s_add_u32 s27, s27, 0
  s_add_u32 s30, s27, 0
  s_add_u32 m0, s35, 0
  s_nop 0
  buffer_load_dwordx4 v1, s[4:7], s30 offen lds
  s_add_u32 s30, s27, 10240
  s_add_u32 m0, s35, 1024
  s_nop 0
  buffer_load_dwordx4 v2, s[4:7], s30 offen lds
  s_add_u32 s30, s27, 20480
  s_add_u32 m0, s35, 2048
  s_nop 0
  buffer_load_dwordx4 v1, s[4:7], s30 offen lds
  s_add_u32 s30, s27, 30720
  s_add_u32 m0, s35, 3072
  s_nop 0
  buffer_load_dwordx4 v2, s[4:7], s30 offen lds
  s_add_u32 s30, s27, 128
  s_add_u32 m0, s35, 16384
  s_nop 0
  buffer_load_dwordx4 v1, s[4:7], s30 offen lds
  s_add_u32 s30, s27, 10368
  s_add_u32 m0, s35, 17408
  s_nop 0
  buffer_load_dwordx4 v2, s[4:7], s30 offen lds
  s_add_u32 s30, s27, 20608
  s_add_u32 m0, s35, 18432
  s_nop 0
  buffer_load_dwordx4 v1, s[4:7], s30 offen lds
  s_add_u32 s30, s27, 30848
  s_add_u32 m0, s35, 19456
  s_nop 0
  buffer_load_dwordx4 v2, s[4:7], s30 offen lds
  s_add_u32 s30, s27, 256
  s_add_u32 m0, s35, 32768
  s_nop 0
  buffer_load_dwordx4 v1, s[4:7], s30 offen lds
  s_add_u32 s30, s27, 10496
  s_add_u32 m0, s35, 33792
  s_nop 0
  buffer_load_dwordx4 v2, s[4:7], s30 offen lds
  s_add_u32 s30, s27, 20736
  s_add_u32 m0, s35, 34816
  s_nop 0
  buffer_load_dwordx4 v1, s[4:7], s30 offen lds
  s_add_u32 s30, s27, 30976
  s_add_u32 m0, s35, 35840
  s_nop 0
  buffer_load_dwordx4 v2, s[4:7], s30 offen lds
  s_add_u32 s30, s27, 384
  s_add_u32 m0, s35, 49152
  s_nop 0
  buffer_load_dwordx4 v1, s[4:7], s30 offen lds
  s_add_u32 s30, s27, 10624
  s_add_u32 m0, s35, 50176
  s_nop 0
  buffer_load_dwordx4 v2, s[4:7], s30 offen lds
  s_add_u32 s30, s27, 20864
  s_add_u32 m0, s35, 51200
  s_nop 0
  buffer_load_dwordx4 v1, s[4:7], s30 offen lds
  s_add_u32 s30, s27, 31104
  s_add_u32 m0, s35, 52224
  s_nop 0
  buffer_load_dwordx4 v2, s[4:7], s30 offen lds
  s_add_u32 s30, s27, 512
  s_add_u32 m0, s35, 65536
  s_nop 0
  buffer_load_dwordx4 v1, s[4:7], s30 offen lds
  s_add_u32 s30, s27, 10752
  s_add_u32 m0, s35, 66560
  s_nop 0
  buffer_load_dwordx4 v2, s[4:7], s30 offen lds
  s_add_u32 s30, s27, 20992
  s_add_u32 m0, s35, 67584
  s_nop 0
  buffer_load_dwordx4 v1, s[4:7], s30 offen lds
  s_add_u32 s30, s27, 31232
  s_add_u32 m0, s35, 68608
  s_nop 0
  buffer_load_dwordx4 v2, s[4:7], s30 offen lds
  s_add_u32 s30, s27, 640
  s_add_u32 m0, s35, 81920
  s_nop 0
  buffer_load_dwordx4 v1, s[4:7], s30 offen lds
  s_add_u32 s30, s27, 10880
  s_add_u32 m0, s35, 82944
  s_nop 0
  buffer_load_dwordx4 v2, s[4:7], s30 offen lds
  s_add_u32 s30, s27, 21120
  s_add_u32 m0, s35, 83968
  s_nop 0
  buffer_load_dwordx4 v1, s[4:7], s30 offen lds
  s_add_u32 s30, s27, 31360
  s_add_u32 m0, s35, 84992
  s_nop 0
  buffer_load_dwordx4 v2, s[4:7], s30 offen lds
  s_add_u32 s30, s27, 768
  s_add_u32 m0, s35, 98304
  s_nop 0
  buffer_load_dwordx4 v1, s[4:7], s30 offen lds
  s_add_u32 s30, s27, 11008
  s_add_u32 m0, s35, 99328
  s_nop 0
  buffer_load_dwordx4 v2, s[4:7], s30 offen lds
  s_add_u32 s30, s27, 21248
  s_add_u32 m0, s35, 100352
  s_nop 0
  buffer_load_dwordx4 v1, s[4:7], s30 offen lds
  s_add_u32 s30, s27, 31488
  s_add_u32 m0, s35, 101376
  s_nop 0
  buffer_load_dwordx4 v2, s[4:7], s30 offen lds
  s_add_u32 s30, s27, 896
  s_add_u32 m0, s35, 114688
  s_nop 0
  buffer_load_dwordx4 v1, s[4:7], s30 offen lds
  s_add_u32 s30, s27, 11136
  s_add_u32 m0, s35, 115712
  s_nop 0
  buffer_load_dwordx4 v2, s[4:7], s30 offen lds
  s_add_u32 s30, s27, 21376
  s_add_u32 m0, s35, 116736
  s_nop 0
  buffer_load_dwordx4 v1, s[4:7], s30 offen lds
  s_add_u32 s30, s27, 31616
  s_add_u32 m0, s35, 117760
  s_nop 0
  buffer_load_dwordx4 v2, s[4:7], s30 offen lds
qs_4400064:
  v_mov_b64 v[64:65], 0
  v_mov_b64 v[66:67], 0
  v_mov_b64 v[68:69], 0
  v_mov_b64 v[70:71], 0
  v_mov_b64 v[72:73], 0
  v_mov_b64 v[74:75], 0
  v_mov_b64 v[76:77], 0
  v_mov_b64 v[78:79], 0
  v_mov_b64 v[80:81], 0
  v_mov_b64 v[82:83], 0
  v_mov_b64 v[84:85], 0
  v_mov_b64 v[86:87], 0
  v_mov_b64 v[88:89], 0
  v_mov_b64 v[90:91], 0
  v_mov_b64 v[92:93], 0
  v_mov_b64 v[94:95], 0
  v_mov_b64 v[96:97], 0
  v_mov_b64 v[98:99], 0
  v_mov_b64 v[100:101], 0
  v_mov_b64 v[102:103], 0
  v_mov_b64 v[104:105], 0
  v_mov_b64 v[106:107], 0
  v_mov_b64 v[108:109], 0
  v_mov_b64 v[110:111], 0
  v_mov_b64 v[112:113], 0
  v_mov_b64 v[114:115], 0
  v_mov_b64 v[116:117], 0
  v_mov_b64 v[118:119], 0
  v_mov_b64 v[120:121], 0
  v_mov_b64 v[122:123], 0
  v_mov_b64 v[124:125], 0
  v_mov_b64 v[126:127], 0
  s_waitcnt vmcnt(28) lgkmcnt(0)
  s_barrier
  ds_read_b128 v[32:35], v4 offset:0
  ds_read_b128 v[36:39], v4 offset:4096
  s_waitcnt lgkmcnt(0)
  ds_read_b128 v[40:43], v5 offset:0
  v_mfma_f32_32x32x16_bf16 v[64:79], a[0:3], v[32:35], v[64:79]
  ds_read_b128 v[44:47], v5 offset:4096
  v_mfma_f32_32x32x16_bf16 v[80:95], a[4:7], v[32:35], v[80:95]
  v_mfma_f32_32x32x16_bf16 v[96:111], a[0:3], v[36:39], v[96:111]
  v_mfma_f32_32x32x16_bf16 v[112:127], a[4:7], v[36:39], v[112:127]
  s_waitcnt lgkmcnt(0)
  ds_read_b128 v[32:35], v6 offset:0
  v_mfma_f32_32x32x16_bf16 v[64:79], a[8:11], v[40:43], v[64:79]
  ds_read_b128 v[36:39], v6 offset:4096
  v_mfma_f32_32x32x16_bf16 v[80:95], a[12:15], v[40:43], v[80:95]
  v_mfma_f32_32x32x16_bf16 v[96:111], a[8:11], v[44:47], v[96:111]
  v_mfma_f32_32x32x16_bf16 v[112:127], a[12:15], v[44:47], v[112:127]
  s_waitcnt lgkmcnt(0)
  ds_read_b128 v[40:43], v7 offset:0
  v_mfma_f32_32x32x16_bf16 v[64:79], a[16:19], v[32:35], v[64:79]
  ds_read_b128 v[44:47], v7 offset:4096
  v_mfma_f32_32x32x16_bf16 v[80:95], a[20:23], v[32:35], v[80:95]
  v_mfma_f32_32x32x16_bf16 v[96:111], a[16:19], v[36:39], v[96:111]
  v_mfma_f32_32x32x16_bf16 v[112:127], a[20:23], v[36:39], v[112:127]
  s_waitcnt vmcnt(24) lgkmcnt(0)
  s_barrier
  ds_read_b128 v[32:35], v4 offset:16384
  v_mfma_f32_32x32x16_bf16 v[64:79], a[24:27], v[40:43], v[64:79]
  ds_read_b128 v[36:39], v4 offset:20480
  v_mfma_f32_32x32x16_bf16 v[80:95], a[28:31], v[40:43], v[80:95]
  v_mfma_f32_32x32x16_bf16 v[96:111], a[24:27], v[44:47], v[96:111]
  v_mfma_f32_32x32x16_bf16 v[112:127], a[28:31], v[44:47], v[112:127]
  s_add_u32 s30, s27, 1024
  s_add_u32 m0, s35, 0
  s_nop 0
  buffer_load_dwordx4 v1, s[4:7], s30 offen lds
  s_add_u32 s30, s27, 11264
  s_add_u32 m0, s35, 1024
  s_nop 0
  buffer_load_dwordx4 v2, s[4:7], s30 offen lds
  s_add_u32 s30, s27, 21504
  s_add_u32 m0, s35, 2048
  s_nop 0
  buffer_load_dwordx4 v1, s[4:7], s30 offen lds
  s_add_u32 s30, s27, 31744
  s_add_u32 m0, s35, 3072
  s_nop 0
  buffer_load_dwordx4 v2, s[4:7], s30 offen lds
  s_waitcnt lgkmcnt(0)
  ds_read_b128 v[40:43], v5 offset:16384
  v_mfma_f32_32x32x16_bf16 v[64:79], a[32:35], v[32:35], v[64:79]
  ds_read_b128 v[44:47], v5 offset:20480
  v_mfma_f32_32x32x16_bf16 v[80:95], a[36:39], v[32:35], v[80:95]
  v_mfma_f32_32x32x16_bf16 v[96:111], a[32:35], v[36:39], v[96:111]
  v_mfma_f32_32x32x16_bf16 v[112:127], a[36:39], v[36:39], v[112:127]
  s_waitcnt lgkmcnt(0)
  ds_read_b128 v[32:35], v6 offset:16384
  v_mfma_f32_32x32x16_bf16 v[64:79], a[40:43], v[40:43], v[64:79]
  ds_read_b128 v[36:39], v6 offset:20480
  v_mfma_f32_32x32x16_bf16 v[80:95], a[44:47], v[40:43], v[80:95]
  v_mfma_f32_32x32x16_bf16 v[96:111], a[40:43], v[44:47], v[96:111]
  v_mfma_f32_32x32x16_bf16 v[112:127], a[44:47], v[44:47], v[112:127]
  s_waitcnt lgkmcnt(0)
  ds_read_b128 v[40:43], v7 offset:16384
  v_mfma_f32_32x32x16_bf16 v[64:79], a[48:51], v[32:35], v[64:79]
  ds_read_b128 v[44:47], v7 offset:20480
  v_mfma_f32_32x32x16_bf16 v[80:95], a[52:55], v[32:35], v[80:95]
  v_mfma_f32_32x32x16_bf16 v[96:111], a[48:51], v[36:39], v[96:111]
  v_mfma_f32_32x32x16_bf16 v[112:127], a[52:55], v[36:39], v[112:127]
  s_waitcnt vmcnt(24) lgkmcnt(0)
  s_barrier
  ds_read_b128 v[32:35], v4 offset:32768
  v_mfma_f32_32x32x16_bf16 v[64:79], a[56:59], v[40:43], v[64:79]
  ds_read_b128 v[36:39], v4 offset:36864
  v_mfma_f32_32x32x16_bf16 v[80:95], a[60:63], v[40:43], v[80:95]
  v_mfma_f32_32x32x16_bf16 v[96:111], a[56:59], v[44:47], v[96:111]
  v_mfma_f32_32x32x16_bf16 v[112:127], a[60:63], v[44:47], v[112:127]
  s_add_u32 s30, s27, 1152
  s_add_u32 m0, s35, 16384
  s_nop 0
  buffer_load_dwordx4 v1, s[4:7], s30 offen lds
  s_add_u32 s30, s27, 11392
  s_add_u32 m0, s35, 17408
  s_nop 0
  buffer_load_dwordx4 v2, s[4:7], s30 offen lds
  s_add_u32 s30, s27, 21632
  s_add_u32 m0, s35, 18432
  s_nop 0
  buffer_load_dwordx4 v1, s[4:7], s30 offen lds
  s_add_u32 s30, s27, 31872
  s_add_u32 m0, s35, 19456
  s_nop 0
  buffer_load_dwordx4 v2, s[4:7], s30 offen lds
  s_waitcnt lgkmcnt(0)
  ds_read_b128 v[40:43], v5 offset:32768
  v_mfma_f32_32x32x16_bf16 v[64:79], a[64:67], v[32:35], v[64:79]
  ds_read_b128 v[44:47], v5 offset:36864
  v_mfma_f32_32x32x16_bf16 v[80:95], a[68:71], v[32:35], v[80:95]
  v_mfma_f32_32x32x16_bf16 v[96:111], a[64:67], v[36:39], v[96:111]
  v_mfma_f32_32x32x16_bf16 v[112:127], a[68:71], v[36:39], v[112:127]
  s_waitcnt lgkmcnt(0)
  ds_read_b128 v[32:35], v6 offset:32768
  v_mfma_f32_32x32x16_bf16 v[64:79], a[72:75], v[40:43], v[64:79]
  ds_read_b128 v[36:39], v6 offset:36864
  v_mfma_f32_32x32x16_bf16 v[80:95], a[76:79], v[40:43], v[80:95]
  v_mfma_f32_32x32x16_bf16 v[96:111], a[72:75], v[44:47], v[96:111]
  v_mfma_f32_32x32x16_bf16 v[112:127], a[76:79], v[44:47], v[112:127]
  s_waitcnt lgkmcnt(0)
  ds_read_b128 v[40:43], v7 offset:32768
  v_mfma_f32_32x32x16_bf16 v[64:79], a[80:83], v[32:35], v[64:79]
  ds_read_b128 v[44:47], v7 offset:36864
  v_mfma_f32_32x32x16_bf16 v[80:95], a[84:87], v[32:35], v[80:95]
  v_mfma_f32_32x32x16_bf16 v[96:111], a[80:83], v[36:39], v[96:111]
  v_mfma_f32_32x32x16_bf16 v[112:127], a[84:87], v[36:39], v[112:127]
  s_waitcnt vmcnt(24) lgkmcnt(0)
  s_barrier
  ds_read_b128 v[32:35], v4 offset:49152
  v_mfma_f32_32x32x16_bf16 v[64:79], a[88:91], v[40:43], v[64:79]
  ds_read_b128 v[36:39], v4 offset:53248
  v_mfma_f32_32x32x16_bf16 v[80:95], a[92:95], v[40:43], v[80:95]
  v_mfma_f32_32x32x16_bf16 v[96:111], a[88:91], v[44:47], v[96:111]
  v_mfma_f32_32x32x16_bf16 v[112:127], a[92:95], v[44:47], v[112:127]
  s_waitcnt lgkmcnt(0)
  ds_read_b128 v[40:43], v5 offset:49152
  v_mfma_f32_32x32x16_bf16 v[64:79], a[96:99], v[32:35], v[64:79]
  ds_read_b128 v[44:47], v5 offset:53248
  v_mfma_f32_32x32x16_bf16 v[80:95], a[100:103], v[32:35], v[80:95]
  v_mfma_f32_32x32x16_bf16 v[96:111], a[96:99], v[36:39], v[96:111]
  v_mfma_f32_32x32x16_bf16 v[112:127], a[100:103], v[36:39], v[112:127]
  s_waitcnt lgkmcnt(0)
  ds_read_b128 v[32:35], v6 offset:49152
  v_mfma_f32_32x32x16_bf16 v[64:79], a[104:107], v[40:43], v[64:79]
  ds_read_b128 v[36:39], v6 offset:53248
  v_mfma_f32_32x32x16_bf16 v[80:95], a[108:111], v[40:43], v[80:95]
  v_mfma_f32_32x32x16_bf16 v[96:111], a[104:107], v[44:47], v[96:111]
  v_mfma_f32_32x32x16_bf16 v[112:127], a[108:111], v[44:47], v[112:127]
  s_waitcnt lgkmcnt(0)
  ds_read_b128 v[40:43], v7 offset:49152
  v_mfma_f32_32x32x16_bf16 v[64:79], a[112:115], v[32:35], v[64:79]
  ds_read_b128 v[44:47], v7 offset:53248
  v_mfma_f32_32x32x16_bf16 v[80:95], a[116:119], v[32:35], v[80:95]
  v_mfma_f32_32x32x16_bf16 v[96:111], a[112:115], v[36:39], v[96:111]
  v_mfma_f32_32x32x16_bf16 v[112:127], a[116:119], v[36:39], v[112:127]
  s_waitcnt vmcnt(20) lgkmcnt(0)
  s_barrier
  ds_read_b128 v[32:35], v8 offset:0
  v_mfma_f32_32x32x16_bf16 v[64:79], a[120:123], v[40:43], v[64:79]
  ds_read_b128 v[36:39], v8 offset:4096
  v_mfma_f32_32x32x16_bf16 v[80:95], a[124:127], v[40:43], v[80:95]
  v_mfma_f32_32x32x16_bf16 v[96:111], a[120:123], v[44:47], v[96:111]
  v_mfma_f32_32x32x16_bf16 v[112:127], a[124:127], v[44:47], v[112:127]
  s_waitcnt lgkmcnt(0)
  ds_read_b128 v[40:43], v9 offset:0
  v_mfma_f32_32x32x16_bf16 v[64:79], a[128:131], v[32:35], v[64:79]
  ds_read_b128 v[44:47], v9 offset:4096
  v_mfma_f32_32x32x16_bf16 v[80:95], a[132:135], v[32:35], v[80:95]
  v_mfma_f32_32x32x16_bf16 v[96:111], a[128:131], v[36:39], v[96:111]
  v_mfma_f32_32x32x16_bf16 v[112:127], a[132:135], v[36:39], v[112:127]
  s_waitcnt lgkmcnt(0)
  ds_read_b128 v[32:35], v10 offset:0
  v_mfma_f32_32x32x16_bf16 v[64:79], a[136:139], v[40:43], v[64:79]
  ds_read_b128 v[36:39], v10 offset:4096
  v_mfma_f32_32x32x16_bf16 v[80:95], a[140:143], v[40:43], v[80:95]
  v_mfma_f32_32x32x16_bf16 v[96:111], a[136:139], v[44:47], v[96:111]
  v_mfma_f32_32x32x16_bf16 v[112:127], a[140:143], v[44:47], v[112:127]
  s_waitcnt lgkmcnt(0)
  ds_read_b128 v[40:43], v11 offset:0
  v_mfma_f32_32x32x16_bf16 v[64:79], a[144:147], v[32:35], v[64:79]
  ds_read_b128 v[44:47], v11 offset:4096
  v_mfma_f32_32x32x16_bf16 v[80:95], a[148:151], v[32:35], v[80:95]
  v_mfma_f32_32x32x16_bf16 v[96:111], a[144:147], v[36:39], v[96:111]
  v_mfma_f32_32x32x16_bf16 v[112:127], a[148:151], v[36:39], v[112:127]
  s_waitcnt vmcnt(16) lgkmcnt(0)
  s_barrier
  ds_read_b128 v[32:35], v8 offset:16384
  v_mfma_f32_32x32x16_bf16 v[64:79], a[152:155], v[40:43], v[64:79]
  ds_read_b128 v[36:39], v8 offset:20480
  v_mfma_f32_32x32x16_bf16 v[80:95], a[156:159], v[40:43], v[80:95]
  v_mfma_f32_32x32x16_bf16 v[96:111], a[152:155], v[44:47], v[96:111]
  v_mfma_f32_32x32x16_bf16 v[112:127], a[156:159], v[44:47], v[112:127]
  s_waitcnt lgkmcnt(0)
  ds_read_b128 v[40:43], v9 offset:16384
  v_mfma_f32_32x32x16_bf16 v[64:79], a[160:163], v[32:35], v[64:79]
  ds_read_b128 v[44:47], v9 offset:20480
  v_mfma_f32_32x32x16_bf16 v[80:95], a[164:167], v[32:35], v[80:95]
  v_mfma_f32_32x32x16_bf16 v[96:111], a[160:163], v[36:39], v[96:111]
  v_mfma_f32_32x32x16_bf16 v[112:127], a[164:167], v[36:39], v[112:127]
  s_waitcnt lgkmcnt(0)
  ds_read_b128 v[32:35], v10 offset:16384
  v_mfma_f32_32x32x16_bf16 v[64:79], a[168:171], v[40:43], v[64:79]
  ds_read_b128 v[36:39], v10 offset:20480
  v_mfma_f32_32x32x16_bf16 v[80:95], a[172:175], v[40:43], v[80:95]
  v_mfma_f32_32x32x16_bf16 v[96:111], a[168:171], v[44:47], v[96:111]
  v_mfma_f32_32x32x16_bf16 v[112:127], a[172:175], v[44:47], v[112:127]
  s_waitcnt lgkmcnt(0)
  ds_read_b128 v[40:43], v11 offset:16384
  v_mfma_f32_32x32x16_bf16 v[64:79], a[176:179], v[32:35], v[64:79]
  ds_read_b128 v[44:47], v11 offset:20480
  v_mfma_f32_32x32x16_bf16 v[80:95], a[180:183], v[32:35], v[80:95]
  v_mfma_f32_32x32x16_bf16 v[96:111], a[176:179], v[36:39], v[96:111]
  v_mfma_f32_32x32x16_bf16 v[112:127], a[180:183], v[36:39], v[112:127]
  s_waitcnt vmcnt(12) lgkmcnt(0)
  s_barrier
  ds_read_b128 v[32:35], v8 offset:32768
  v_mfma_f32_32x32x16_bf16 v[64:79], a[184:187], v[40:43], v[64:79]
  ds_read_b128 v[36:39], v8 offset:36864
  v_mfma_f32_32x32x16_bf16 v[80:95], a[188:191], v[40:43], v[80:95]
  v_mfma_f32_32x32x16_bf16 v[96:111], a[184:187], v[44:47], v[96:111]
  v_mfma_f32_32x32x16_bf16 v[112:127], a[188:191], v[44:47], v[112:127]
  s_waitcnt lgkmcnt(0)
  ds_read_b128 v[40:43], v9 offset:32768
  v_mfma_f32_32x32x16_bf16 v[64:79], a[192:195], v[32:35], v[64:79]
  ds_read_b128 v[44:47], v9 offset:36864
  v_mfma_f32_32x32x16_bf16 v[80:95], a[196:199], v[32:35], v[80:95]
  v_mfma_f32_32x32x16_bf16 v[96:111], a[192:195], v[36:39], v[96:111]
  v_mfma_f32_32x32x16_bf16 v[112:127], a[196:199], v[36:39], v[112:127]
  s_waitcnt lgkmcnt(0)
  ds_read_b128 v[32:35], v10 offset:32768
  v_mfma_f32_32x32x16_bf16 v[64:79], a[200:203], v[40:43], v[64:79]
  ds_read_b128 v[36:39], v10 offset:36864
  v_mfma_f32_32x32x16_bf16 v[80:95], a[204:207], v[40:43], v[80:95]
  v_mfma_f32_32x32x16_bf16 v[96:111], a[200:203], v[44:47], v[96:111]
  v_mfma_f32_32x32x16_bf16 v[112:127], a[204:207], v[44:47], v[112:127]
  s_waitcnt lgkmcnt(0)
  ds_read_b128 v[40:43], v11 offset:32768
  v_mfma_f32_32x32x16_bf16 v[64:79], a[208:211], v[32:35], v[64:79]
  ds_read_b128 v[44:47], v11 offset:36864
  v_mfma_f32_32x32x16_bf16 v[80:95], a[212:215], v[32:35], v[80:95]
  v_mfma_f32_32x32x16_bf16 v[96:111], a[208:211], v[36:39], v[96:111]
  v_mfma_f32_32x32x16_bf16 v[112:127], a[212:215], v[36:39], v[112:127]
  s_waitcnt vmcnt(8) lgkmcnt(0)
  s_barrier
  ds_read_b128 v[32:35], v8 offset:49152
  v_mfma_f32_32x32x16_bf16 v[64:79], a[216:219], v[40:43], v[64:79]
  ds_read_b128 v[36:39], v8 offset:53248
  v_mfma_f32_32x32x16_bf16 v[80:95], a[220:223], v[40:43], v[80:95]
  v_mfma_f32_32x32x16_bf16 v[96:111], a[216:219], v[44:47], v[96:111]
  v_mfma_f32_32x32x16_bf16 v[112:127], a[220:223], v[44:47], v[112:127]
  s_waitcnt lgkmcnt(0)
  ds_read_b128 v[40:43], v9 offset:49152
  v_mfma_f32_32x32x16_bf16 v[64:79], a[224:227], v[32:35], v[64:79]
  ds_read_b128 v[44:47], v9 offset:53248
  v_mfma_f32_32x32x16_bf16 v[80:95], a[228:231], v[32:35], v[80:95]
  v_mfma_f32_32x32x16_bf16 v[96:111], a[224:227], v[36:39], v[96:111]
  v_mfma_f32_32x32x16_bf16 v[112:127], a[228:231], v[36:39], v[112:127]
  s_waitcnt lgkmcnt(0)
  ds_read_b128 v[32:35], v10 offset:49152
  v_mfma_f32_32x32x16_bf16 v[64:79], a[232:235], v[40:43], v[64:79]
  ds_read_b128 v[36:39], v10 offset:53248
  v_mfma_f32_32x32x16_bf16 v[80:95], a[236:239], v[40:43], v[80:95]
  v_mfma_f32_32x32x16_bf16 v[96:111], a[232:235], v[44:47], v[96:111]
  v_mfma_f32_32x32x16_bf16 v[112:127], a[236:239], v[44:47], v[112:127]
  s_waitcnt lgkmcnt(0)
  ds_read_b128 v[40:43], v11 offset:49152
  v_mfma_f32_32x32x16_bf16 v[64:79], a[240:243], v[32:35], v[64:79]
  ds_read_b128 v[44:47], v11 offset:53248
  v_mfma_f32_32x32x16_bf16 v[80:95], a[244:247], v[32:35], v[80:95]
  v_mfma_f32_32x32x16_bf16 v[96:111], a[240:243], v[36:39], v[96:111]
  v_mfma_f32_32x32x16_bf16 v[112:127], a[244:247], v[36:39], v[112:127]
  s_waitcnt vmcnt(4) lgkmcnt(0)
  s_barrier
  ds_read_b128 v[32:35], v4 offset:0
  v_mfma_f32_32x32x16_bf16 v[64:79], a[248:251], v[40:43], v[64:79]
  ds_read_b128 v[36:39], v4 offset:4096
  v_mfma_f32_32x32x16_bf16 v[80:95], a[252:255], v[40:43], v[80:95]
  v_mfma_f32_32x32x16_bf16 v[96:111], a[248:251], v[44:47], v[96:111]
  v_mfma_f32_32x32x16_bf16 v[112:127], a[252:255], v[44:47], v[112:127]
  s_waitcnt lgkmcnt(0)
  ds_read_b128 v[40:43], v5 offset:0
  v_mfma_f32_32x32x16_bf16 v[64:79], v[128:131], v[32:35], v[64:79]
  ds_read_b128 v[44:47], v5 offset:4096
  v_mfma_f32_32x32x16_bf16 v[80:95], v[132:135], v[32:35], v[80:95]
  v_mfma_f32_32x32x16_bf16 v[96:111], v[128:131], v[36:39], v[96:111]
  v_mfma_f32_32x32x16_bf16 v[112:127], v[132:135], v[36:39], v[112:127]
  s_waitcnt lgkmcnt(0)
  ds_read_b128 v[32:35], v6 offset:0
  v_mfma_f32_32x32x16_bf16 v[64:79], v[136:139], v[40:43], v[64:79]
  ds_read_b128 v[36:39], v6 offset:4096
  v_mfma_f32_32x32x16_bf16 v[80:95], v[140:143], v[40:43], v[80:95]
  v_mfma_f32_32x32x16_bf16 v[96:111], v[136:139], v[44:47], v[96:111]
  v_mfma_f32_32x32x16_bf16 v[112:127], v[140:143], v[44:47], v[112:127]
  s_waitcnt lgkmcnt(0)
  ds_read_b128 v[40:43], v7 offset:0
  v_mfma_f32_32x32x16_bf16 v[64:79], v[144:147], v[32:35], v[64:79]
  ds_read_b128 v[44:47], v7 offset:4096
  v_mfma_f32_32x32x16_bf16 v[80:95], v[148:151], v[32:35], v[80:95]
  v_mfma_f32_32x32x16_bf16 v[96:111], v[144:147], v[36:39], v[96:111]
  v_mfma_f32_32x32x16_bf16 v[112:127], v[148:151], v[36:39], v[112:127]
  s_waitcnt vmcnt(0) lgkmcnt(0)
  s_barrier
  ds_read_b128 v[32:35], v4 offset:16384
  v_mfma_f32_32x32x16_bf16 v[64:79], v[152:155], v[40:43], v[64:79]
  ds_read_b128 v[36:39], v4 offset:20480
  v_mfma_f32_32x32x16_bf16 v[80:95], v[156:159], v[40:43], v[80:95]
  v_mfma_f32_32x32x16_bf16 v[96:111], v[152:155], v[44:47], v[96:111]
  v_mfma_f32_32x32x16_bf16 v[112:127], v[156:159], v[44:47], v[112:127]
  s_waitcnt lgkmcnt(0)
  ds_read_b128 v[40:43], v5 offset:16384
  v_mfma_f32_32x32x16_bf16 v[64:79], v[160:163], v[32:35], v[64:79]
  ds_read_b128 v[44:47], v5 offset:20480
  v_mfma_f32_32x32x16_bf16 v[80:95], v[164:167], v[32:35], v[80:95]
  v_mfma_f32_32x32x16_bf16 v[96:111], v[160:163], v[36:39], v[96:111]
  v_mfma_f32_32x32x16_bf16 v[112:127], v[164:167], v[36:39], v[112:127]
  s_waitcnt lgkmcnt(0)
  ds_read_b128 v[32:35], v6 offset:16384
  v_mfma_f32_32x32x16_bf16 v[64:79], v[168:171], v[40:43], v[64:79]
  ds_read_b128 v[36:39], v6 offset:20480
  v_mfma_f32_32x32x16_bf16 v[80:95], v[172:175], v[40:43], v[80:95]
  v_mfma_f32_32x32x16_bf16 v[96:111], v[168:171], v[44:47], v[96:111]
  v_mfma_f32_32x32x16_bf16 v[112:127], v[172:175], v[44:47], v[112:127]
  s_waitcnt lgkmcnt(0)
  ds_read_b128 v[40:43], v7 offset:16384
  v_mfma_f32_32x32x16_bf16 v[64:79], v[176:179], v[32:35], v[64:79]
  ds_read_b128 v[44:47], v7 offset:20480
  v_mfma_f32_32x32x16_bf16 v[80:95], v[180:183], v[32:35], v[80:95]
  v_mfma_f32_32x32x16_bf16 v[96:111], v[176:179], v[36:39], v[96:111]
  v_mfma_f32_32x32x16_bf16 v[112:127], v[180:183], v[36:39], v[112:127]
  s_waitcnt lgkmcnt(0)
  v_mfma_f32_32x32x16_bf16 v[64:79], v[184:187], v[40:43], v[64:79]
  v_mfma_f32_32x32x16_bf16 v[80:95], v[188:191], v[40:43], v[80:95]
  v_mfma_f32_32x32x16_bf16 v[96:111], v[184:187], v[44:47], v[96:111]
  v_mfma_f32_32x32x16_bf16 v[112:127], v[188:191], v[44:47], v[112:127]
  s_barrier
  s_mov_b32 s50, s40
  s_add_u32 s40, s40, 2
  s_min_u32 s40, s40, 15
  s_lshl_b32 s30, s40, 7
  s_lshl_b32 s31, s24, 5
  s_add_u32 s30, s30, s31
  s_mul_i32 s27, s30, 1280
  s_add_u32 s27, s27, 0
  s_add_u32 s30, s27, 0
  s_add_u32 m0, s35, 0
  s_nop 0
  buffer_load_dwordx4 v1, s[4:7], s30 offen lds
  s_add_u32 s30, s27, 10240
  s_add_u32 m0, s35, 1024
  s_nop 0
  buffer_load_dwordx4 v2, s[4:7], s30 offen lds
  s_add_u32 s30, s27, 20480
  s_add_u32 m0, s35, 2048
  s_nop 0
  buffer_load_dwordx4 v1, s[4:7], s30 offen lds
  s_add_u32 s30, s27, 30720
  s_add_u32 m0, s35, 3072
  s_nop 0
  buffer_load_dwordx4 v2, s[4:7], s30 offen lds
  s_add_u32 s30, s27, 128
  s_add_u32 m0, s35, 16384
  s_nop 0
  buffer_load_dwordx4 v1, s[4:7], s30 offen lds
  s_add_u32 s30, s27, 10368
  s_add_u32 m0, s35, 17408
  s_nop 0
  buffer_load_dwordx4 v2, s[4:7], s30 offen lds
  s_add_u32 s30, s27, 20608
  s_add_u32 m0, s35, 18432
  s_nop 0
  buffer_load_dwordx4 v1, s[4:7], s30 offen lds
  s_add_u32 s30, s27, 30848
  s_add_u32 m0, s35, 19456
  s_nop 0
  buffer_load_dwordx4 v2, s[4:7], s30 offen lds
  s_add_u32 s30, s27, 256
  s_add_u32 m0, s35, 32768
  s_nop 0
  buffer_load_dwordx4 v1, s[4:7], s30 offen lds
  s_add_u32 s30, s27, 10496
  s_add_u32 m0, s35, 33792
  s_nop 0
  buffer_load_dwordx4 v2, s[4:7], s30 offen lds
  s_add_u32 s30, s27, 20736
  s_add_u32 m0, s35, 34816
  s_nop 0
  buffer_load_dwordx4 v1, s[4:7], s30 offen lds
  s_add_u32 s30, s27, 30976
  s_add_u32 m0, s35, 35840
  s_nop 0
  buffer_load_dwordx4 v2, s[4:7], s30 offen lds
  s_add_u32 s30, s27, 384
  s_add_u32 m0, s35, 49152
  s_nop 0
  buffer_load_dwordx4 v1, s[4:7], s30 offen lds
  s_add_u32 s30, s27, 10624
  s_add_u32 m0, s35, 50176
  s_nop 0
  buffer_load_dwordx4 v2, s[4:7], s30 offen lds
  s_add_u32 s30, s27, 20864
  s_add_u32 m0, s35, 51200
  s_nop 0
  buffer_load_dwordx4 v1, s[4:7], s30 offen lds
  s_add_u32 s30, s27, 31104
  s_add_u32 m0, s35, 52224
  s_nop 0
  buffer_load_dwordx4 v2, s[4:7], s30 offen lds
  s_mov_b32 s40, s50
  s_mov_b32 s45, 20971520
  s_lshl_b32 s46, s40, 7
  s_lshl_b32 s47, s25, 6
  s_add_u32 s46, s46, s47
  s_lshl_b32 s46, s46, 13
  s_add_u32 s45, s45, s46
  s_lshl_b32 s46, s43, 8
  s_add_u32 s45, s45, s46
  s_lshl_b32 s46, s26, 7
  s_add_u32 s45, s45, s46
  v_and_b32 v22, 31, v0
  v_lshlrev_b32 v23, 7, v22
  v_and_b32 v24, 7, v0
  v_lshrrev_b32 v25, 5, v0
  s_lshl_b32 s46, s24, 13
  s_add_u32 s46, s46, 131072
  v_add_u32 v23, s46, v23
  v_cvt_pk_bf16_f32 v32, v64, v65
  v_cvt_pk_bf16_f32 v33, v66, v67
  v_cvt_pk_bf16_f32 v34, v68, v69
  v_cvt_pk_bf16_f32 v35, v70, v71
  v_cvt_pk_bf16_f32 v36, v72, v73
  v_cvt_pk_bf16_f32 v37, v74, v75
  v_cvt_pk_bf16_f32 v38, v76, v77
  v_cvt_pk_bf16_f32 v39, v78, v79
  v_permlane32_swap_b32 v32, v34
  v_permlane32_swap_b32 v33, v35
  v_permlane32_swap_b32 v36, v38
  v_permlane32_swap_b32 v37, v39
  v_add_u32 v26, 0, v25
  v_xor_b32 v26, v26, v24
  v_lshlrev_b32 v26, 4, v26
  v_add_u32 v26, v26, v23
  ds_write_b128 v26, v[32:35] offset:0
  v_add_u32 v26, 2, v25
  v_xor_b32 v26, v26, v24
  v_lshlrev_b32 v26, 4, v26
  v_add_u32 v26, v26, v23
  ds_write_b128 v26, v[36:39] offset:0
  v_cvt_pk_bf16_f32 v40, v80, v81
  v_cvt_pk_bf16_f32 v41, v82, v83
  v_cvt_pk_bf16_f32 v42, v84, v85
  v_cvt_pk_bf16_f32 v43, v86, v87
  v_cvt_pk_bf16_f32 v44, v88, v89
  v_cvt_pk_bf16_f32 v45, v90, v91
  v_cvt_pk_bf16_f32 v46, v92, v93
  v_cvt_pk_bf16_f32 v47, v94, v95
  v_permlane32_swap_b32 v40, v42
  v_permlane32_swap_b32 v41, v43
  v_permlane32_swap_b32 v44, v46
  v_permlane32_swap_b32 v45, v47
  v_add_u32 v26, 4, v25
  v_xor_b32 v26, v26, v24
  v_lshlrev_b32 v26, 4, v26
  v_add_u32 v26, v26, v23
  ds_write_b128 v26, v[40:43] offset:0
  v_add_u32 v26, 6, v25
  v_xor_b32 v26, v26, v24
  v_lshlrev_b32 v26, 4, v26
  v_add_u32 v26, v26, v23
  ds_write_b128 v26, v[44:47] offset:0
  v_cvt_pk_bf16_f32 v32, v96, v97
  v_cvt_pk_bf16_f32 v33, v98, v99
  v_cvt_pk_bf16_f32 v34, v100, v101
  v_cvt_pk_bf16_f32 v35, v102, v103
  v_cvt_pk_bf16_f32 v36, v104, v105
  v_cvt_pk_bf16_f32 v37, v106, v107
  v_cvt_pk_bf16_f32 v38, v108, v109
  v_cvt_pk_bf16_f32 v39, v110, v111
  v_permlane32_swap_b32 v32, v34
  v_permlane32_swap_b32 v33, v35
  v_permlane32_swap_b32 v36, v38
  v_permlane32_swap_b32 v37, v39
  v_add_u32 v26, 0, v25
  v_xor_b32 v26, v26, v24
  v_lshlrev_b32 v26, 4, v26
  v_add_u32 v26, v26, v23
  ds_write_b128 v26, v[32:35] offset:4096
  v_add_u32 v26, 2, v25
  v_xor_b32 v26, v26, v24
  v_lshlrev_b32 v26, 4, v26
  v_add_u32 v26, v26, v23
  ds_write_b128 v26, v[36:39] offset:4096
  v_cvt_pk_bf16_f32 v40, v112, v113
  v_cvt_pk_bf16_f32 v41, v114, v115
  v_cvt_pk_bf16_f32 v42, v116, v117
  v_cvt_pk_bf16_f32 v43, v118, v119
  v_cvt_pk_bf16_f32 v44, v120, v121
  v_cvt_pk_bf16_f32 v45, v122, v123
  v_cvt_pk_bf16_f32 v46, v124, v125
  v_cvt_pk_bf16_f32 v47, v126, v127
  v_permlane32_swap_b32 v40, v42
  v_permlane32_swap_b32 v41, v43
  v_permlane32_swap_b32 v44, v46
  v_permlane32_swap_b32 v45, v47
  v_add_u32 v26, 4, v25
  v_xor_b32 v26, v26, v24
  v_lshlrev_b32 v26, 4, v26
  v_add_u32 v26, v26, v23
  ds_write_b128 v26, v[40:43] offset:4096
  v_add_u32 v26, 6, v25
  v_xor_b32 v26, v26, v24
  v_lshlrev_b32 v26, 4, v26
  v_add_u32 v26, v26, v23
  ds_write_b128 v26, v[44:47] offset:4096
  v_lshrrev_b32 v22, 3, v0
  v_and_b32 v24, 7, v0
  v_xor_b32 v25, v24, v22
  v_lshlrev_b32 v25, 4, v25
  v_lshlrev_b32 v26, 7, v22
  v_add_u32 v25, v25, v26
  v_add_u32 v25, s46, v25
  s_mov_b32 s47, 8192
  v_mul_lo_u32 v22, v22, s47
  v_lshlrev_b32 v24, 4, v24
  v_add_u32 v22, v22, v24
  s_waitcnt lgkmcnt(0)
  ds_read_b128 v[32:35], v25 offset:0
  ds_read_b128 v[36:39], v25 offset:1024
  ds_read_b128 v[40:43], v25 offset:2048
  ds_read_b128 v[44:47], v25 offset:3072
  ds_read_b128 v[48:51], v25 offset:4096
  ds_read_b128 v[52:55], v25 offset:5120
  ds_read_b128 v[56:59], v25 offset:6144
  ds_read_b128 v[60:63], v25 offset:7168
  s_waitcnt lgkmcnt(7)
  s_add_u32 s47, s45, 0
  buffer_store_dwordx4 v[32:35], v22, s[4:7], s47 offen sc1
  s_waitcnt lgkmcnt(6)
  s_add_u32 s47, s45, 65536
  buffer_store_dwordx4 v[36:39], v22, s[4:7], s47 offen sc1
  s_waitcnt lgkmcnt(5)
  s_add_u32 s47, s45, 131072
  buffer_store_dwordx4 v[40:43], v22, s[4:7], s47 offen sc1
  s_waitcnt lgkmcnt(4)
  s_add_u32 s47, s45, 196608
  buffer_store_dwordx4 v[44:47], v22, s[4:7], s47 offen sc1
  s_waitcnt lgkmcnt(3)
  s_add_u32 s47, s45, 262144
  buffer_store_dwordx4 v[48:51], v22, s[4:7], s47 offen sc1
  s_waitcnt lgkmcnt(2)
  s_add_u32 s47, s45, 327680
  buffer_store_dwordx4 v[52:55], v22, s[4:7], s47 offen sc1
  s_waitcnt lgkmcnt(1)
  s_add_u32 s47, s45, 393216
  buffer_store_dwordx4 v[56:59], v22, s[4:7], s47 offen sc1
  s_waitcnt lgkmcnt(0)
  s_add_u32 s47, s45, 458752
  buffer_store_dwordx4 v[60:63], v22, s[4:7], s47 offen sc1
  s_add_u32 s30, s27, 512
  s_add_u32 m0, s35, 65536
  s_nop 0
  buffer_load_dwordx4 v1, s[4:7], s30 offen lds
  s_add_u32 s30, s27, 10752
  s_add_u32 m0, s35, 66560
  s_nop 0
  buffer_load_dwordx4 v2, s[4:7], s30 offen lds
  s_add_u32 s30, s27, 20992
  s_add_u32 m0, s35, 67584
  s_nop 0
  buffer_load_dwordx4 v1, s[4:7], s30 offen lds
  s_add_u32 s30, s27, 31232
  s_add_u32 m0, s35, 68608
  s_nop 0
  buffer_load_dwordx4 v2, s[4:7], s30 offen lds
  s_add_u32 s30, s27, 640
  s_add_u32 m0, s35, 81920
  s_nop 0
  buffer_load_dwordx4 v1, s[4:7], s30 offen lds
  s_add_u32 s30, s27, 10880
  s_add_u32 m0, s35, 82944
  s_nop 0
  buffer_load_dwordx4 v2, s[4:7], s30 offen lds
  s_add_u32 s30, s27, 21120
  s_add_u32 m0, s35, 83968
  s_nop 0
  buffer_load_dwordx4 v1, s[4:7], s30 offen lds
  s_add_u32 s30, s27, 31360
  s_add_u32 m0, s35, 84992
  s_nop 0
  buffer_load_dwordx4 v2, s[4:7], s30 offen lds
  s_add_u32 s30, s27, 768
  s_add_u32 m0, s35, 98304
  s_nop 0
  buffer_load_dwordx4 v1, s[4:7], s30 offen lds
  s_add_u32 s30, s27, 11008
  s_add_u32 m0, s35, 99328
  s_nop 0
  buffer_load_dwordx4 v2, s[4:7], s30 offen lds
  s_add_u32 s30, s27, 21248
  s_add_u32 m0, s35, 100352
  s_nop 0
  buffer_load_dwordx4 v1, s[4:7], s30 offen lds
  s_add_u32 s30, s27, 31488
  s_add_u32 m0, s35, 101376
  s_nop 0
  buffer_load_dwordx4 v2, s[4:7], s30 offen lds
  s_add_u32 s30, s27, 896
  s_add_u32 m0, s35, 114688
  s_nop 0
  buffer_load_dwordx4 v1, s[4:7], s30 offen lds
  s_add_u32 s30, s27, 11136
  s_add_u32 m0, s35, 115712
  s_nop 0
  buffer_load_dwordx4 v2, s[4:7], s30 offen lds
  s_add_u32 s30, s27, 21376
  s_add_u32 m0, s35, 116736
  s_nop 0
  buffer_load_dwordx4 v1, s[4:7], s30 offen lds
  s_add_u32 s30, s27, 31616
  s_add_u32 m0, s35, 117760
  s_nop 0
  buffer_load_dwordx4 v2, s[4:7], s30 offen lds
  s_lshl_b32 s49, s40, 7
  s_add_u32 s49, s49, 85065728
  s_waitcnt vmcnt(16)
  s_barrier
  v_cmp_eq_u32 vcc, 0, v254
  s_nop 0
  s_and_saveexec_b64 s[56:57], vcc
  s_cbranch_execz sig_4400065
  v_mov_b32 v250, 1
  v_mov_b32 v251, 0
  buffer_atomic_add v250, v251, s[4:7], s49 offen
sig_4400065:
  s_mov_b64 exec, s[56:57]
  s_add_u32 s40, s40, 2
  s_cmp_lt_u32 s40, 16
  s_cbranch_scc1 qs_4400064
  s_waitcnt vmcnt(0)
  s_barrier
  s_nop 0
  s_branch qd_4400061
qv_4400059:
  s_load_dwordx2 s[8:9], s[0:1], 32
  s_mov_b32 s10, 5242880
  s_mov_b32 s11, 0x00020000
  v_mov_b32 v0, v254
  v_lshrrev_b32 v22, 6, v0
  s_nop 0
  v_readfirstlane_b32 s24, v22
  v_and_b32 v0, 63, v0
  s_lshr_b32 s25, s24, 1
  s_and_b32 s26, s24, 1
  v_lshrrev_b32 v22, 3, v0
  s_mov_b32 s30, 1280
  v_mul_lo_u32 v22, v22, s30
  v_and_b32 v23, 7, v0
  v_lshrrev_b32 v24, 4, v0
  v_xor_b32 v23, v23, v24
  v_lshlrev_b32 v24, 4, v23
  v_add_u32 v1, v22, v24
  v_xor_b32 v23, 4, v23
  v_lshlrev_b32 v24, 4, v23
  v_add_u32 v2, v22, v24
  v_lshrrev_b32 v22, 4, v0
  s_mov_b32 s30, 8192
  v_mul_lo_u32 v23, v22, s30
  v_bfe_u32 v24, v0, 2, 2
  v_xor_b32 v24, v24, v22
  v_lshlrev_b32 v24, 6, v24
  v_add_u32 v23, v23, v24
  v_and_b32 v24, 3, v0
  v_lshlrev_b32 v24, 4, v24
  v_add_u32 v3, v23, v24
  v_and_b32 v22, 31, v0
  s_lshl_b32 s30, s25, 6
  v_add_u32 v23, s30, v22
  v_lshlrev_b32 v23, 7, v23
  v_bfe_u32 v24, v0, 1, 3
  v_lshrrev_b32 v25, 5, v0
  v_add_u32 v26, 0, v25
  v_xor_b32 v26, v26, v24
  v_lshlrev_b32 v26, 4, v26
  v_add_u32 v4, v23, v26
  v_add_u32 v8, 65536, v4
  v_add_u32 v26, 2, v25
  v_xor_b32 v26, v26, v24
  v_lshlrev_b32 v26, 4, v26
  v_add_u32 v5, v23, v26
  v_add_u32 v9, 65536, v5
  v_add_u32 v26, 4, v25
  v_xor_b32 v26, v26, v24
  v_lshlrev_b32 v26, 4, v26
  v_add_u32 v6, v23, v26
  v_add_u32 v10, 65536, v6
  v_add_u32 v26, 6, v25
  v_xor_b32 v26, v26, v24
  v_lshlrev_b32 v26, 4, v26
  v_add_u32 v7, v23, v26
  v_add_u32 v11, 65536, v7
  v_lshrrev_b32 v22, 5, v0
  v_lshlrev_b32 v22, 3, v22
  v_bfe_u32 v23, v0, 2, 2
  v_add_u32 v22, v22, v23
  v_lshlrev_b32 v22, 8, v22
  v_bfe_u32 v24, v0, 4, 1
  v_lshlrev_b32 v24, 5, v24
  v_add_u32 v22, v22, v24
  v_and_b32 v24, 3, v0
  v_lshlrev_b32 v24, 3, v24
  v_add_u32 v22, v22, v24
  s_lshl_b32 s30, s26, 1
  s_add_u32 s31, s30, 0
  v_xor_b32 v24, s31, v23
  v_lshlrev_b32 v24, 6, v24
  v_add_u32 v24, v22, v24
  v_add_u32 v16, 131072, v24
  s_add_u32 s31, s30, 1
  v_xor_b32 v24, s31, v23
  v_lshlrev_b32 v24, 6, v24
  v_add_u32 v24, v22, v24
  v_add_u32 v17, 131072, v24
  s_lshl_b32 s35, s24, 12
  s_lshl_b32 s36, s24, 12
  s_add_u32 s36, s36, 131072
  s_lshl_b32 s28, s43, 8
  s_lshl_b32 s31, s24, 17
  s_add_u32 s28, s28, s31
  s_waitcnt lgkmcnt(0)
  s_barrier
  s_add_u32 s30, s28, 0
  s_sub_u32 m0, s36, 131072
  s_nop 0
  buffer_load_dwordx4 v3, s[8:11], s30 offen lds
  s_add_u32 s30, s28, 32768
  s_sub_u32 m0, s36, 130048
  s_nop 0
  buffer_load_dwordx4 v3, s[8:11], s30 offen lds
  s_add_u32 s30, s28, 65536
  s_sub_u32 m0, s36, 129024
  s_nop 0
  buffer_load_dwordx4 v3, s[8:11], s30 offen lds
  s_add_u32 s30, s28, 98304
  s_sub_u32 m0, s36, 128000
  s_nop 0
  buffer_load_dwordx4 v3, s[8:11], s30 offen lds
  s_add_u32 s30, s28, 524288
  s_sub_u32 m0, s36, 114688
  s_nop 0
  buffer_load_dwordx4 v3, s[8:11], s30 offen lds
  s_add_u32 s30, s28, 557056
  s_sub_u32 m0, s36, 113664
  s_nop 0
  buffer_load_dwordx4 v3, s[8:11], s30 offen lds
  s_add_u32 s30, s28, 589824
  s_sub_u32 m0, s36, 112640
  s_nop 0
  buffer_load_dwordx4 v3, s[8:11], s30 offen lds
  s_add_u32 s30, s28, 622592
  s_sub_u32 m0, s36, 111616
  s_nop 0
  buffer_load_dwordx4 v3, s[8:11], s30 offen lds
  s_add_u32 s30, s28, 1048576
  s_sub_u32 m0, s36, 98304
  s_nop 0
  buffer_load_dwordx4 v3, s[8:11], s30 offen lds
  s_add_u32 s30, s28, 1081344
  s_sub_u32 m0, s36, 97280
  s_nop 0
  buffer_load_dwordx4 v3, s[8:11], s30 offen lds
  s_add_u32 s30, s28, 1114112
  s_sub_u32 m0, s36, 96256
  s_nop 0
  buffer_load_dwordx4 v3, s[8:11], s30 offen lds
  s_add_u32 s30, s28, 1146880
  s_sub_u32 m0, s36, 95232
  s_nop 0
  buffer_load_dwordx4 v3, s[8:11], s30 offen lds
  s_add_u32 s30, s28, 1572864
  s_sub_u32 m0, s36, 81920
  s_nop 0
  buffer_load_dwordx4 v3, s[8:11], s30 offen lds
  s_add_u32 s30, s28, 1605632
  s_sub_u32 m0, s36, 80896
  s_nop 0
  buffer_load_dwordx4 v3, s[8:11], s30 offen lds
  s_add_u32 s30, s28, 1638400
  s_sub_u32 m0, s36, 79872
  s_nop 0
  buffer_load_dwordx4 v3, s[8:11], s30 offen lds
  s_add_u32 s30, s28, 1671168
  s_sub_u32 m0, s36, 78848
  s_nop 0
  buffer_load_dwordx4 v3, s[8:11], s30 offen lds
  s_add_u32 s30, s28, 2097152
  s_sub_u32 m0, s36, 65536
  s_nop 0
  buffer_load_dwordx4 v3, s[8:11], s30 offen lds
  s_add_u32 s30, s28, 2129920
  s_sub_u32 m0, s36, 64512
  s_nop 0
  buffer_load_dwordx4 v3, s[8:11], s30 offen lds
  s_add_u32 s30, s28, 2162688
  s_sub_u32 m0, s36, 63488
  s_nop 0
  buffer_load_dwordx4 v3, s[8:11], s30 offen lds
  s_add_u32 s30, s28, 2195456
  s_sub_u32 m0, s36, 62464
  s_nop 0
  buffer_load_dwordx4 v3, s[8:11], s30 offen lds
  s_add_u32 s30, s28, 2621440
  s_sub_u32 m0, s36, 49152
  s_nop 0
  buffer_load_dwordx4 v3, s[8:11], s30 offen lds
  s_add_u32 s30, s28, 2654208
  s_sub_u32 m0, s36, 48128
  s_nop 0
  buffer_load_dwordx4 v3, s[8:11], s30 offen lds
  s_add_u32 s30, s28, 2686976
  s_sub_u32 m0, s36, 47104
  s_nop 0
  buffer_load_dwordx4 v3, s[8:11], s30 offen lds
  s_add_u32 s30, s28, 2719744
  s_sub_u32 m0, s36, 46080
  s_nop 0
  buffer_load_dwordx4 v3, s[8:11], s30 offen lds
  s_add_u32 s30, s28, 3145728
  s_sub_u32 m0, s36, 32768
  s_nop 0
  buffer_load_dwordx4 v3, s[8:11], s30 offen lds
  s_add_u32 s30, s28, 3178496
  s_sub_u32 m0, s36, 31744
  s_nop 0
  buffer_load_dwordx4 v3, s[8:11], s30 offen lds
  s_add_u32 s30, s28, 3211264
  s_sub_u32 m0, s36, 30720
  s_nop 0
  buffer_load_dwordx4 v3, s[8:11], s30 offen lds
  s_add_u32 s30, s28, 3244032
  s_sub_u32 m0, s36, 29696
  s_nop 0
  buffer_load_dwordx4 v3, s[8:11], s30 offen lds
  s_add_u32 s30, s28, 3670016
  s_sub_u32 m0, s36, 16384
  s_nop 0
  buffer_load_dwordx4 v3, s[8:11], s30 offen lds
  s_add_u32 s30, s28, 3702784
  s_sub_u32 m0, s36, 15360
  s_nop 0
  buffer_load_dwordx4 v3, s[8:11], s30 offen lds
  s_add_u32 s30, s28, 3735552
  s_sub_u32 m0, s36, 14336
  s_nop 0
  buffer_load_dwordx4 v3, s[8:11], s30 offen lds
  s_add_u32 s30, s28, 3768320
  s_sub_u32 m0, s36, 13312
  s_nop 0
  buffer_load_dwordx4 v3, s[8:11], s30 offen lds
  s_add_u32 s30, s28, 4194304
  s_add_u32 m0, s36, 0
  s_nop 0
  buffer_load_dwordx4 v3, s[8:11], s30 offen lds
  s_add_u32 s30, s28, 4227072
  s_add_u32 m0, s36, 1024
  s_nop 0
  buffer_load_dwordx4 v3, s[8:11], s30 offen lds
  s_add_u32 s30, s28, 4259840
  s_add_u32 m0, s36, 2048
  s_nop 0
  buffer_load_dwordx4 v3, s[8:11], s30 offen lds
  s_add_u32 s30, s28, 4292608
  s_add_u32 m0, s36, 3072
  s_nop 0
  buffer_load_dwordx4 v3, s[8:11], s30 offen lds
  s_add_u32 s30, s28, 4718592
  s_add_u32 m0, s36, 16384
  s_nop 0
  buffer_load_dwordx4 v3, s[8:11], s30 offen lds
  s_add_u32 s30, s28, 4751360
  s_add_u32 m0, s36, 17408
  s_nop 0
  buffer_load_dwordx4 v3, s[8:11], s30 offen lds
  s_add_u32 s30, s28, 4784128
  s_add_u32 m0, s36, 18432
  s_nop 0
  buffer_load_dwordx4 v3, s[8:11], s30 offen lds
  s_add_u32 s30, s28, 4816896
  s_add_u32 m0, s36, 19456
  s_nop 0
  buffer_load_dwordx4 v3, s[8:11], s30 offen lds
  s_waitcnt vmcnt(36)
  s_barrier
  v_subrev_u32 v22, 131072, v16
  v_subrev_u32 v23, 131072, v17
  ds_read_b64_tr_b16 a[0:1], v22 offset:0
  ds_read_b64_tr_b16 a[2:3], v22 offset:1024
  ds_read_b64_tr_b16 a[4:5], v23 offset:0
  ds_read_b64_tr_b16 a[6:7], v23 offset:1024
  ds_read_b64_tr_b16 a[8:9], v22 offset:4096
  ds_read_b64_tr_b16 a[10:11], v22 offset:5120
  ds_read_b64_tr_b16 a[12:13], v23 offset:4096
  ds_read_b64_tr_b16 a[14:15], v23 offset:5120
  ds_read_b64_tr_b16 a[16:17], v22 offset:8192
  ds_read_b64_tr_b16 a[18:19], v22 offset:9216
  ds_read_b64_tr_b16 a[20:21], v23 offset:8192
  ds_read_b64_tr_b16 a[22:23], v23 offset:9216
  ds_read_b64_tr_b16 a[24:25], v22 offset:12288
  ds_read_b64_tr_b16 a[26:27], v22 offset:13312
  ds_read_b64_tr_b16 a[28:29], v23 offset:12288
  ds_read_b64_tr_b16 a[30:31], v23 offset:13312
  s_waitcnt vmcnt(32)
  s_barrier
  v_subrev_u32 v22, 114688, v16
  v_subrev_u32 v23, 114688, v17
  ds_read_b64_tr_b16 a[32:33], v22 offset:0
  ds_read_b64_tr_b16 a[34:35], v22 offset:1024
  ds_read_b64_tr_b16 a[36:37], v23 offset:0
  ds_read_b64_tr_b16 a[38:39], v23 offset:1024
  ds_read_b64_tr_b16 a[40:41], v22 offset:4096
  ds_read_b64_tr_b16 a[42:43], v22 offset:5120
  ds_read_b64_tr_b16 a[44:45], v23 offset:4096
  ds_read_b64_tr_b16 a[46:47], v23 offset:5120
  ds_read_b64_tr_b16 a[48:49], v22 offset:8192
  ds_read_b64_tr_b16 a[50:51], v22 offset:9216
  ds_read_b64_tr_b16 a[52:53], v23 offset:8192
  ds_read_b64_tr_b16 a[54:55], v23 offset:9216
  ds_read_b64_tr_b16 a[56:57], v22 offset:12288
  ds_read_b64_tr_b16 a[58:59], v22 offset:13312
  ds_read_b64_tr_b16 a[60:61], v23 offset:12288
  ds_read_b64_tr_b16 a[62:63], v23 offset:13312
  s_waitcnt vmcnt(28)
  s_barrier
  v_subrev_u32 v22, 98304, v16
  v_subrev_u32 v23, 98304, v17
  ds_read_b64_tr_b16 a[64:65], v22 offset:0
  ds_read_b64_tr_b16 a[66:67], v22 offset:1024
  ds_read_b64_tr_b16 a[68:69], v23 offset:0
  ds_read_b64_tr_b16 a[70:71], v23 offset:1024
  ds_read_b64_tr_b16 a[72:73], v22 offset:4096
  ds_read_b64_tr_b16 a[74:75], v22 offset:5120
  ds_read_b64_tr_b16 a[76:77], v23 offset:4096
  ds_read_b64_tr_b16 a[78:79], v23 offset:5120
  ds_read_b64_tr_b16 a[80:81], v22 offset:8192
  ds_read_b64_tr_b16 a[82:83], v22 offset:9216
  ds_read_b64_tr_b16 a[84:85], v23 offset:8192
  ds_read_b64_tr_b16 a[86:87], v23 offset:9216
  ds_read_b64_tr_b16 a[88:89], v22 offset:12288
  ds_read_b64_tr_b16 a[90:91], v22 offset:13312
  ds_read_b64_tr_b16 a[92:93], v23 offset:12288
  ds_read_b64_tr_b16 a[94:95], v23 offset:13312
  s_waitcnt vmcnt(24)
  s_barrier
  v_subrev_u32 v22, 81920, v16
  v_subrev_u32 v23, 81920, v17
  ds_read_b64_tr_b16 a[96:97], v22 offset:0
  ds_read_b64_tr_b16 a[98:99], v22 offset:1024
  ds_read_b64_tr_b16 a[100:101], v23 offset:0
  ds_read_b64_tr_b16 a[102:103], v23 offset:1024
  ds_read_b64_tr_b16 a[104:105], v22 offset:4096
  ds_read_b64_tr_b16 a[106:107], v22 offset:5120
  ds_read_b64_tr_b16 a[108:109], v23 offset:4096
  ds_read_b64_tr_b16 a[110:111], v23 offset:5120
  ds_read_b64_tr_b16 a[112:113], v22 offset:8192
  ds_read_b64_tr_b16 a[114:115], v22 offset:9216
  ds_read_b64_tr_b16 a[116:117], v23 offset:8192
  ds_read_b64_tr_b16 a[118:119], v23 offset:9216
  ds_read_b64_tr_b16 a[120:121], v22 offset:12288
  ds_read_b64_tr_b16 a[122:123], v22 offset:13312
  ds_read_b64_tr_b16 a[124:125], v23 offset:12288
  ds_read_b64_tr_b16 a[126:127], v23 offset:13312
  s_waitcnt vmcnt(20)
  s_barrier
  v_subrev_u32 v22, 65536, v16
  v_subrev_u32 v23, 65536, v17
  ds_read_b64_tr_b16 a[128:129], v22 offset:0
  ds_read_b64_tr_b16 a[130:131], v22 offset:1024
  ds_read_b64_tr_b16 a[132:133], v23 offset:0
  ds_read_b64_tr_b16 a[134:135], v23 offset:1024
  ds_read_b64_tr_b16 a[136:137], v22 offset:4096
  ds_read_b64_tr_b16 a[138:139], v22 offset:5120
  ds_read_b64_tr_b16 a[140:141], v23 offset:4096
  ds_read_b64_tr_b16 a[142:143], v23 offset:5120
  ds_read_b64_tr_b16 a[144:145], v22 offset:8192
  ds_read_b64_tr_b16 a[146:147], v22 offset:9216
  ds_read_b64_tr_b16 a[148:149], v23 offset:8192
  ds_read_b64_tr_b16 a[150:151], v23 offset:9216
  ds_read_b64_tr_b16 a[152:153], v22 offset:12288
  ds_read_b64_tr_b16 a[154:155], v22 offset:13312
  ds_read_b64_tr_b16 a[156:157], v23 offset:12288
  ds_read_b64_tr_b16 a[158:159], v23 offset:13312
  s_waitcnt vmcnt(16)
  s_barrier
  v_subrev_u32 v22, 49152, v16
  v_subrev_u32 v23, 49152, v17
  ds_read_b64_tr_b16 a[160:161], v22 offset:0
  ds_read_b64_tr_b16 a[162:163], v22 offset:1024
  ds_read_b64_tr_b16 a[164:165], v23 offset:0
  ds_read_b64_tr_b16 a[166:167], v23 offset:1024
  ds_read_b64_tr_b16 a[168:169], v22 offset:4096
  ds_read_b64_tr_b16 a[170:171], v22 offset:5120
  ds_read_b64_tr_b16 a[172:173], v23 offset:4096
  ds_read_b64_tr_b16 a[174:175], v23 offset:5120
  ds_read_b64_tr_b16 a[176:177], v22 offset:8192
  ds_read_b64_tr_b16 a[178:179], v22 offset:9216
  ds_read_b64_tr_b16 a[180:181], v23 offset:8192
  ds_read_b64_tr_b16 a[182:183], v23 offset:9216
  ds_read_b64_tr_b16 a[184:185], v22 offset:12288
  ds_read_b64_tr_b16 a[186:187], v22 offset:13312
  ds_read_b64_tr_b16 a[188:189], v23 offset:12288
  ds_read_b64_tr_b16 a[190:191], v23 offset:13312
  s_waitcnt vmcnt(12)
  s_barrier
  v_subrev_u32 v22, 32768, v16
  v_subrev_u32 v23, 32768, v17
  ds_read_b64_tr_b16 a[192:193], v22 offset:0
  ds_read_b64_tr_b16 a[194:195], v22 offset:1024
  ds_read_b64_tr_b16 a[196:197], v23 offset:0
  ds_read_b64_tr_b16 a[198:199], v23 offset:1024
  ds_read_b64_tr_b16 a[200:201], v22 offset:4096
  ds_read_b64_tr_b16 a[202:203], v22 offset:5120
  ds_read_b64_tr_b16 a[204:205], v23 offset:4096
  ds_read_b64_tr_b16 a[206:207], v23 offset:5120
  ds_read_b64_tr_b16 a[208:209], v22 offset:8192
  ds_read_b64_tr_b16 a[210:211], v22 offset:9216
  ds_read_b64_tr_b16 a[212:213], v23 offset:8192
  ds_read_b64_tr_b16 a[214:215], v23 offset:9216
  ds_read_b64_tr_b16 a[216:217], v22 offset:12288
  ds_read_b64_tr_b16 a[218:219], v22 offset:13312
  ds_read_b64_tr_b16 a[220:221], v23 offset:12288
  ds_read_b64_tr_b16 a[222:223], v23 offset:13312
  s_waitcnt vmcnt(8)
  s_barrier
  v_subrev_u32 v22, 16384, v16
  v_subrev_u32 v23, 16384, v17
  ds_read_b64_tr_b16 a[224:225], v22 offset:0
  ds_read_b64_tr_b16 a[226:227], v22 offset:1024
  ds_read_b64_tr_b16 a[228:229], v23 offset:0
  ds_read_b64_tr_b16 a[230:231], v23 offset:1024
  ds_read_b64_tr_b16 a[232:233], v22 offset:4096
  ds_read_b64_tr_b16 a[234:235], v22 offset:5120
  ds_read_b64_tr_b16 a[236:237], v23 offset:4096
  ds_read_b64_tr_b16 a[238:239], v23 offset:5120
  ds_read_b64_tr_b16 a[240:241], v22 offset:8192
  ds_read_b64_tr_b16 a[242:243], v22 offset:9216
  ds_read_b64_tr_b16 a[244:245], v23 offset:8192
  ds_read_b64_tr_b16 a[246:247], v23 offset:9216
  ds_read_b64_tr_b16 a[248:249], v22 offset:12288
  ds_read_b64_tr_b16 a[250:251], v22 offset:13312
  ds_read_b64_tr_b16 a[252:253], v23 offset:12288
  ds_read_b64_tr_b16 a[254:255], v23 offset:13312
  s_waitcnt vmcnt(4)
  s_barrier
  v_add_u32 v22, 0, v16
  v_add_u32 v23, 0, v17
  ds_read_b64_tr_b16 v[128:129], v22 offset:0
  ds_read_b64_tr_b16 v[130:131], v22 offset:1024
  ds_read_b64_tr_b16 v[132:133], v23 offset:0
  ds_read_b64_tr_b16 v[134:135], v23 offset:1024
  ds_read_b64_tr_b16 v[136:137], v22 offset:4096
  ds_read_b64_tr_b16 v[138:139], v22 offset:5120
  ds_read_b64_tr_b16 v[140:141], v23 offset:4096
  ds_read_b64_tr_b16 v[142:143], v23 offset:5120
  ds_read_b64_tr_b16 v[144:145], v22 offset:8192
  ds_read_b64_tr_b16 v[146:147], v22 offset:9216
  ds_read_b64_tr_b16 v[148:149], v23 offset:8192
  ds_read_b64_tr_b16 v[150:151], v23 offset:9216
  ds_read_b64_tr_b16 v[152:153], v22 offset:12288
  ds_read_b64_tr_b16 v[154:155], v22 offset:13312
  ds_read_b64_tr_b16 v[156:157], v23 offset:12288
  ds_read_b64_tr_b16 v[158:159], v23 offset:13312
  s_waitcnt vmcnt(0)
  s_barrier
  v_add_u32 v22, 16384, v16
  v_add_u32 v23, 16384, v17
  ds_read_b64_tr_b16 v[160:161], v22 offset:0
  ds_read_b64_tr_b16 v[162:163], v22 offset:1024
  ds_read_b64_tr_b16 v[164:165], v23 offset:0
  ds_read_b64_tr_b16 v[166:167], v23 offset:1024
  ds_read_b64_tr_b16 v[168:169], v22 offset:4096
  ds_read_b64_tr_b16 v[170:171], v22 offset:5120
  ds_read_b64_tr_b16 v[172:173], v23 offset:4096
  ds_read_b64_tr_b16 v[174:175], v23 offset:5120
  ds_read_b64_tr_b16 v[176:177], v22 offset:8192
  ds_read_b64_tr_b16 v[178:179], v22 offset:9216
  ds_read_b64_tr_b16 v[180:181], v23 offset:8192
  ds_read_b64_tr_b16 v[182:183], v23 offset:9216
  ds_read_b64_tr_b16 v[184:185], v22 offset:12288
  ds_read_b64_tr_b16 v[186:187], v22 offset:13312
  ds_read_b64_tr_b16 v[188:189], v23 offset:12288
  ds_read_b64_tr_b16 v[190:191], v23 offset:13312
  s_waitcnt lgkmcnt(0)
  s_barrier
  v_and_b32 v251, 15, v0
  v_lshlrev_b32 v251, 2, v251
l1b_4400066:
  buffer_load_dword v250, v251, s[84:87], 0 offen offset:128 sc1
  s_waitcnt vmcnt(0)
  v_cmp_gt_u32 vcc, 8, v250
  s_nop 1
  s_cbranch_vccz l1bok_4400067
  s_add_u32 s63, s63, 1
  s_cmp_gt_u32 s63, 4194304
  s_cbranch_scc1 fz_fail
  s_sleep 3
  s_branch l1b_4400066
l1bok_4400067:
  s_barrier
  s_lshl_b32 s30, s40, 7
  s_lshl_b32 s31, s24, 5
  s_add_u32 s30, s30, s31
  s_mul_i32 s27, s30, 1280
  s_add_u32 s27, s27, 0
  s_add_u32 s30, s27, 0
  s_add_u32 m0, s35, 0
  s_nop 0
  buffer_load_dwordx4 v1, s[4:7], s30 offen lds
  s_add_u32 s30, s27, 10240
  s_add_u32 m0, s35, 1024
  s_nop 0
  buffer_load_dwordx4 v2, s[4:7], s30 offen lds
  s_add_u32 s30, s27, 20480
  s_add_u32 m0, s35, 2048
  s_nop 0
  buffer_load_dwordx4 v1, s[4:7], s30 offen lds
  s_add_u32 s30, s27, 30720
  s_add_u32 m0, s35, 3072
  s_nop 0
  buffer_load_dwordx4 v2, s[4:7], s30 offen lds
  s_add_u32 s30, s27, 128
  s_add_u32 m0, s35, 16384
  s_nop 0
  buffer_load_dwordx4 v1, s[4:7], s30 offen lds
  s_add_u32 s30, s27, 10368
  s_add_u32 m0, s35, 17408
  s_nop 0
  buffer_load_dwordx4 v2, s[4:7], s30 offen lds
  s_add_u32 s30, s27, 20608
  s_add_u32 m0, s35, 18432
  s_nop 0
  buffer_load_dwordx4 v1, s[4:7], s30 offen lds
  s_add_u32 s30, s27, 30848
  s_add_u32 m0, s35, 19456
  s_nop 0
  buffer_load_dwordx4 v2, s[4:7], s30 offen lds
  s_add_u32 s30, s27, 256
  s_add_u32 m0, s35, 32768
  s_nop 0
  buffer_load_dwordx4 v1, s[4:7], s30 offen lds
  s_add_u32 s30, s27, 10496
  s_add_u32 m0, s35, 33792
  s_nop 0
  buffer_load_dwordx4 v2, s[4:7], s30 offen lds
  s_add_u32 s30, s27, 20736
  s_add_u32 m0, s35, 34816
  s_nop 0
  buffer_load_dwordx4 v1, s[4:7], s30 offen lds
  s_add_u32 s30, s27, 30976
  s_add_u32 m0, s35, 35840
  s_nop 0
  buffer_load_dwordx4 v2, s[4:7], s30 offen lds
  s_add_u32 s30, s27, 384
  s_add_u32 m0, s35, 49152
  s_nop 0
  buffer_load_dwordx4 v1, s[4:7], s30 offen lds
  s_add_u32 s30, s27, 10624
  s_add_u32 m0, s35, 50176
  s_nop 0
  buffer_load_dwordx4 v2, s[4:7], s30 offen lds
  s_add_u32 s30, s27, 20864
  s_add_u32 m0, s35, 51200
  s_nop 0
  buffer_load_dwordx4 v1, s[4:7], s30 offen lds
  s_add_u32 s30, s27, 31104
  s_add_u32 m0, s35, 52224
  s_nop 0
  buffer_load_dwordx4 v2, s[4:7], s30 offen lds
  s_add_u32 s30, s27, 512
  s_add_u32 m0, s35, 65536
  s_nop 0
  buffer_load_dwordx4 v1, s[4:7], s30 offen lds
  s_add_u32 s30, s27, 10752
  s_add_u32 m0, s35, 66560
  s_nop 0
  buffer_load_dwordx4 v2, s[4:7], s30 offen lds
  s_add_u32 s30, s27, 20992
  s_add_u32 m0, s35, 67584
  s_nop 0
  buffer_load_dwordx4 v1, s[4:7], s30 offen lds
  s_add_u32 s30, s27, 31232
  s_add_u32 m0, s35, 68608
  s_nop 0
  buffer_load_dwordx4 v2, s[4:7], s30 offen lds
  s_add_u32 s30, s27, 640
  s_add_u32 m0, s35, 81920
  s_nop 0
  buffer_load_dwordx4 v1, s[4:7], s30 offen lds
  s_add_u32 s30, s27, 10880
  s_add_u32 m0, s35, 82944
  s_nop 0
  buffer_load_dwordx4 v2, s[4:7], s30 offen lds
  s_add_u32 s30, s27, 21120
  s_add_u32 m0, s35, 83968
  s_nop 0
  buffer_load_dwordx4 v1, s[4:7], s30 offen lds
  s_add_u32 s30, s27, 31360
  s_add_u32 m0, s35, 84992
  s_nop 0
  buffer_load_dwordx4 v2, s[4:7], s30 offen lds
  s_add_u32 s30, s27, 768
  s_add_u32 m0, s35, 98304
  s_nop 0
  buffer_load_dwordx4 v1, s[4:7], s30 offen lds
  s_add_u32 s30, s27, 11008
  s_add_u32 m0, s35, 99328
  s_nop 0
  buffer_load_dwordx4 v2, s[4:7], s30 offen lds
  s_add_u32 s30, s27, 21248
  s_add_u32 m0, s35, 100352
  s_nop 0
  buffer_load_dwordx4 v1, s[4:7], s30 offen lds
  s_add_u32 s30, s27, 31488
  s_add_u32 m0, s35, 101376
  s_nop 0
  buffer_load_dwordx4 v2, s[4:7], s30 offen lds
  s_add_u32 s30, s27, 896
  s_add_u32 m0, s35, 114688
  s_nop 0
  buffer_load_dwordx4 v1, s[4:7], s30 offen lds
  s_add_u32 s30, s27, 11136
  s_add_u32 m0, s35, 115712
  s_nop 0
  buffer_load_dwordx4 v2, s[4:7], s30 offen lds
  s_add_u32 s30, s27, 21376
  s_add_u32 m0, s35, 116736
  s_nop 0
  buffer_load_dwordx4 v1, s[4:7], s30 offen lds
  s_add_u32 s30, s27, 31616
  s_add_u32 m0, s35, 117760
  s_nop 0
  buffer_load_dwordx4 v2, s[4:7], s30 offen lds
qs_4400068:
  v_mov_b64 v[64:65], 0
  v_mov_b64 v[66:67], 0
  v_mov_b64 v[68:69], 0
  v_mov_b64 v[70:71], 0
  v_mov_b64 v[72:73], 0
  v_mov_b64 v[74:75], 0
  v_mov_b64 v[76:77], 0
  v_mov_b64 v[78:79], 0
  v_mov_b64 v[80:81], 0
  v_mov_b64 v[82:83], 0
  v_mov_b64 v[84:85], 0
  v_mov_b64 v[86:87], 0
  v_mov_b64 v[88:89], 0
  v_mov_b64 v[90:91], 0
  v_mov_b64 v[92:93], 0
  v_mov_b64 v[94:95], 0
  v_mov_b64 v[96:97], 0
  v_mov_b64 v[98:99], 0
  v_mov_b64 v[100:101], 0
  v_mov_b64 v[102:103], 0
  v_mov_b64 v[104:105], 0
  v_mov_b64 v[106:107], 0
  v_mov_b64 v[108:109], 0
  v_mov_b64 v[110:111], 0
  v_mov_b64 v[112:113], 0
  v_mov_b64 v[114:115], 0
  v_mov_b64 v[116:117], 0
  v_mov_b64 v[118:119], 0
  v_mov_b64 v[120:121], 0
  v_mov_b64 v[122:123], 0
  v_mov_b64 v[124:125], 0
  v_mov_b64 v[126:127], 0
  s_waitcnt vmcnt(28) lgkmcnt(0)
  s_barrier
  ds_read_b128 v[32:35], v4 offset:0
  ds_read_b128 v[36:39], v4 offset:4096
  s_waitcnt lgkmcnt(0)
  ds_read_b128 v[40:43], v5 offset:0
  v_mfma_f32_32x32x16_bf16 v[64:79], v[32:35], a[0:3], v[64:79]
  ds_read_b128 v[44:47], v5 offset:4096
  v_mfma_f32_32x32x16_bf16 v[80:95], v[32:35], a[4:7], v[80:95]
  v_mfma_f32_32x32x16_bf16 v[96:111], v[36:39], a[0:3], v[96:111]
  v_mfma_f32_32x32x16_bf16 v[112:127], v[36:39], a[4:7], v[112:127]
  s_waitcnt lgkmcnt(0)
  ds_read_b128 v[32:35], v6 offset:0
  v_mfma_f32_32x32x16_bf16 v[64:79], v[40:43], a[8:11], v[64:79]
  ds_read_b128 v[36:39], v6 offset:4096
  v_mfma_f32_32x32x16_bf16 v[80:95], v[40:43], a[12:15], v[80:95]
  v_mfma_f32_32x32x16_bf16 v[96:111], v[44:47], a[8:11], v[96:111]
  v_mfma_f32_32x32x16_bf16 v[112:127], v[44:47], a[12:15], v[112:127]
  s_waitcnt lgkmcnt(0)
  ds_read_b128 v[40:43], v7 offset:0
  v_mfma_f32_32x32x16_bf16 v[64:79], v[32:35], a[16:19], v[64:79]
  ds_read_b128 v[44:47], v7 offset:4096
  v_mfma_f32_32x32x16_bf16 v[80:95], v[32:35], a[20:23], v[80:95]
  v_mfma_f32_32x32x16_bf16 v[96:111], v[36:39], a[16:19], v[96:111]
  v_mfma_f32_32x32x16_bf16 v[112:127], v[36:39], a[20:23], v[112:127]
  s_waitcnt vmcnt(24) lgkmcnt(0)
  s_barrier
  ds_read_b128 v[32:35], v4 offset:16384
  v_mfma_f32_32x32x16_bf16 v[64:79], v[40:43], a[24:27], v[64:79]
  ds_read_b128 v[36:39], v4 offset:20480
  v_mfma_f32_32x32x16_bf16 v[80:95], v[40:43], a[28:31], v[80:95]
  v_mfma_f32_32x32x16_bf16 v[96:111], v[44:47], a[24:27], v[96:111]
  v_mfma_f32_32x32x16_bf16 v[112:127], v[44:47], a[28:31], v[112:127]
  s_add_u32 s30, s27, 1024
  s_add_u32 m0, s35, 0
  s_nop 0
  buffer_load_dwordx4 v1, s[4:7], s30 offen lds
  s_add_u32 s30, s27, 11264
  s_add_u32 m0, s35, 1024
  s_nop 0
  buffer_load_dwordx4 v2, s[4:7], s30 offen lds
  s_add_u32 s30, s27, 21504
  s_add_u32 m0, s35, 2048
  s_nop 0
  buffer_load_dwordx4 v1, s[4:7], s30 offen lds
  s_add_u32 s30, s27, 31744
  s_add_u32 m0, s35, 3072
  s_nop 0
  buffer_load_dwordx4 v2, s[4:7], s30 offen lds
  s_waitcnt lgkmcnt(0)
  ds_read_b128 v[40:43], v5 offset:16384
  v_mfma_f32_32x32x16_bf16 v[64:79], v[32:35], a[32:35], v[64:79]
  ds_read_b128 v[44:47], v5 offset:20480
  v_mfma_f32_32x32x16_bf16 v[80:95], v[32:35], a[36:39], v[80:95]
  v_mfma_f32_32x32x16_bf16 v[96:111], v[36:39], a[32:35], v[96:111]
  v_mfma_f32_32x32x16_bf16 v[112:127], v[36:39], a[36:39], v[112:127]
  s_waitcnt lgkmcnt(0)
  ds_read_b128 v[32:35], v6 offset:16384
  v_mfma_f32_32x32x16_bf16 v[64:79], v[40:43], a[40:43], v[64:79]
  ds_read_b128 v[36:39], v6 offset:20480
  v_mfma_f32_32x32x16_bf16 v[80:95], v[40:43], a[44:47], v[80:95]
  v_mfma_f32_32x32x16_bf16 v[96:111], v[44:47], a[40:43], v[96:111]
  v_mfma_f32_32x32x16_bf16 v[112:127], v[44:47], a[44:47], v[112:127]
  s_waitcnt lgkmcnt(0)
  ds_read_b128 v[40:43], v7 offset:16384
  v_mfma_f32_32x32x16_bf16 v[64:79], v[32:35], a[48:51], v[64:79]
  ds_read_b128 v[44:47], v7 offset:20480
  v_mfma_f32_32x32x16_bf16 v[80:95], v[32:35], a[52:55], v[80:95]
  v_mfma_f32_32x32x16_bf16 v[96:111], v[36:39], a[48:51], v[96:111]
  v_mfma_f32_32x32x16_bf16 v[112:127], v[36:39], a[52:55], v[112:127]
  s_waitcnt vmcnt(24) lgkmcnt(0)
  s_barrier
  ds_read_b128 v[32:35], v4 offset:32768
  v_mfma_f32_32x32x16_bf16 v[64:79], v[40:43], a[56:59], v[64:79]
  ds_read_b128 v[36:39], v4 offset:36864
  v_mfma_f32_32x32x16_bf16 v[80:95], v[40:43], a[60:63], v[80:95]
  v_mfma_f32_32x32x16_bf16 v[96:111], v[44:47], a[56:59], v[96:111]
  v_mfma_f32_32x32x16_bf16 v[112:127], v[44:47], a[60:63], v[112:127]
  s_add_u32 s30, s27, 1152
  s_add_u32 m0, s35, 16384
  s_nop 0
  buffer_load_dwordx4 v1, s[4:7], s30 offen lds
  s_add_u32 s30, s27, 11392
  s_add_u32 m0, s35, 17408
  s_nop 0
  buffer_load_dwordx4 v2, s[4:7], s30 offen lds
  s_add_u32 s30, s27, 21632
  s_add_u32 m0, s35, 18432
  s_nop 0
  buffer_load_dwordx4 v1, s[4:7], s30 offen lds
  s_add_u32 s30, s27, 31872
  s_add_u32 m0, s35, 19456
  s_nop 0
  buffer_load_dwordx4 v2, s[4:7], s30 offen lds
  s_waitcnt lgkmcnt(0)
  ds_read_b128 v[40:43], v5 offset:32768
  v_mfma_f32_32x32x16_bf16 v[64:79], v[32:35], a[64:67], v[64:79]
  ds_read_b128 v[44:47], v5 offset:36864
  v_mfma_f32_32x32x16_bf16 v[80:95], v[32:35], a[68:71], v[80:95]
  v_mfma_f32_32x32x16_bf16 v[96:111], v[36:39], a[64:67], v[96:111]
  v_mfma_f32_32x32x16_bf16 v[112:127], v[36:39], a[68:71], v[112:127]
  s_waitcnt lgkmcnt(0)
  ds_read_b128 v[32:35], v6 offset:32768
  v_mfma_f32_32x32x16_bf16 v[64:79], v[40:43], a[72:75], v[64:79]
  ds_read_b128 v[36:39], v6 offset:36864
  v_mfma_f32_32x32x16_bf16 v[80:95], v[40:43], a[76:79], v[80:95]
  v_mfma_f32_32x32x16_bf16 v[96:111], v[44:47], a[72:75], v[96:111]
  v_mfma_f32_32x32x16_bf16 v[112:127], v[44:47], a[76:79], v[112:127]
  s_waitcnt lgkmcnt(0)
  ds_read_b128 v[40:43], v7 offset:32768
  v_mfma_f32_32x32x16_bf16 v[64:79], v[32:35], a[80:83], v[64:79]
  ds_read_b128 v[44:47], v7 offset:36864
  v_mfma_f32_32x32x16_bf16 v[80:95], v[32:35], a[84:87], v[80:95]
  v_mfma_f32_32x32x16_bf16 v[96:111], v[36:39], a[80:83], v[96:111]
  v_mfma_f32_32x32x16_bf16 v[112:127], v[36:39], a[84:87], v[112:127]
  s_waitcnt vmcnt(24) lgkmcnt(0)
  s_barrier
  ds_read_b128 v[32:35], v4 offset:49152
  v_mfma_f32_32x32x16_bf16 v[64:79], v[40:43], a[88:91], v[64:79]
  ds_read_b128 v[36:39], v4 offset:53248
  v_mfma_f32_32x32x16_bf16 v[80:95], v[40:43], a[92:95], v[80:95]
  v_mfma_f32_32x32x16_bf16 v[96:111], v[44:47], a[88:91], v[96:111]
  v_mfma_f32_32x32x16_bf16 v[112:127], v[44:47], a[92:95], v[112:127]
  s_waitcnt lgkmcnt(0)
  ds_read_b128 v[40:43], v5 offset:49152
  v_mfma_f32_32x32x16_bf16 v[64:79], v[32:35], a[96:99], v[64:79]
  ds_read_b128 v[44:47], v5 offset:53248
  v_mfma_f32_32x32x16_bf16 v[80:95], v[32:35], a[100:103], v[80:95]
  v_mfma_f32_32x32x16_bf16 v[96:111], v[36:39], a[96:99], v[96:111]
  v_mfma_f32_32x32x16_bf16 v[112:127], v[36:39], a[100:103], v[112:127]
  s_waitcnt lgkmcnt(0)
  ds_read_b128 v[32:35], v6 offset:49152
  v_mfma_f32_32x32x16_bf16 v[64:79], v[40:43], a[104:107], v[64:79]
  ds_read_b128 v[36:39], v6 offset:53248
  v_mfma_f32_32x32x16_bf16 v[80:95], v[40:43], a[108:111], v[80:95]
  v_mfma_f32_32x32x16_bf16 v[96:111], v[44:47], a[104:107], v[96:111]
  v_mfma_f32_32x32x16_bf16 v[112:127], v[44:47], a[108:111], v[112:127]
  s_waitcnt lgkmcnt(0)
  ds_read_b128 v[40:43], v7 offset:49152
  v_mfma_f32_32x32x16_bf16 v[64:79], v[32:35], a[112:115], v[64:79]
  ds_read_b128 v[44:47], v7 offset:53248
  v_mfma_f32_32x32x16_bf16 v[80:95], v[32:35], a[116:119], v[80:95]
  v_mfma_f32_32x32x16_bf16 v[96:111], v[36:39], a[112:115], v[96:111]
  v_mfma_f32_32x32x16_bf16 v[112:127], v[36:39], a[116:119], v[112:127]
  s_waitcnt vmcnt(20) lgkmcnt(0)
  s_barrier
  ds_read_b128 v[32:35], v8 offset:0
  v_mfma_f32_32x32x16_bf16 v[64:79], v[40:43], a[120:123], v[64:79]
  ds_read_b128 v[36:39], v8 offset:4096
  v_mfma_f32_32x32x16_bf16 v[80:95], v[40:43], a[124:127], v[80:95]
  v_mfma_f32_32x32x16_bf16 v[96:111], v[44:47], a[120:123], v[96:111]
  v_mfma_f32_32x32x16_bf16 v[112:127], v[44:47], a[124:127], v[112:127]
  s_waitcnt lgkmcnt(0)
  ds_read_b128 v[40:43], v9 offset:0
  v_mfma_f32_32x32x16_bf16 v[64:79], v[32:35], a[128:131], v[64:79]
  ds_read_b128 v[44:47], v9 offset:4096
  v_mfma_f32_32x32x16_bf16 v[80:95], v[32:35], a[132:135], v[80:95]
  v_mfma_f32_32x32x16_bf16 v[96:111], v[36:39], a[128:131], v[96:111]
  v_mfma_f32_32x32x16_bf16 v[112:127], v[36:39], a[132:135], v[112:127]
  s_waitcnt lgkmcnt(0)
  ds_read_b128 v[32:35], v10 offset:0
  v_mfma_f32_32x32x16_bf16 v[64:79], v[40:43], a[136:139], v[64:79]
  ds_read_b128 v[36:39], v10 offset:4096
  v_mfma_f32_32x32x16_bf16 v[80:95], v[40:43], a[140:143], v[80:95]
  v_mfma_f32_32x32x16_bf16 v[96:111], v[44:47], a[136:139], v[96:111]
  v_mfma_f32_32x32x16_bf16 v[112:127], v[44:47], a[140:143], v[112:127]
  s_waitcnt lgkmcnt(0)
  ds_read_b128 v[40:43], v11 offset:0
  v_mfma_f32_32x32x16_bf16 v[64:79], v[32:35], a[144:147], v[64:79]
  ds_read_b128 v[44:47], v11 offset:4096
  v_mfma_f32_32x32x16_bf16 v[80:95], v[32:35], a[148:151], v[80:95]
  v_mfma_f32_32x32x16_bf16 v[96:111], v[36:39], a[144:147], v[96:111]
  v_mfma_f32_32x32x16_bf16 v[112:127], v[36:39], a[148:151], v[112:127]
  s_waitcnt vmcnt(16) lgkmcnt(0)
  s_barrier
  ds_read_b128 v[32:35], v8 offset:16384
  v_mfma_f32_32x32x16_bf16 v[64:79], v[40:43], a[152:155], v[64:79]
  ds_read_b128 v[36:39], v8 offset:20480
  v_mfma_f32_32x32x16_bf16 v[80:95], v[40:43], a[156:159], v[80:95]
  v_mfma_f32_32x32x16_bf16 v[96:111], v[44:47], a[152:155], v[96:111]
  v_mfma_f32_32x32x16_bf16 v[112:127], v[44:47], a[156:159], v[112:127]
  s_waitcnt lgkmcnt(0)
  ds_read_b128 v[40:43], v9 offset:16384
  v_mfma_f32_32x32x16_bf16 v[64:79], v[32:35], a[160:163], v[64:79]
  ds_read_b128 v[44:47], v9 offset:20480
  v_mfma_f32_32x32x16_bf16 v[80:95], v[32:35], a[164:167], v[80:95]
  v_mfma_f32_32x32x16_bf16 v[96:111], v[36:39], a[160:163], v[96:111]
  v_mfma_f32_32x32x16_bf16 v[112:127], v[36:39], a[164:167], v[112:127]
  s_waitcnt lgkmcnt(0)
  ds_read_b128 v[32:35], v10 offset:16384
  v_mfma_f32_32x32x16_bf16 v[64:79], v[40:43], a[168:171], v[64:79]
  ds_read_b128 v[36:39], v10 offset:20480
  v_mfma_f32_32x32x16_bf16 v[80:95], v[40:43], a[172:175], v[80:95]
  v_mfma_f32_32x32x16_bf16 v[96:111], v[44:47], a[168:171], v[96:111]
  v_mfma_f32_32x32x16_bf16 v[112:127], v[44:47], a[172:175], v[112:127]
  s_waitcnt lgkmcnt(0)
  ds_read_b128 v[40:43], v11 offset:16384
  v_mfma_f32_32x32x16_bf16 v[64:79], v[32:35], a[176:179], v[64:79]
  ds_read_b128 v[44:47], v11 offset:20480
  v_mfma_f32_32x32x16_bf16 v[80:95], v[32:35], a[180:183], v[80:95]
  v_mfma_f32_32x32x16_bf16 v[96:111], v[36:39], a[176:179], v[96:111]
  v_mfma_f32_32x32x16_bf16 v[112:127], v[36:39], a[180:183], v[112:127]
  s_waitcnt vmcnt(12) lgkmcnt(0)
  s_barrier
  ds_read_b128 v[32:35], v8 offset:32768
  v_mfma_f32_32x32x16_bf16 v[64:79], v[40:43], a[184:187], v[64:79]
  ds_read_b128 v[36:39], v8 offset:36864
  v_mfma_f32_32x32x16_bf16 v[80:95], v[40:43], a[188:191], v[80:95]
  v_mfma_f32_32x32x16_bf16 v[96:111], v[44:47], a[184:187], v[96:111]
  v_mfma_f32_32x32x16_bf16 v[112:127], v[44:47], a[188:191], v[112:127]
  s_waitcnt lgkmcnt(0)
  ds_read_b128 v[40:43], v9 offset:32768
  v_mfma_f32_32x32x16_bf16 v[64:79], v[32:35], a[192:195], v[64:79]
  ds_read_b128 v[44:47], v9 offset:36864
  v_mfma_f32_32x32x16_bf16 v[80:95], v[32:35], a[196:199], v[80:95]
  v_mfma_f32_32x32x16_bf16 v[96:111], v[36:39], a[192:195], v[96:111]
  v_mfma_f32_32x32x16_bf16 v[112:127], v[36:39], a[196:199], v[112:127]
  s_waitcnt lgkmcnt(0)
  ds_read_b128 v[32:35], v10 offset:32768
  v_mfma_f32_32x32x16_bf16 v[64:79], v[40:43], a[200:203], v[64:79]
  ds_read_b128 v[36:39], v10 offset:36864
  v_mfma_f32_32x32x16_bf16 v[80:95], v[40:43], a[204:207], v[80:95]
  v_mfma_f32_32x32x16_bf16 v[96:111], v[44:47], a[200:203], v[96:111]
  v_mfma_f32_32x32x16_bf16 v[112:127], v[44:47], a[204:207], v[112:127]
  s_waitcnt lgkmcnt(0)
  ds_read_b128 v[40:43], v11 offset:32768
  v_mfma_f32_32x32x16_bf16 v[64:79], v[32:35], a[208:211], v[64:79]
  ds_read_b128 v[44:47], v11 offset:36864
  v_mfma_f32_32x32x16_bf16 v[80:95], v[32:35], a[212:215], v[80:95]
  v_mfma_f32_32x32x16_bf16 v[96:111], v[36:39], a[208:211], v[96:111]
  v_mfma_f32_32x32x16_bf16 v[112:127], v[36:39], a[212:215], v[112:127]
  s_waitcnt vmcnt(8) lgkmcnt(0)
  s_barrier
  ds_read_b128 v[32:35], v8 offset:49152
  v_mfma_f32_32x32x16_bf16 v[64:79], v[40:43], a[216:219], v[64:79]
  ds_read_b128 v[36:39], v8 offset:53248
  v_mfma_f32_32x32x16_bf16 v[80:95], v[40:43], a[220:223], v[80:95]
  v_mfma_f32_32x32x16_bf16 v[96:111], v[44:47], a[216:219], v[96:111]
  v_mfma_f32_32x32x16_bf16 v[112:127], v[44:47], a[220:223], v[112:127]
  s_waitcnt lgkmcnt(0)
  ds_read_b128 v[40:43], v9 offset:49152
  v_mfma_f32_32x32x16_bf16 v[64:79], v[32:35], a[224:227], v[64:79]
  ds_read_b128 v[44:47], v9 offset:53248
  v_mfma_f32_32x32x16_bf16 v[80:95], v[32:35], a[228:231], v[80:95]
  v_mfma_f32_32x32x16_bf16 v[96:111], v[36:39], a[224:227], v[96:111]
  v_mfma_f32_32x32x16_bf16 v[112:127], v[36:39], a[228:231], v[112:127]
  s_waitcnt lgkmcnt(0)
  ds_read_b128 v[32:35], v10 offset:49152
  v_mfma_f32_32x32x16_bf16 v[64:79], v[40:43], a[232:235], v[64:79]
  ds_read_b128 v[36:39], v10 offset:53248
  v_mfma_f32_32x32x16_bf16 v[80:95], v[40:43], a[236:239], v[80:95]
  v_mfma_f32_32x32x16_bf16 v[96:111], v[44:47], a[232:235], v[96:111]
  v_mfma_f32_32x32x16_bf16 v[112:127], v[44:47], a[236:239], v[112:127]
  s_waitcnt lgkmcnt(0)
  ds_read_b128 v[40:43], v11 offset:49152
  v_mfma_f32_32x32x16_bf16 v[64:79], v[32:35], a[240:243], v[64:79]
  ds_read_b128 v[44:47], v11 offset:53248
  v_mfma_f32_32x32x16_bf16 v[80:95], v[32:35], a[244:247], v[80:95]
  v_mfma_f32_32x32x16_bf16 v[96:111], v[36:39], a[240:243], v[96:111]
  v_mfma_f32_32x32x16_bf16 v[112:127], v[36:39], a[244:247], v[112:127]
  s_waitcnt vmcnt(4) lgkmcnt(0)
  s_barrier
  ds_read_b128 v[32:35], v4 offset:0
  v_mfma_f32_32x32x16_bf16 v[64:79], v[40:43], a[248:251], v[64:79]
  ds_read_b128 v[36:39], v4 offset:4096
  v_mfma_f32_32x32x16_bf16 v[80:95], v[40:43], a[252:255], v[80:95]
  v_mfma_f32_32x32x16_bf16 v[96:111], v[44:47], a[248:251], v[96:111]
  v_mfma_f32_32x32x16_bf16 v[112:127], v[44:47], a[252:255], v[112:127]
  s_waitcnt lgkmcnt(0)
  ds_read_b128 v[40:43], v5 offset:0
  v_mfma_f32_32x32x16_bf16 v[64:79], v[32:35], v[128:131], v[64:79]
  ds_read_b128 v[44:47], v5 offset:4096
  v_mfma_f32_32x32x16_bf16 v[80:95], v[32:35], v[132:135], v[80:95]
  v_mfma_f32_32x32x16_bf16 v[96:111], v[36:39], v[128:131], v[96:111]
  v_mfma_f32_32x32x16_bf16 v[112:127], v[36:39], v[132:135], v[112:127]
  s_waitcnt lgkmcnt(0)
  ds_read_b128 v[32:35], v6 offset:0
  v_mfma_f32_32x32x16_bf16 v[64:79], v[40:43], v[136:139], v[64:79]
  ds_read_b128 v[36:39], v6 offset:4096
  v_mfma_f32_32x32x16_bf16 v[80:95], v[40:43], v[140:143], v[80:95]
  v_mfma_f32_32x32x16_bf16 v[96:111], v[44:47], v[136:139], v[96:111]
  v_mfma_f32_32x32x16_bf16 v[112:127], v[44:47], v[140:143], v[112:127]
  s_waitcnt lgkmcnt(0)
  ds_read_b128 v[40:43], v7 offset:0
  v_mfma_f32_32x32x16_bf16 v[64:79], v[32:35], v[144:147], v[64:79]
  ds_read_b128 v[44:47], v7 offset:4096
  v_mfma_f32_32x32x16_bf16 v[80:95], v[32:35], v[148:151], v[80:95]
  v_mfma_f32_32x32x16_bf16 v[96:111], v[36:39], v[144:147], v[96:111]
  v_mfma_f32_32x32x16_bf16 v[112:127], v[36:39], v[148:151], v[112:127]
  s_waitcnt vmcnt(0) lgkmcnt(0)
  s_barrier
  ds_read_b128 v[32:35], v4 offset:16384
  v_mfma_f32_32x32x16_bf16 v[64:79], v[40:43], v[152:155], v[64:79]
  ds_read_b128 v[36:39], v4 offset:20480
  v_mfma_f32_32x32x16_bf16 v[80:95], v[40:43], v[156:159], v[80:95]
  v_mfma_f32_32x32x16_bf16 v[96:111], v[44:47], v[152:155], v[96:111]
  v_mfma_f32_32x32x16_bf16 v[112:127], v[44:47], v[156:159], v[112:127]
  s_waitcnt lgkmcnt(0)
  ds_read_b128 v[40:43], v5 offset:16384
  v_mfma_f32_32x32x16_bf16 v[64:79], v[32:35], v[160:163], v[64:79]
  ds_read_b128 v[44:47], v5 offset:20480
  v_mfma_f32_32x32x16_bf16 v[80:95], v[32:35], v[164:167], v[80:95]
  v_mfma_f32_32x32x16_bf16 v[96:111], v[36:39], v[160:163], v[96:111]
  v_mfma_f32_32x32x16_bf16 v[112:127], v[36:39], v[164:167], v[112:127]
  s_waitcnt lgkmcnt(0)
  ds_read_b128 v[32:35], v6 offset:16384
  v_mfma_f32_32x32x16_bf16 v[64:79], v[40:43], v[168:171], v[64:79]
  ds_read_b128 v[36:39], v6 offset:20480
  v_mfma_f32_32x32x16_bf16 v[80:95], v[40:43], v[172:175], v[80:95]
  v_mfma_f32_32x32x16_bf16 v[96:111], v[44:47], v[168:171], v[96:111]
  v_mfma_f32_32x32x16_bf16 v[112:127], v[44:47], v[172:175], v[112:127]
  s_waitcnt lgkmcnt(0)
  ds_read_b128 v[40:43], v7 offset:16384
  v_mfma_f32_32x32x16_bf16 v[64:79], v[32:35], v[176:179], v[64:79]
  ds_read_b128 v[44:47], v7 offset:20480
  v_mfma_f32_32x32x16_bf16 v[80:95], v[32:35], v[180:183], v[80:95]
  v_mfma_f32_32x32x16_bf16 v[96:111], v[36:39], v[176:179], v[96:111]
  v_mfma_f32_32x32x16_bf16 v[112:127], v[36:39], v[180:183], v[112:127]
  s_waitcnt lgkmcnt(0)
  v_mfma_f32_32x32x16_bf16 v[64:79], v[40:43], v[184:187], v[64:79]
  v_mfma_f32_32x32x16_bf16 v[80:95], v[40:43], v[188:191], v[80:95]
  v_mfma_f32_32x32x16_bf16 v[96:111], v[44:47], v[184:187], v[96:111]
  v_mfma_f32_32x32x16_bf16 v[112:127], v[44:47], v[188:191], v[112:127]
  s_barrier
  s_mov_b32 s50, s40
  s_add_u32 s40, s40, 2
  s_min_u32 s40, s40, 15
  s_lshl_b32 s30, s40, 7
  s_lshl_b32 s31, s24, 5
  s_add_u32 s30, s30, s31
  s_mul_i32 s27, s30, 1280
  s_add_u32 s27, s27, 0
  s_add_u32 s30, s27, 0
  s_add_u32 m0, s35, 0
  s_nop 0
  buffer_load_dwordx4 v1, s[4:7], s30 offen lds
  s_add_u32 s30, s27, 10240
  s_add_u32 m0, s35, 1024
  s_nop 0
  buffer_load_dwordx4 v2, s[4:7], s30 offen lds
  s_add_u32 s30, s27, 20480
  s_add_u32 m0, s35, 2048
  s_nop 0
  buffer_load_dwordx4 v1, s[4:7], s30 offen lds
  s_add_u32 s30, s27, 30720
  s_add_u32 m0, s35, 3072
  s_nop 0
  buffer_load_dwordx4 v2, s[4:7], s30 offen lds
  s_add_u32 s30, s27, 128
  s_add_u32 m0, s35, 16384
  s_nop 0
  buffer_load_dwordx4 v1, s[4:7], s30 offen lds
  s_add_u32 s30, s27, 10368
  s_add_u32 m0, s35, 17408
  s_nop 0
  buffer_load_dwordx4 v2, s[4:7], s30 offen lds
  s_add_u32 s30, s27, 20608
  s_add_u32 m0, s35, 18432
  s_nop 0
  buffer_load_dwordx4 v1, s[4:7], s30 offen lds
  s_add_u32 s30, s27, 30848
  s_add_u32 m0, s35, 19456
  s_nop 0
  buffer_load_dwordx4 v2, s[4:7], s30 offen lds
  s_add_u32 s30, s27, 256
  s_add_u32 m0, s35, 32768
  s_nop 0
  buffer_load_dwordx4 v1, s[4:7], s30 offen lds
  s_add_u32 s30, s27, 10496
  s_add_u32 m0, s35, 33792
  s_nop 0
  buffer_load_dwordx4 v2, s[4:7], s30 offen lds
  s_add_u32 s30, s27, 20736
  s_add_u32 m0, s35, 34816
  s_nop 0
  buffer_load_dwordx4 v1, s[4:7], s30 offen lds
  s_add_u32 s30, s27, 30976
  s_add_u32 m0, s35, 35840
  s_nop 0
  buffer_load_dwordx4 v2, s[4:7], s30 offen lds
  s_add_u32 s30, s27, 384
  s_add_u32 m0, s35, 49152
  s_nop 0
  buffer_load_dwordx4 v1, s[4:7], s30 offen lds
  s_add_u32 s30, s27, 10624
  s_add_u32 m0, s35, 50176
  s_nop 0
  buffer_load_dwordx4 v2, s[4:7], s30 offen lds
  s_add_u32 s30, s27, 20864
  s_add_u32 m0, s35, 51200
  s_nop 0
  buffer_load_dwordx4 v1, s[4:7], s30 offen lds
  s_add_u32 s30, s27, 31104
  s_add_u32 m0, s35, 52224
  s_nop 0
  buffer_load_dwordx4 v2, s[4:7], s30 offen lds
  s_mov_b32 s40, s50
  v_bfe_u32 v22, v0, 4, 1
  v_lshlrev_b32 v22, 10, v22
  v_and_b32 v23, 15, v0
  v_lshlrev_b32 v23, 4, v23
  v_add_u32 v22, v22, v23
  v_lshrrev_b32 v23, 5, v0
  v_lshlrev_b32 v23, 9, v23
  v_add_u32 v22, v22, v23
  s_lshl_b32 s45, s40, 2
  s_lshl_b32 s46, s25, 1
  s_add_u32 s45, s45, s46
  s_lshl_b32 s45, s45, 18
  s_lshl_b32 s46, s43, 13
  s_add_u32 s45, s45, s46
  s_lshl_b32 s46, s26, 12
  s_add_u32 s45, s45, s46
  s_add_u32 s45, s45, 37748736
  v_cvt_pk_bf16_f32 v32, v64, v65
  v_cvt_pk_bf16_f32 v33, v66, v67
  v_cvt_pk_bf16_f32 v34, v68, v69
  v_cvt_pk_bf16_f32 v35, v70, v71
  v_cvt_pk_bf16_f32 v36, v72, v73
  v_cvt_pk_bf16_f32 v37, v74, v75
  v_cvt_pk_bf16_f32 v38, v76, v77
  v_cvt_pk_bf16_f32 v39, v78, v79
  s_add_u32 s47, s45, 0
  buffer_store_dwordx4 v[32:35], v22, s[4:7], s47 offen sc1
  buffer_store_dwordx4 v[36:39], v22, s[4:7], s47 offen offset:256 sc1
  v_cvt_pk_bf16_f32 v40, v80, v81
  v_cvt_pk_bf16_f32 v41, v82, v83
  v_cvt_pk_bf16_f32 v42, v84, v85
  v_cvt_pk_bf16_f32 v43, v86, v87
  v_cvt_pk_bf16_f32 v44, v88, v89
  v_cvt_pk_bf16_f32 v45, v90, v91
  v_cvt_pk_bf16_f32 v46, v92, v93
  v_cvt_pk_bf16_f32 v47, v94, v95
  s_add_u32 s47, s45, 2048
  buffer_store_dwordx4 v[40:43], v22, s[4:7], s47 offen sc1
  buffer_store_dwordx4 v[44:47], v22, s[4:7], s47 offen offset:256 sc1
  v_cvt_pk_bf16_f32 v32, v96, v97
  v_cvt_pk_bf16_f32 v33, v98, v99
  v_cvt_pk_bf16_f32 v34, v100, v101
  v_cvt_pk_bf16_f32 v35, v102, v103
  v_cvt_pk_bf16_f32 v36, v104, v105
  v_cvt_pk_bf16_f32 v37, v106, v107
  v_cvt_pk_bf16_f32 v38, v108, v109
  v_cvt_pk_bf16_f32 v39, v110, v111
  s_add_u32 s47, s45, 262144
  buffer_store_dwordx4 v[32:35], v22, s[4:7], s47 offen sc1
  buffer_store_dwordx4 v[36:39], v22, s[4:7], s47 offen offset:256 sc1
  v_cvt_pk_bf16_f32 v40, v112, v113
  v_cvt_pk_bf16_f32 v41, v114, v115
  v_cvt_pk_bf16_f32 v42, v116, v117
  v_cvt_pk_bf16_f32 v43, v118, v119
  v_cvt_pk_bf16_f32 v44, v120, v121
  v_cvt_pk_bf16_f32 v45, v122, v123
  v_cvt_pk_bf16_f32 v46, v124, v125
  v_cvt_pk_bf16_f32 v47, v126, v127
  s_add_u32 s47, s45, 264192
  buffer_store_dwordx4 v[40:43], v22, s[4:7], s47 offen sc1
  buffer_store_dwordx4 v[44:47], v22, s[4:7], s47 offen offset:256 sc1
  s_add_u32 s30, s27, 512
  s_add_u32 m0, s35, 65536
  s_nop 0
  buffer_load_dwordx4 v1, s[4:7], s30 offen lds
  s_add_u32 s30, s27, 10752
  s_add_u32 m0, s35, 66560
  s_nop 0
  buffer_load_dwordx4 v2, s[4:7], s30 offen lds
  s_add_u32 s30, s27, 20992
  s_add_u32 m0, s35, 67584
  s_nop 0
  buffer_load_dwordx4 v1, s[4:7], s30 offen lds
  s_add_u32 s30, s27, 31232
  s_add_u32 m0, s35, 68608
  s_nop 0
  buffer_load_dwordx4 v2, s[4:7], s30 offen lds
  s_add_u32 s30, s27, 640
  s_add_u32 m0, s35, 81920
  s_nop 0
  buffer_load_dwordx4 v1, s[4:7], s30 offen lds
  s_add_u32 s30, s27, 10880
  s_add_u32 m0, s35, 82944
  s_nop 0
  buffer_load_dwordx4 v2, s[4:7], s30 offen lds
  s_add_u32 s30, s27, 21120
  s_add_u32 m0, s35, 83968
  s_nop 0
  buffer_load_dwordx4 v1, s[4:7], s30 offen lds
  s_add_u32 s30, s27, 31360
  s_add_u32 m0, s35, 84992
  s_nop 0
  buffer_load_dwordx4 v2, s[4:7], s30 offen lds
  s_add_u32 s30, s27, 768
  s_add_u32 m0, s35, 98304
  s_nop 0
  buffer_load_dwordx4 v1, s[4:7], s30 offen lds
  s_add_u32 s30, s27, 11008
  s_add_u32 m0, s35, 99328
  s_nop 0
  buffer_load_dwordx4 v2, s[4:7], s30 offen lds
  s_add_u32 s30, s27, 21248
  s_add_u32 m0, s35, 100352
  s_nop 0
  buffer_load_dwordx4 v1, s[4:7], s30 offen lds
  s_add_u32 s30, s27, 31488
  s_add_u32 m0, s35, 101376
  s_nop 0
  buffer_load_dwordx4 v2, s[4:7], s30 offen lds
  s_add_u32 s30, s27, 896
  s_add_u32 m0, s35, 114688
  s_nop 0
  buffer_load_dwordx4 v1, s[4:7], s30 offen lds
  s_add_u32 s30, s27, 11136
  s_add_u32 m0, s35, 115712
  s_nop 0
  buffer_load_dwordx4 v2, s[4:7], s30 offen lds
  s_add_u32 s30, s27, 21376
  s_add_u32 m0, s35, 116736
  s_nop 0
  buffer_load_dwordx4 v1, s[4:7], s30 offen lds
  s_add_u32 s30, s27, 31616
  s_add_u32 m0, s35, 117760
  s_nop 0
  buffer_load_dwordx4 v2, s[4:7], s30 offen lds
  s_lshl_b32 s49, s40, 7
  s_add_u32 s49, s49, 85065728
  s_waitcnt vmcnt(16)
  s_barrier
  v_cmp_eq_u32 vcc, 0, v254
  s_nop 0
  s_and_saveexec_b64 s[56:57], vcc
  s_cbranch_execz sig_4400069
  v_mov_b32 v250, 1
  v_mov_b32 v251, 0
  buffer_atomic_add v250, v251, s[4:7], s49 offen
sig_4400069:
  s_mov_b64 exec, s[56:57]
  s_add_u32 s40, s40, 2
  s_cmp_lt_u32 s40, 16
  s_cbranch_scc1 qs_4400068
  s_waitcnt vmcnt(0)
  s_barrier
  s_nop 0
  s_branch qd_4400061
qq_4400060:
  s_load_dwordx2 s[8:9], s[0:1], 16
  s_mov_b32 s10, 5242880
  s_mov_b32 s11, 0x00020000
  v_mov_b32 v0, v254
  v_lshrrev_b32 v22, 6, v0
  s_nop 0
  v_readfirstlane_b32 s24, v22
  v_and_b32 v0, 63, v0
  s_lshr_b32 s25, s24, 1
  s_and_b32 s26, s24, 1
  v_lshrrev_b32 v22, 3, v0
  s_mov_b32 s30, 1280
  v_mul_lo_u32 v22, v22, s30
  v_and_b32 v23, 7, v0
  v_lshrrev_b32 v24, 4, v0
  v_xor_b32 v23, v23, v24
  v_lshlrev_b32 v24, 4, v23
  v_add_u32 v1, v22, v24
  v_xor_b32 v23, 4, v23
  v_lshlrev_b32 v24, 4, v23
  v_add_u32 v2, v22, v24
  v_lshrrev_b32 v22, 4, v0
  s_mov_b32 s30, 8192
  v_mul_lo_u32 v23, v22, s30
  v_bfe_u32 v24, v0, 2, 2
  v_xor_b32 v24, v24, v22
  v_lshlrev_b32 v24, 6, v24
  v_add_u32 v23, v23, v24
  v_and_b32 v24, 3, v0
  v_lshlrev_b32 v24, 4, v24
  v_add_u32 v3, v23, v24
  v_and_b32 v22, 31, v0
  s_lshl_b32 s30, s25, 6
  v_add_u32 v23, s30, v22
  v_lshlrev_b32 v23, 7, v23
  v_bfe_u32 v24, v0, 1, 3
  v_lshrrev_b32 v25, 5, v0
  v_add_u32 v26, 0, v25
  v_xor_b32 v26, v26, v24
  v_lshlrev_b32 v26, 4, v26
  v_add_u32 v4, v23, v26
  v_add_u32 v8, 65536, v4
  v_add_u32 v26, 2, v25
  v_xor_b32 v26, v26, v24
  v_lshlrev_b32 v26, 4, v26
  v_add_u32 v5, v23, v26
  v_add_u32 v9, 65536, v5
  v_add_u32 v26, 4, v25
  v_xor_b32 v26, v26, v24
  v_lshlrev_b32 v26, 4, v26
  v_add_u32 v6, v23, v26
  v_add_u32 v10, 65536, v6
  v_add_u32 v26, 6, v25
  v_xor_b32 v26, v26, v24
  v_lshlrev_b32 v26, 4, v26
  v_add_u32 v7, v23, v26
  v_add_u32 v11, 65536, v7
  v_lshrrev_b32 v22, 5, v0
  v_lshlrev_b32 v22, 3, v22
  v_bfe_u32 v23, v0, 2, 2
  v_add_u32 v22, v22, v23
  v_lshlrev_b32 v22, 8, v22
  v_bfe_u32 v24, v0, 4, 1
  v_lshlrev_b32 v24, 5, v24
  v_add_u32 v22, v22, v24
  v_and_b32 v24, 3, v0
  v_lshlrev_b32 v24, 3, v24
  v_add_u32 v22, v22, v24
  s_lshl_b32 s30, s26, 1
  s_add_u32 s31, s30, 0
  v_xor_b32 v24, s31, v23
  v_lshlrev_b32 v24, 6, v24
  v_add_u32 v24, v22, v24
  v_add_u32 v16, 131072, v24
  s_add_u32 s31, s30, 1
  v_xor_b32 v24, s31, v23
  v_lshlrev_b32 v24, 6, v24
  v_add_u32 v24, v22, v24
  v_add_u32 v17, 131072, v24
  s_lshl_b32 s35, s24, 12
  s_lshl_b32 s36, s24, 12
  s_add_u32 s36, s36, 131072
  s_lshl_b32 s28, s43, 8
  s_lshl_b32 s31, s24, 17
  s_add_u32 s28, s28, s31
  s_waitcnt lgkmcnt(0)
  s_barrier
  s_add_u32 s30, s28, 0
  s_sub_u32 m0, s36, 131072
  s_nop 0
  buffer_load_dwordx4 v3, s[8:11], s30 offen lds
  s_add_u32 s30, s28, 32768
  s_sub_u32 m0, s36, 130048
  s_nop 0
  buffer_load_dwordx4 v3, s[8:11], s30 offen lds
  s_add_u32 s30, s28, 65536
  s_sub_u32 m0, s36, 129024
  s_nop 0
  buffer_load_dwordx4 v3, s[8:11], s30 offen lds
  s_add_u32 s30, s28, 98304
  s_sub_u32 m0, s36, 128000
  s_nop 0
  buffer_load_dwordx4 v3, s[8:11], s30 offen lds
  s_add_u32 s30, s28, 524288
  s_sub_u32 m0, s36, 114688
  s_nop 0
  buffer_load_dwordx4 v3, s[8:11], s30 offen lds
  s_add_u32 s30, s28, 557056
  s_sub_u32 m0, s36, 113664
  s_nop 0
  buffer_load_dwordx4 v3, s[8:11], s30 offen lds
  s_add_u32 s30, s28, 589824
  s_sub_u32 m0, s36, 112640
  s_nop 0
  buffer_load_dwordx4 v3, s[8:11], s30 offen lds
  s_add_u32 s30, s28, 622592
  s_sub_u32 m0, s36, 111616
  s_nop 0
  buffer_load_dwordx4 v3, s[8:11], s30 offen lds
  s_add_u32 s30, s28, 1048576
  s_sub_u32 m0, s36, 98304
  s_nop 0
  buffer_load_dwordx4 v3, s[8:11], s30 offen lds
  s_add_u32 s30, s28, 1081344
  s_sub_u32 m0, s36, 97280
  s_nop 0
  buffer_load_dwordx4 v3, s[8:11], s30 offen lds
  s_add_u32 s30, s28, 1114112
  s_sub_u32 m0, s36, 96256
  s_nop 0
  buffer_load_dwordx4 v3, s[8:11], s30 offen lds
  s_add_u32 s30, s28, 1146880
  s_sub_u32 m0, s36, 95232
  s_nop 0
  buffer_load_dwordx4 v3, s[8:11], s30 offen lds
  s_add_u32 s30, s28, 1572864
  s_sub_u32 m0, s36, 81920
  s_nop 0
  buffer_load_dwordx4 v3, s[8:11], s30 offen lds
  s_add_u32 s30, s28, 1605632
  s_sub_u32 m0, s36, 80896
  s_nop 0
  buffer_load_dwordx4 v3, s[8:11], s30 offen lds
  s_add_u32 s30, s28, 1638400
  s_sub_u32 m0, s36, 79872
  s_nop 0
  buffer_load_dwordx4 v3, s[8:11], s30 offen lds
  s_add_u32 s30, s28, 1671168
  s_sub_u32 m0, s36, 78848
  s_nop 0
  buffer_load_dwordx4 v3, s[8:11], s30 offen lds
  s_add_u32 s30, s28, 2097152
  s_sub_u32 m0, s36, 65536
  s_nop 0
  buffer_load_dwordx4 v3, s[8:11], s30 offen lds
  s_add_u32 s30, s28, 2129920
  s_sub_u32 m0, s36, 64512
  s_nop 0
  buffer_load_dwordx4 v3, s[8:11], s30 offen lds
  s_add_u32 s30, s28, 2162688
  s_sub_u32 m0, s36, 63488
  s_nop 0
  buffer_load_dwordx4 v3, s[8:11], s30 offen lds
  s_add_u32 s30, s28, 2195456
  s_sub_u32 m0, s36, 62464
  s_nop 0
  buffer_load_dwordx4 v3, s[8:11], s30 offen lds
  s_add_u32 s30, s28, 2621440
  s_sub_u32 m0, s36, 49152
  s_nop 0
  buffer_load_dwordx4 v3, s[8:11], s30 offen lds
  s_add_u32 s30, s28, 2654208
  s_sub_u32 m0, s36, 48128
  s_nop 0
  buffer_load_dwordx4 v3, s[8:11], s30 offen lds
  s_add_u32 s30, s28, 2686976
  s_sub_u32 m0, s36, 47104
  s_nop 0
  buffer_load_dwordx4 v3, s[8:11], s30 offen lds
  s_add_u32 s30, s28, 2719744
  s_sub_u32 m0, s36, 46080
  s_nop 0
  buffer_load_dwordx4 v3, s[8:11], s30 offen lds
  s_add_u32 s30, s28, 3145728
  s_sub_u32 m0, s36, 32768
  s_nop 0
  buffer_load_dwordx4 v3, s[8:11], s30 offen lds
  s_add_u32 s30, s28, 3178496
  s_sub_u32 m0, s36, 31744
  s_nop 0
  buffer_load_dwordx4 v3, s[8:11], s30 offen lds
  s_add_u32 s30, s28, 3211264
  s_sub_u32 m0, s36, 30720
  s_nop 0
  buffer_load_dwordx4 v3, s[8:11], s30 offen lds
  s_add_u32 s30, s28, 3244032
  s_sub_u32 m0, s36, 29696
  s_nop 0
  buffer_load_dwordx4 v3, s[8:11], s30 offen lds
  s_add_u32 s30, s28, 3670016
  s_sub_u32 m0, s36, 16384
  s_nop 0
  buffer_load_dwordx4 v3, s[8:11], s30 offen lds
  s_add_u32 s30, s28, 3702784
  s_sub_u32 m0, s36, 15360
  s_nop 0
  buffer_load_dwordx4 v3, s[8:11], s30 offen lds
  s_add_u32 s30, s28, 3735552
  s_sub_u32 m0, s36, 14336
  s_nop 0
  buffer_load_dwordx4 v3, s[8:11], s30 offen lds
  s_add_u32 s30, s28, 3768320
  s_sub_u32 m0, s36, 13312
  s_nop 0
  buffer_load_dwordx4 v3, s[8:11], s30 offen lds
  s_add_u32 s30, s28, 4194304
  s_add_u32 m0, s36, 0
  s_nop 0
  buffer_load_dwordx4 v3, s[8:11], s30 offen lds
  s_add_u32 s30, s28, 4227072
  s_add_u32 m0, s36, 1024
  s_nop 0
  buffer_load_dwordx4 v3, s[8:11], s30 offen lds
  s_add_u32 s30, s28, 4259840
  s_add_u32 m0, s36, 2048
  s_nop 0
  buffer_load_dwordx4 v3, s[8:11], s30 offen lds
  s_add_u32 s30, s28, 4292608
  s_add_u32 m0, s36, 3072
  s_nop 0
  buffer_load_dwordx4 v3, s[8:11], s30 offen lds
  s_add_u32 s30, s28, 4718592
  s_add_u32 m0, s36, 16384
  s_nop 0
  buffer_load_dwordx4 v3, s[8:11], s30 offen lds
  s_add_u32 s30, s28, 4751360
  s_add_u32 m0, s36, 17408
  s_nop 0
  buffer_load_dwordx4 v3, s[8:11], s30 offen lds
  s_add_u32 s30, s28, 4784128
  s_add_u32 m0, s36, 18432
  s_nop 0
  buffer_load_dwordx4 v3, s[8:11], s30 offen lds
  s_add_u32 s30, s28, 4816896
  s_add_u32 m0, s36, 19456
  s_nop 0
  buffer_load_dwordx4 v3, s[8:11], s30 offen lds
  s_waitcnt vmcnt(36)
  s_barrier
  v_subrev_u32 v22, 131072, v16
  v_subrev_u32 v23, 131072, v17
  ds_read_b64_tr_b16 a[0:1], v22 offset:0
  ds_read_b64_tr_b16 a[2:3], v22 offset:1024
  ds_read_b64_tr_b16 a[4:5], v23 offset:0
  ds_read_b64_tr_b16 a[6:7], v23 offset:1024
  ds_read_b64_tr_b16 a[8:9], v22 offset:4096
  ds_read_b64_tr_b16 a[10:11], v22 offset:5120
  ds_read_b64_tr_b16 a[12:13], v23 offset:4096
  ds_read_b64_tr_b16 a[14:15], v23 offset:5120
  ds_read_b64_tr_b16 a[16:17], v22 offset:8192
  ds_read_b64_tr_b16 a[18:19], v22 offset:9216
  ds_read_b64_tr_b16 a[20:21], v23 offset:8192
  ds_read_b64_tr_b16 a[22:23], v23 offset:9216
  ds_read_b64_tr_b16 a[24:25], v22 offset:12288
  ds_read_b64_tr_b16 a[26:27], v22 offset:13312
  ds_read_b64_tr_b16 a[28:29], v23 offset:12288
  ds_read_b64_tr_b16 a[30:31], v23 offset:13312
  s_waitcnt vmcnt(32)
  s_barrier
  v_subrev_u32 v22, 114688, v16
  v_subrev_u32 v23, 114688, v17
  ds_read_b64_tr_b16 a[32:33], v22 offset:0
  ds_read_b64_tr_b16 a[34:35], v22 offset:1024
  ds_read_b64_tr_b16 a[36:37], v23 offset:0
  ds_read_b64_tr_b16 a[38:39], v23 offset:1024
  ds_read_b64_tr_b16 a[40:41], v22 offset:4096
  ds_read_b64_tr_b16 a[42:43], v22 offset:5120
  ds_read_b64_tr_b16 a[44:45], v23 offset:4096
  ds_read_b64_tr_b16 a[46:47], v23 offset:5120
  ds_read_b64_tr_b16 a[48:49], v22 offset:8192
  ds_read_b64_tr_b16 a[50:51], v22 offset:9216
  ds_read_b64_tr_b16 a[52:53], v23 offset:8192
  ds_read_b64_tr_b16 a[54:55], v23 offset:9216
  ds_read_b64_tr_b16 a[56:57], v22 offset:12288
  ds_read_b64_tr_b16 a[58:59], v22 offset:13312
  ds_read_b64_tr_b16 a[60:61], v23 offset:12288
  ds_read_b64_tr_b16 a[62:63], v23 offset:13312
  s_waitcnt vmcnt(28)
  s_barrier
  v_subrev_u32 v22, 98304, v16
  v_subrev_u32 v23, 98304, v17
  ds_read_b64_tr_b16 a[64:65], v22 offset:0
  ds_read_b64_tr_b16 a[66:67], v22 offset:1024
  ds_read_b64_tr_b16 a[68:69], v23 offset:0
  ds_read_b64_tr_b16 a[70:71], v23 offset:1024
  ds_read_b64_tr_b16 a[72:73], v22 offset:4096
  ds_read_b64_tr_b16 a[74:75], v22 offset:5120
  ds_read_b64_tr_b16 a[76:77], v23 offset:4096
  ds_read_b64_tr_b16 a[78:79], v23 offset:5120
  ds_read_b64_tr_b16 a[80:81], v22 offset:8192
  ds_read_b64_tr_b16 a[82:83], v22 offset:9216
  ds_read_b64_tr_b16 a[84:85], v23 offset:8192
  ds_read_b64_tr_b16 a[86:87], v23 offset:9216
  ds_read_b64_tr_b16 a[88:89], v22 offset:12288
  ds_read_b64_tr_b16 a[90:91], v22 offset:13312
  ds_read_b64_tr_b16 a[92:93], v23 offset:12288
  ds_read_b64_tr_b16 a[94:95], v23 offset:13312
  s_waitcnt vmcnt(24)
  s_barrier
  v_subrev_u32 v22, 81920, v16
  v_subrev_u32 v23, 81920, v17
  ds_read_b64_tr_b16 a[96:97], v22 offset:0
  ds_read_b64_tr_b16 a[98:99], v22 offset:1024
  ds_read_b64_tr_b16 a[100:101], v23 offset:0
  ds_read_b64_tr_b16 a[102:103], v23 offset:1024
  ds_read_b64_tr_b16 a[104:105], v22 offset:4096
  ds_read_b64_tr_b16 a[106:107], v22 offset:5120
  ds_read_b64_tr_b16 a[108:109], v23 offset:4096
  ds_read_b64_tr_b16 a[110:111], v23 offset:5120
  ds_read_b64_tr_b16 a[112:113], v22 offset:8192
  ds_read_b64_tr_b16 a[114:115], v22 offset:9216
  ds_read_b64_tr_b16 a[116:117], v23 offset:8192
  ds_read_b64_tr_b16 a[118:119], v23 offset:9216
  ds_read_b64_tr_b16 a[120:121], v22 offset:12288
  ds_read_b64_tr_b16 a[122:123], v22 offset:13312
  ds_read_b64_tr_b16 a[124:125], v23 offset:12288
  ds_read_b64_tr_b16 a[126:127], v23 offset:13312
  s_waitcnt vmcnt(20)
  s_barrier
  v_subrev_u32 v22, 65536, v16
  v_subrev_u32 v23, 65536, v17
  ds_read_b64_tr_b16 a[128:129], v22 offset:0
  ds_read_b64_tr_b16 a[130:131], v22 offset:1024
  ds_read_b64_tr_b16 a[132:133], v23 offset:0
  ds_read_b64_tr_b16 a[134:135], v23 offset:1024
  ds_read_b64_tr_b16 a[136:137], v22 offset:4096
  ds_read_b64_tr_b16 a[138:139], v22 offset:5120
  ds_read_b64_tr_b16 a[140:141], v23 offset:4096
  ds_read_b64_tr_b16 a[142:143], v23 offset:5120
  ds_read_b64_tr_b16 a[144:145], v22 offset:8192
  ds_read_b64_tr_b16 a[146:147], v22 offset:9216
  ds_read_b64_tr_b16 a[148:149], v23 offset:8192
  ds_read_b64_tr_b16 a[150:151], v23 offset:9216
  ds_read_b64_tr_b16 a[152:153], v22 offset:12288
  ds_read_b64_tr_b16 a[154:155], v22 offset:13312
  ds_read_b64_tr_b16 a[156:157], v23 offset:12288
  ds_read_b64_tr_b16 a[158:159], v23 offset:13312
  s_waitcnt vmcnt(16)
  s_barrier
  v_subrev_u32 v22, 49152, v16
  v_subrev_u32 v23, 49152, v17
  ds_read_b64_tr_b16 a[160:161], v22 offset:0
  ds_read_b64_tr_b16 a[162:163], v22 offset:1024
  ds_read_b64_tr_b16 a[164:165], v23 offset:0
  ds_read_b64_tr_b16 a[166:167], v23 offset:1024
  ds_read_b64_tr_b16 a[168:169], v22 offset:4096
  ds_read_b64_tr_b16 a[170:171], v22 offset:5120
  ds_read_b64_tr_b16 a[172:173], v23 offset:4096
  ds_read_b64_tr_b16 a[174:175], v23 offset:5120
  ds_read_b64_tr_b16 a[176:177], v22 offset:8192
  ds_read_b64_tr_b16 a[178:179], v22 offset:9216
  ds_read_b64_tr_b16 a[180:181], v23 offset:8192
  ds_read_b64_tr_b16 a[182:183], v23 offset:9216
  ds_read_b64_tr_b16 a[184:185], v22 offset:12288
  ds_read_b64_tr_b16 a[186:187], v22 offset:13312
  ds_read_b64_tr_b16 a[188:189], v23 offset:12288
  ds_read_b64_tr_b16 a[190:191], v23 offset:13312
  s_waitcnt vmcnt(12)
  s_barrier
  v_subrev_u32 v22, 32768, v16
  v_subrev_u32 v23, 32768, v17
  ds_read_b64_tr_b16 a[192:193], v22 offset:0
  ds_read_b64_tr_b16 a[194:195], v22 offset:1024
  ds_read_b64_tr_b16 a[196:197], v23 offset:0
  ds_read_b64_tr_b16 a[198:199], v23 offset:1024
  ds_read_b64_tr_b16 a[200:201], v22 offset:4096
  ds_read_b64_tr_b16 a[202:203], v22 offset:5120
  ds_read_b64_tr_b16 a[204:205], v23 offset:4096
  ds_read_b64_tr_b16 a[206:207], v23 offset:5120
  ds_read_b64_tr_b16 a[208:209], v22 offset:8192
  ds_read_b64_tr_b16 a[210:211], v22 offset:9216
  ds_read_b64_tr_b16 a[212:213], v23 offset:8192
  ds_read_b64_tr_b16 a[214:215], v23 offset:9216
  ds_read_b64_tr_b16 a[216:217], v22 offset:12288
  ds_read_b64_tr_b16 a[218:219], v22 offset:13312
  ds_read_b64_tr_b16 a[220:221], v23 offset:12288
  ds_read_b64_tr_b16 a[222:223], v23 offset:13312
  s_waitcnt vmcnt(8)
  s_barrier
  v_subrev_u32 v22, 16384, v16
  v_subrev_u32 v23, 16384, v17
  ds_read_b64_tr_b16 a[224:225], v22 offset:0
  ds_read_b64_tr_b16 a[226:227], v22 offset:1024
  ds_read_b64_tr_b16 a[228:229], v23 offset:0
  ds_read_b64_tr_b16 a[230:231], v23 offset:1024
  ds_read_b64_tr_b16 a[232:233], v22 offset:4096
  ds_read_b64_tr_b16 a[234:235], v22 offset:5120
  ds_read_b64_tr_b16 a[236:237], v23 offset:4096
  ds_read_b64_tr_b16 a[238:239], v23 offset:5120
  ds_read_b64_tr_b16 a[240:241], v22 offset:8192
  ds_read_b64_tr_b16 a[242:243], v22 offset:9216
  ds_read_b64_tr_b16 a[244:245], v23 offset:8192
  ds_read_b64_tr_b16 a[246:247], v23 offset:9216
  ds_read_b64_tr_b16 a[248:249], v22 offset:12288
  ds_read_b64_tr_b16 a[250:251], v22 offset:13312
  ds_read_b64_tr_b16 a[252:253], v23 offset:12288
  ds_read_b64_tr_b16 a[254:255], v23 offset:13312
  s_waitcnt vmcnt(4)
  s_barrier
  v_add_u32 v22, 0, v16
  v_add_u32 v23, 0, v17
  ds_read_b64_tr_b16 v[128:129], v22 offset:0
  ds_read_b64_tr_b16 v[130:131], v22 offset:1024
  ds_read_b64_tr_b16 v[132:133], v23 offset:0
  ds_read_b64_tr_b16 v[134:135], v23 offset:1024
  ds_read_b64_tr_b16 v[136:137], v22 offset:4096
  ds_read_b64_tr_b16 v[138:139], v22 offset:5120
  ds_read_b64_tr_b16 v[140:141], v23 offset:4096
  ds_read_b64_tr_b16 v[142:143], v23 offset:5120
  ds_read_b64_tr_b16 v[144:145], v22 offset:8192
  ds_read_b64_tr_b16 v[146:147], v22 offset:9216
  ds_read_b64_tr_b16 v[148:149], v23 offset:8192
  ds_read_b64_tr_b16 v[150:151], v23 offset:9216
  ds_read_b64_tr_b16 v[152:153], v22 offset:12288
  ds_read_b64_tr_b16 v[154:155], v22 offset:13312
  ds_read_b64_tr_b16 v[156:157], v23 offset:12288
  ds_read_b64_tr_b16 v[158:159], v23 offset:13312
  s_waitcnt vmcnt(0)
  s_barrier
  v_add_u32 v22, 16384, v16
  v_add_u32 v23, 16384, v17
  ds_read_b64_tr_b16 v[160:161], v22 offset:0
  ds_read_b64_tr_b16 v[162:163], v22 offset:1024
  ds_read_b64_tr_b16 v[164:165], v23 offset:0
  ds_read_b64_tr_b16 v[166:167], v23 offset:1024
  ds_read_b64_tr_b16 v[168:169], v22 offset:4096
  ds_read_b64_tr_b16 v[170:171], v22 offset:5120
  ds_read_b64_tr_b16 v[172:173], v23 offset:4096
  ds_read_b64_tr_b16 v[174:175], v23 offset:5120
  ds_read_b64_tr_b16 v[176:177], v22 offset:8192
  ds_read_b64_tr_b16 v[178:179], v22 offset:9216
  ds_read_b64_tr_b16 v[180:181], v23 offset:8192
  ds_read_b64_tr_b16 v[182:183], v23 offset:9216
  ds_read_b64_tr_b16 v[184:185], v22 offset:12288
  ds_read_b64_tr_b16 v[186:187], v22 offset:13312
  ds_read_b64_tr_b16 v[188:189], v23 offset:12288
  ds_read_b64_tr_b16 v[190:191], v23 offset:13312
  s_waitcnt lgkmcnt(0)
  s_barrier
  v_and_b32 v251, 15, v0
  v_lshlrev_b32 v251, 2, v251
l1b_4400070:
  buffer_load_dword v250, v251, s[84:87], 0 offen offset:128 sc1
  s_waitcnt vmcnt(0)
  v_cmp_gt_u32 vcc, 8, v250
  s_nop 1
  s_cbranch_vccz l1bok_4400071
  s_add_u32 s63, s63, 1
  s_cmp_gt_u32 s63, 4194304
  s_cbranch_scc1 fz_fail
  s_sleep 3
  s_branch l1b_4400070
l1bok_4400071:
  s_barrier
  s_lshl_b32 s30, s40, 7
  s_lshl_b32 s31, s24, 5
  s_add_u32 s30, s30, s31
  s_mul_i32 s27, s30, 1280
  s_add_u32 s27, s27, 0
  s_add_u32 s30, s27, 0
  s_add_u32 m0, s35, 0
  s_nop 0
  buffer_load_dwordx4 v1, s[4:7], s30 offen lds
  s_add_u32 s30, s27, 10240
  s_add_u32 m0, s35, 1024
  s_nop 0
  buffer_load_dwordx4 v2, s[4:7], s30 offen lds
  s_add_u32 s30, s27, 20480
  s_add_u32 m0, s35, 2048
  s_nop 0
  buffer_load_dwordx4 v1, s[4:7], s30 offen lds
  s_add_u32 s30, s27, 30720
  s_add_u32 m0, s35, 3072
  s_nop 0
  buffer_load_dwordx4 v2, s[4:7], s30 offen lds
  s_add_u32 s30, s27, 128
  s_add_u32 m0, s35, 16384
  s_nop 0
  buffer_load_dwordx4 v1, s[4:7], s30 offen lds
  s_add_u32 s30, s27, 10368
  s_add_u32 m0, s35, 17408
  s_nop 0
  buffer_load_dwordx4 v2, s[4:7], s30 offen lds
  s_add_u32 s30, s27, 20608
  s_add_u32 m0, s35, 18432
  s_nop 0
  buffer_load_dwordx4 v1, s[4:7], s30 offen lds
  s_add_u32 s30, s27, 30848
  s_add_u32 m0, s35, 19456
  s_nop 0
  buffer_load_dwordx4 v2, s[4:7], s30 offen lds
  s_add_u32 s30, s27, 256
  s_add_u32 m0, s35, 32768
  s_nop 0
  buffer_load_dwordx4 v1, s[4:7], s30 offen lds
  s_add_u32 s30, s27, 10496
  s_add_u32 m0, s35, 33792
  s_nop 0
  buffer_load_dwordx4 v2, s[4:7], s30 offen lds
  s_add_u32 s30, s27, 20736
  s_add_u32 m0, s35, 34816
  s_nop 0
  buffer_load_dwordx4 v1, s[4:7], s30 offen lds
  s_add_u32 s30, s27, 30976
  s_add_u32 m0, s35, 35840
  s_nop 0
  buffer_load_dwordx4 v2, s[4:7], s30 offen lds
  s_add_u32 s30, s27, 384
  s_add_u32 m0, s35, 49152
  s_nop 0
  buffer_load_dwordx4 v1, s[4:7], s30 offen lds
  s_add_u32 s30, s27, 10624
  s_add_u32 m0, s35, 50176
  s_nop 0
  buffer_load_dwordx4 v2, s[4:7], s30 offen lds
  s_add_u32 s30, s27, 20864
  s_add_u32 m0, s35, 51200
  s_nop 0
  buffer_load_dwordx4 v1, s[4:7], s30 offen lds
  s_add_u32 s30, s27, 31104
  s_add_u32 m0, s35, 52224
  s_nop 0
  buffer_load_dwordx4 v2, s[4:7], s30 offen lds
  s_add_u32 s30, s27, 512
  s_add_u32 m0, s35, 65536
  s_nop 0
  buffer_load_dwordx4 v1, s[4:7], s30 offen lds
  s_add_u32 s30, s27, 10752
  s_add_u32 m0, s35, 66560
  s_nop 0
  buffer_load_dwordx4 v2, s[4:7], s30 offen lds
  s_add_u32 s30, s27, 20992
  s_add_u32 m0, s35, 67584
  s_nop 0
  buffer_load_dwordx4 v1, s[4:7], s30 offen lds
  s_add_u32 s30, s27, 31232
  s_add_u32 m0, s35, 68608
  s_nop 0
  buffer_load_dwordx4 v2, s[4:7], s30 offen lds
  s_add_u32 s30, s27, 640
  s_add_u32 m0, s35, 81920
  s_nop 0
  buffer_load_dwordx4 v1, s[4:7], s30 offen lds
  s_add_u32 s30, s27, 10880
  s_add_u32 m0, s35, 82944
  s_nop 0
  buffer_load_dwordx4 v2, s[4:7], s30 offen lds
  s_add_u32 s30, s27, 21120
  s_add_u32 m0, s35, 83968
  s_nop 0
  buffer_load_dwordx4 v1, s[4:7], s30 offen lds
  s_add_u32 s30, s27, 31360
  s_add_u32 m0, s35, 84992
  s_nop 0
  buffer_load_dwordx4 v2, s[4:7], s30 offen lds
  s_add_u32 s30, s27, 768
  s_add_u32 m0, s35, 98304
  s_nop 0
  buffer_load_dwordx4 v1, s[4:7], s30 offen lds
  s_add_u32 s30, s27, 11008
  s_add_u32 m0, s35, 99328
  s_nop 0
  buffer_load_dwordx4 v2, s[4:7], s30 offen lds
  s_add_u32 s30, s27, 21248
  s_add_u32 m0, s35, 100352
  s_nop 0
  buffer_load_dwordx4 v1, s[4:7], s30 offen lds
  s_add_u32 s30, s27, 31488
  s_add_u32 m0, s35, 101376
  s_nop 0
  buffer_load_dwordx4 v2, s[4:7], s30 offen lds
  s_add_u32 s30, s27, 896
  s_add_u32 m0, s35, 114688
  s_nop 0
  buffer_load_dwordx4 v1, s[4:7], s30 offen lds
  s_add_u32 s30, s27, 11136
  s_add_u32 m0, s35, 115712
  s_nop 0
  buffer_load_dwordx4 v2, s[4:7], s30 offen lds
  s_add_u32 s30, s27, 21376
  s_add_u32 m0, s35, 116736
  s_nop 0
  buffer_load_dwordx4 v1, s[4:7], s30 offen lds
  s_add_u32 s30, s27, 31616
  s_add_u32 m0, s35, 117760
  s_nop 0
  buffer_load_dwordx4 v2, s[4:7], s30 offen lds
qs_4400072:
  v_mov_b64 v[64:65], 0
  v_mov_b64 v[66:67], 0
  v_mov_b64 v[68:69], 0
  v_mov_b64 v[70:71], 0
  v_mov_b64 v[72:73], 0
  v_mov_b64 v[74:75], 0
  v_mov_b64 v[76:77], 0
  v_mov_b64 v[78:79], 0
  v_mov_b64 v[80:81], 0
  v_mov_b64 v[82:83], 0
  v_mov_b64 v[84:85], 0
  v_mov_b64 v[86:87], 0
  v_mov_b64 v[88:89], 0
  v_mov_b64 v[90:91], 0
  v_mov_b64 v[92:93], 0
  v_mov_b64 v[94:95], 0
  v_mov_b64 v[96:97], 0
  v_mov_b64 v[98:99], 0
  v_mov_b64 v[100:101], 0
  v_mov_b64 v[102:103], 0
  v_mov_b64 v[104:105], 0
  v_mov_b64 v[106:107], 0
  v_mov_b64 v[108:109], 0
  v_mov_b64 v[110:111], 0
  v_mov_b64 v[112:113], 0
  v_mov_b64 v[114:115], 0
  v_mov_b64 v[116:117], 0
  v_mov_b64 v[118:119], 0
  v_mov_b64 v[120:121], 0
  v_mov_b64 v[122:123], 0
  v_mov_b64 v[124:125], 0
  v_mov_b64 v[126:127], 0
  s_waitcnt vmcnt(28) lgkmcnt(0)
  s_barrier
  ds_read_b128 v[32:35], v4 offset:0
  ds_read_b128 v[36:39], v4 offset:4096
  s_waitcnt lgkmcnt(0)
  ds_read_b128 v[40:43], v5 offset:0
  v_mfma_f32_32x32x16_bf16 v[64:79], a[0:3], v[32:35], v[64:79]
  ds_read_b128 v[44:47], v5 offset:4096
  v_mfma_f32_32x32x16_bf16 v[80:95], a[4:7], v[32:35], v[80:95]
  v_mfma_f32_32x32x16_bf16 v[96:111], a[0:3], v[36:39], v[96:111]
  v_mfma_f32_32x32x16_bf16 v[112:127], a[4:7], v[36:39], v[112:127]
  s_waitcnt lgkmcnt(0)
  ds_read_b128 v[32:35], v6 offset:0
  v_mfma_f32_32x32x16_bf16 v[64:79], a[8:11], v[40:43], v[64:79]
  ds_read_b128 v[36:39], v6 offset:4096
  v_mfma_f32_32x32x16_bf16 v[80:95], a[12:15], v[40:43], v[80:95]
  v_mfma_f32_32x32x16_bf16 v[96:111], a[8:11], v[44:47], v[96:111]
  v_mfma_f32_32x32x16_bf16 v[112:127], a[12:15], v[44:47], v[112:127]
  s_waitcnt lgkmcnt(0)
  ds_read_b128 v[40:43], v7 offset:0
  v_mfma_f32_32x32x16_bf16 v[64:79], a[16:19], v[32:35], v[64:79]
  ds_read_b128 v[44:47], v7 offset:4096
  v_mfma_f32_32x32x16_bf16 v[80:95], a[20:23], v[32:35], v[80:95]
  v_mfma_f32_32x32x16_bf16 v[96:111], a[16:19], v[36:39], v[96:111]
  v_mfma_f32_32x32x16_bf16 v[112:127], a[20:23], v[36:39], v[112:127]
  s_waitcnt vmcnt(24) lgkmcnt(0)
  s_barrier
  ds_read_b128 v[32:35], v4 offset:16384
  v_mfma_f32_32x32x16_bf16 v[64:79], a[24:27], v[40:43], v[64:79]
  ds_read_b128 v[36:39], v4 offset:20480
  v_mfma_f32_32x32x16_bf16 v[80:95], a[28:31], v[40:43], v[80:95]
  v_mfma_f32_32x32x16_bf16 v[96:111], a[24:27], v[44:47], v[96:111]
  v_mfma_f32_32x32x16_bf16 v[112:127], a[28:31], v[44:47], v[112:127]
  s_add_u32 s30, s27, 1024
  s_add_u32 m0, s35, 0
  s_nop 0
  buffer_load_dwordx4 v1, s[4:7], s30 offen lds
  s_add_u32 s30, s27, 11264
  s_add_u32 m0, s35, 1024
  s_nop 0
  buffer_load_dwordx4 v2, s[4:7], s30 offen lds
  s_add_u32 s30, s27, 21504
  s_add_u32 m0, s35, 2048
  s_nop 0
  buffer_load_dwordx4 v1, s[4:7], s30 offen lds
  s_add_u32 s30, s27, 31744
  s_add_u32 m0, s35, 3072
  s_nop 0
  buffer_load_dwordx4 v2, s[4:7], s30 offen lds
  s_waitcnt lgkmcnt(0)
  ds_read_b128 v[40:43], v5 offset:16384
  v_mfma_f32_32x32x16_bf16 v[64:79], a[32:35], v[32:35], v[64:79]
  ds_read_b128 v[44:47], v5 offset:20480
  v_mfma_f32_32x32x16_bf16 v[80:95], a[36:39], v[32:35], v[80:95]
  v_mfma_f32_32x32x16_bf16 v[96:111], a[32:35], v[36:39], v[96:111]
  v_mfma_f32_32x32x16_bf16 v[112:127], a[36:39], v[36:39], v[112:127]
  s_waitcnt lgkmcnt(0)
  ds_read_b128 v[32:35], v6 offset:16384
  v_mfma_f32_32x32x16_bf16 v[64:79], a[40:43], v[40:43], v[64:79]
  ds_read_b128 v[36:39], v6 offset:20480
  v_mfma_f32_32x32x16_bf16 v[80:95], a[44:47], v[40:43], v[80:95]
  v_mfma_f32_32x32x16_bf16 v[96:111], a[40:43], v[44:47], v[96:111]
  v_mfma_f32_32x32x16_bf16 v[112:127], a[44:47], v[44:47], v[112:127]
  s_waitcnt lgkmcnt(0)
  ds_read_b128 v[40:43], v7 offset:16384
  v_mfma_f32_32x32x16_bf16 v[64:79], a[48:51], v[32:35], v[64:79]
  ds_read_b128 v[44:47], v7 offset:20480
  v_mfma_f32_32x32x16_bf16 v[80:95], a[52:55], v[32:35], v[80:95]
  v_mfma_f32_32x32x16_bf16 v[96:111], a[48:51], v[36:39], v[96:111]
  v_mfma_f32_32x32x16_bf16 v[112:127], a[52:55], v[36:39], v[112:127]
  s_waitcnt vmcnt(24) lgkmcnt(0)
  s_barrier
  ds_read_b128 v[32:35], v4 offset:32768
  v_mfma_f32_32x32x16_bf16 v[64:79], a[56:59], v[40:43], v[64:79]
  ds_read_b128 v[36:39], v4 offset:36864
  v_mfma_f32_32x32x16_bf16 v[80:95], a[60:63], v[40:43], v[80:95]
  v_mfma_f32_32x32x16_bf16 v[96:111], a[56:59], v[44:47], v[96:111]
  v_mfma_f32_32x32x16_bf16 v[112:127], a[60:63], v[44:47], v[112:127]
  s_add_u32 s30, s27, 1152
  s_add_u32 m0, s35, 16384
  s_nop 0
  buffer_load_dwordx4 v1, s[4:7], s30 offen lds
  s_add_u32 s30, s27, 11392
  s_add_u32 m0, s35, 17408
  s_nop 0
  buffer_load_dwordx4 v2, s[4:7], s30 offen lds
  s_add_u32 s30, s27, 21632
  s_add_u32 m0, s35, 18432
  s_nop 0
  buffer_load_dwordx4 v1, s[4:7], s30 offen lds
  s_add_u32 s30, s27, 31872
  s_add_u32 m0, s35, 19456
  s_nop 0
  buffer_load_dwordx4 v2, s[4:7], s30 offen lds
  s_waitcnt lgkmcnt(0)
  ds_read_b128 v[40:43], v5 offset:32768
  v_mfma_f32_32x32x16_bf16 v[64:79], a[64:67], v[32:35], v[64:79]
  ds_read_b128 v[44:47], v5 offset:36864
  v_mfma_f32_32x32x16_bf16 v[80:95], a[68:71], v[32:35], v[80:95]
  v_mfma_f32_32x32x16_bf16 v[96:111], a[64:67], v[36:39], v[96:111]
  v_mfma_f32_32x32x16_bf16 v[112:127], a[68:71], v[36:39], v[112:127]
  s_waitcnt lgkmcnt(0)
  ds_read_b128 v[32:35], v6 offset:32768
  v_mfma_f32_32x32x16_bf16 v[64:79], a[72:75], v[40:43], v[64:79]
  ds_read_b128 v[36:39], v6 offset:36864
  v_mfma_f32_32x32x16_bf16 v[80:95], a[76:79], v[40:43], v[80:95]
  v_mfma_f32_32x32x16_bf16 v[96:111], a[72:75], v[44:47], v[96:111]
  v_mfma_f32_32x32x16_bf16 v[112:127], a[76:79], v[44:47], v[112:127]
  s_waitcnt lgkmcnt(0)
  ds_read_b128 v[40:43], v7 offset:32768
  v_mfma_f32_32x32x16_bf16 v[64:79], a[80:83], v[32:35], v[64:79]
  ds_read_b128 v[44:47], v7 offset:36864
  v_mfma_f32_32x32x16_bf16 v[80:95], a[84:87], v[32:35], v[80:95]
  v_mfma_f32_32x32x16_bf16 v[96:111], a[80:83], v[36:39], v[96:111]
  v_mfma_f32_32x32x16_bf16 v[112:127], a[84:87], v[36:39], v[112:127]
  s_waitcnt vmcnt(24) lgkmcnt(0)
  s_barrier
  ds_read_b128 v[32:35], v4 offset:49152
  v_mfma_f32_32x32x16_bf16 v[64:79], a[88:91], v[40:43], v[64:79]
  ds_read_b128 v[36:39], v4 offset:53248
  v_mfma_f32_32x32x16_bf16 v[80:95], a[92:95], v[40:43], v[80:95]
  v_mfma_f32_32x32x16_bf16 v[96:111], a[88:91], v[44:47], v[96:111]
  v_mfma_f32_32x32x16_bf16 v[112:127], a[92:95], v[44:47], v[112:127]
  s_waitcnt lgkmcnt(0)
  ds_read_b128 v[40:43], v5 offset:49152
  v_mfma_f32_32x32x16_bf16 v[64:79], a[96:99], v[32:35], v[64:79]
  ds_read_b128 v[44:47], v5 offset:53248
  v_mfma_f32_32x32x16_bf16 v[80:95], a[100:103], v[32:35], v[80:95]
  v_mfma_f32_32x32x16_bf16 v[96:111], a[96:99], v[36:39], v[96:111]
  v_mfma_f32_32x32x16_bf16 v[112:127], a[100:103], v[36:39], v[112:127]
  s_waitcnt lgkmcnt(0)
  ds_read_b128 v[32:35], v6 offset:49152
  v_mfma_f32_32x32x16_bf16 v[64:79], a[104:107], v[40:43], v[64:79]
  ds_read_b128 v[36:39], v6 offset:53248
  v_mfma_f32_32x32x16_bf16 v[80:95], a[108:111], v[40:43], v[80:95]
  v_mfma_f32_32x32x16_bf16 v[96:111], a[104:107], v[44:47], v[96:111]
  v_mfma_f32_32x32x16_bf16 v[112:127], a[108:111], v[44:47], v[112:127]
  s_waitcnt lgkmcnt(0)
  ds_read_b128 v[40:43], v7 offset:49152
  v_mfma_f32_32x32x16_bf16 v[64:79], a[112:115], v[32:35], v[64:79]
  ds_read_b128 v[44:47], v7 offset:53248
  v_mfma_f32_32x32x16_bf16 v[80:95], a[116:119], v[32:35], v[80:95]
  v_mfma_f32_32x32x16_bf16 v[96:111], a[112:115], v[36:39], v[96:111]
  v_mfma_f32_32x32x16_bf16 v[112:127], a[116:119], v[36:39], v[112:127]
  s_waitcnt vmcnt(20) lgkmcnt(0)
  s_barrier
  ds_read_b128 v[32:35], v8 offset:0
  v_mfma_f32_32x32x16_bf16 v[64:79], a[120:123], v[40:43], v[64:79]
  ds_read_b128 v[36:39], v8 offset:4096
  v_mfma_f32_32x32x16_bf16 v[80:95], a[124:127], v[40:43], v[80:95]
  v_mfma_f32_32x32x16_bf16 v[96:111], a[120:123], v[44:47], v[96:111]
  v_mfma_f32_32x32x16_bf16 v[112:127], a[124:127], v[44:47], v[112:127]
  s_waitcnt lgkmcnt(0)
  ds_read_b128 v[40:43], v9 offset:0
  v_mfma_f32_32x32x16_bf16 v[64:79], a[128:131], v[32:35], v[64:79]
  ds_read_b128 v[44:47], v9 offset:4096
  v_mfma_f32_32x32x16_bf16 v[80:95], a[132:135], v[32:35], v[80:95]
  v_mfma_f32_32x32x16_bf16 v[96:111], a[128:131], v[36:39], v[96:111]
  v_mfma_f32_32x32x16_bf16 v[112:127], a[132:135], v[36:39], v[112:127]
  s_waitcnt lgkmcnt(0)
  ds_read_b128 v[32:35], v10 offset:0
  v_mfma_f32_32x32x16_bf16 v[64:79], a[136:139], v[40:43], v[64:79]
  ds_read_b128 v[36:39], v10 offset:4096
  v_mfma_f32_32x32x16_bf16 v[80:95], a[140:143], v[40:43], v[80:95]
  v_mfma_f32_32x32x16_bf16 v[96:111], a[136:139], v[44:47], v[96:111]
  v_mfma_f32_32x32x16_bf16 v[112:127], a[140:143], v[44:47], v[112:127]
  s_waitcnt lgkmcnt(0)
  ds_read_b128 v[40:43], v11 offset:0
  v_mfma_f32_32x32x16_bf16 v[64:79], a[144:147], v[32:35], v[64:79]
  ds_read_b128 v[44:47], v11 offset:4096
  v_mfma_f32_32x32x16_bf16 v[80:95], a[148:151], v[32:35], v[80:95]
  v_mfma_f32_32x32x16_bf16 v[96:111], a[144:147], v[36:39], v[96:111]
  v_mfma_f32_32x32x16_bf16 v[112:127], a[148:151], v[36:39], v[112:127]
  s_waitcnt vmcnt(16) lgkmcnt(0)
  s_barrier
  ds_read_b128 v[32:35], v8 offset:16384
  v_mfma_f32_32x32x16_bf16 v[64:79], a[152:155], v[40:43], v[64:79]
  ds_read_b128 v[36:39], v8 offset:20480
  v_mfma_f32_32x32x16_bf16 v[80:95], a[156:159], v[40:43], v[80:95]
  v_mfma_f32_32x32x16_bf16 v[96:111], a[152:155], v[44:47], v[96:111]
  v_mfma_f32_32x32x16_bf16 v[112:127], a[156:159], v[44:47], v[112:127]
  s_waitcnt lgkmcnt(0)
  ds_read_b128 v[40:43], v9 offset:16384
  v_mfma_f32_32x32x16_bf16 v[64:79], a[160:163], v[32:35], v[64:79]
  ds_read_b128 v[44:47], v9 offset:20480
  v_mfma_f32_32x32x16_bf16 v[80:95], a[164:167], v[32:35], v[80:95]
  v_mfma_f32_32x32x16_bf16 v[96:111], a[160:163], v[36:39], v[96:111]
  v_mfma_f32_32x32x16_bf16 v[112:127], a[164:167], v[36:39], v[112:127]
  s_waitcnt lgkmcnt(0)
  ds_read_b128 v[32:35], v10 offset:16384
  v_mfma_f32_32x32x16_bf16 v[64:79], a[168:171], v[40:43], v[64:79]
  ds_read_b128 v[36:39], v10 offset:20480
  v_mfma_f32_32x32x16_bf16 v[80:95], a[172:175], v[40:43], v[80:95]
  v_mfma_f32_32x32x16_bf16 v[96:111], a[168:171], v[44:47], v[96:111]
  v_mfma_f32_32x32x16_bf16 v[112:127], a[172:175], v[44:47], v[112:127]
  s_waitcnt lgkmcnt(0)
  ds_read_b128 v[40:43], v11 offset:16384
  v_mfma_f32_32x32x16_bf16 v[64:79], a[176:179], v[32:35], v[64:79]
  ds_read_b128 v[44:47], v11 offset:20480
  v_mfma_f32_32x32x16_bf16 v[80:95], a[180:183], v[32:35], v[80:95]
  v_mfma_f32_32x32x16_bf16 v[96:111], a[176:179], v[36:39], v[96:111]
  v_mfma_f32_32x32x16_bf16 v[112:127], a[180:183], v[36:39], v[112:127]
  s_waitcnt vmcnt(12) lgkmcnt(0)
  s_barrier
  ds_read_b128 v[32:35], v8 offset:32768
  v_mfma_f32_32x32x16_bf16 v[64:79], a[184:187], v[40:43], v[64:79]
  ds_read_b128 v[36:39], v8 offset:36864
  v_mfma_f32_32x32x16_bf16 v[80:95], a[188:191], v[40:43], v[80:95]
  v_mfma_f32_32x32x16_bf16 v[96:111], a[184:187], v[44:47], v[96:111]
  v_mfma_f32_32x32x16_bf16 v[112:127], a[188:191], v[44:47], v[112:127]
  s_waitcnt lgkmcnt(0)
  ds_read_b128 v[40:43], v9 offset:32768
  v_mfma_f32_32x32x16_bf16 v[64:79], a[192:195], v[32:35], v[64:79]
  ds_read_b128 v[44:47], v9 offset:36864
  v_mfma_f32_32x32x16_bf16 v[80:95], a[196:199], v[32:35], v[80:95]
  v_mfma_f32_32x32x16_bf16 v[96:111], a[192:195], v[36:39], v[96:111]
  v_mfma_f32_32x32x16_bf16 v[112:127], a[196:199], v[36:39], v[112:127]
  s_waitcnt lgkmcnt(0)
  ds_read_b128 v[32:35], v10 offset:32768
  v_mfma_f32_32x32x16_bf16 v[64:79], a[200:203], v[40:43], v[64:79]
  ds_read_b128 v[36:39], v10 offset:36864
  v_mfma_f32_32x32x16_bf16 v[80:95], a[204:207], v[40:43], v[80:95]
  v_mfma_f32_32x32x16_bf16 v[96:111], a[200:203], v[44:47], v[96:111]
  v_mfma_f32_32x32x16_bf16 v[112:127], a[204:207], v[44:47], v[112:127]
  s_waitcnt lgkmcnt(0)
  ds_read_b128 v[40:43], v11 offset:32768
  v_mfma_f32_32x32x16_bf16 v[64:79], a[208:211], v[32:35], v[64:79]
  ds_read_b128 v[44:47], v11 offset:36864
  v_mfma_f32_32x32x16_bf16 v[80:95], a[212:215], v[32:35], v[80:95]
  v_mfma_f32_32x32x16_bf16 v[96:111], a[208:211], v[36:39], v[96:111]
  v_mfma_f32_32x32x16_bf16 v[112:127], a[212:215], v[36:39], v[112:127]
  s_waitcnt vmcnt(8) lgkmcnt(0)
  s_barrier
  ds_read_b128 v[32:35], v8 offset:49152
  v_mfma_f32_32x32x16_bf16 v[64:79], a[216:219], v[40:43], v[64:79]
  ds_read_b128 v[36:39], v8 offset:53248
  v_mfma_f32_32x32x16_bf16 v[80:95], a[220:223], v[40:43], v[80:95]
  v_mfma_f32_32x32x16_bf16 v[96:111], a[216:219], v[44:47], v[96:111]
  v_mfma_f32_32x32x16_bf16 v[112:127], a[220:223], v[44:47], v[112:127]
  s_waitcnt lgkmcnt(0)
  ds_read_b128 v[40:43], v9 offset:49152
  v_mfma_f32_32x32x16_bf16 v[64:79], a[224:227], v[32:35], v[64:79]
  ds_read_b128 v[44:47], v9 offset:53248
  v_mfma_f32_32x32x16_bf16 v[80:95], a[228:231], v[32:35], v[80:95]
  v_mfma_f32_32x32x16_bf16 v[96:111], a[224:227], v[36:39], v[96:111]
  v_mfma_f32_32x32x16_bf16 v[112:127], a[228:231], v[36:39], v[112:127]
  s_waitcnt lgkmcnt(0)
  ds_read_b128 v[32:35], v10 offset:49152
  v_mfma_f32_32x32x16_bf16 v[64:79], a[232:235], v[40:43], v[64:79]
  ds_read_b128 v[36:39], v10 offset:53248
  v_mfma_f32_32x32x16_bf16 v[80:95], a[236:239], v[40:43], v[80:95]
  v_mfma_f32_32x32x16_bf16 v[96:111], a[232:235], v[44:47], v[96:111]
  v_mfma_f32_32x32x16_bf16 v[112:127], a[236:239], v[44:47], v[112:127]
  s_waitcnt lgkmcnt(0)
  ds_read_b128 v[40:43], v11 offset:49152
  v_mfma_f32_32x32x16_bf16 v[64:79], a[240:243], v[32:35], v[64:79]
  ds_read_b128 v[44:47], v11 offset:53248
  v_mfma_f32_32x32x16_bf16 v[80:95], a[244:247], v[32:35], v[80:95]
  v_mfma_f32_32x32x16_bf16 v[96:111], a[240:243], v[36:39], v[96:111]
  v_mfma_f32_32x32x16_bf16 v[112:127], a[244:247], v[36:39], v[112:127]
  s_waitcnt vmcnt(4) lgkmcnt(0)
  s_barrier
  ds_read_b128 v[32:35], v4 offset:0
  v_mfma_f32_32x32x16_bf16 v[64:79], a[248:251], v[40:43], v[64:79]
  ds_read_b128 v[36:39], v4 offset:4096
  v_mfma_f32_32x32x16_bf16 v[80:95], a[252:255], v[40:43], v[80:95]
  v_mfma_f32_32x32x16_bf16 v[96:111], a[248:251], v[44:47], v[96:111]
  v_mfma_f32_32x32x16_bf16 v[112:127], a[252:255], v[44:47], v[112:127]
  s_waitcnt lgkmcnt(0)
  ds_read_b128 v[40:43], v5 offset:0
  v_mfma_f32_32x32x16_bf16 v[64:79], v[128:131], v[32:35], v[64:79]
  ds_read_b128 v[44:47], v5 offset:4096
  v_mfma_f32_32x32x16_bf16 v[80:95], v[132:135], v[32:35], v[80:95]
  v_mfma_f32_32x32x16_bf16 v[96:111], v[128:131], v[36:39], v[96:111]
  v_mfma_f32_32x32x16_bf16 v[112:127], v[132:135], v[36:39], v[112:127]
  s_waitcnt lgkmcnt(0)
  ds_read_b128 v[32:35], v6 offset:0
  v_mfma_f32_32x32x16_bf16 v[64:79], v[136:139], v[40:43], v[64:79]
  ds_read_b128 v[36:39], v6 offset:4096
  v_mfma_f32_32x32x16_bf16 v[80:95], v[140:143], v[40:43], v[80:95]
  v_mfma_f32_32x32x16_bf16 v[96:111], v[136:139], v[44:47], v[96:111]
  v_mfma_f32_32x32x16_bf16 v[112:127], v[140:143], v[44:47], v[112:127]
  s_waitcnt lgkmcnt(0)
  ds_read_b128 v[40:43], v7 offset:0
  v_mfma_f32_32x32x16_bf16 v[64:79], v[144:147], v[32:35], v[64:79]
  ds_read_b128 v[44:47], v7 offset:4096
  v_mfma_f32_32x32x16_bf16 v[80:95], v[148:151], v[32:35], v[80:95]
  v_mfma_f32_32x32x16_bf16 v[96:111], v[144:147], v[36:39], v[96:111]
  v_mfma_f32_32x32x16_bf16 v[112:127], v[148:151], v[36:39], v[112:127]
  s_waitcnt vmcnt(0) lgkmcnt(0)
  s_barrier
  ds_read_b128 v[32:35], v4 offset:16384
  v_mfma_f32_32x32x16_bf16 v[64:79], v[152:155], v[40:43], v[64:79]
  ds_read_b128 v[36:39], v4 offset:20480
  v_mfma_f32_32x32x16_bf16 v[80:95], v[156:159], v[40:43], v[80:95]
  v_mfma_f32_32x32x16_bf16 v[96:111], v[152:155], v[44:47], v[96:111]
  v_mfma_f32_32x32x16_bf16 v[112:127], v[156:159], v[44:47], v[112:127]
  s_waitcnt lgkmcnt(0)
  ds_read_b128 v[40:43], v5 offset:16384
  v_mfma_f32_32x32x16_bf16 v[64:79], v[160:163], v[32:35], v[64:79]
  ds_read_b128 v[44:47], v5 offset:20480
  v_mfma_f32_32x32x16_bf16 v[80:95], v[164:167], v[32:35], v[80:95]
  v_mfma_f32_32x32x16_bf16 v[96:111], v[160:163], v[36:39], v[96:111]
  v_mfma_f32_32x32x16_bf16 v[112:127], v[164:167], v[36:39], v[112:127]
  s_waitcnt lgkmcnt(0)
  ds_read_b128 v[32:35], v6 offset:16384
  v_mfma_f32_32x32x16_bf16 v[64:79], v[168:171], v[40:43], v[64:79]
  ds_read_b128 v[36:39], v6 offset:20480
  v_mfma_f32_32x32x16_bf16 v[80:95], v[172:175], v[40:43], v[80:95]
  v_mfma_f32_32x32x16_bf16 v[96:111], v[168:171], v[44:47], v[96:111]
  v_mfma_f32_32x32x16_bf16 v[112:127], v[172:175], v[44:47], v[112:127]
  s_waitcnt lgkmcnt(0)
  ds_read_b128 v[40:43], v7 offset:16384
  v_mfma_f32_32x32x16_bf16 v[64:79], v[176:179], v[32:35], v[64:79]
  ds_read_b128 v[44:47], v7 offset:20480
  v_mfma_f32_32x32x16_bf16 v[80:95], v[180:183], v[32:35], v[80:95]
  v_mfma_f32_32x32x16_bf16 v[96:111], v[176:179], v[36:39], v[96:111]
  v_mfma_f32_32x32x16_bf16 v[112:127], v[180:183], v[36:39], v[112:127]
  s_waitcnt lgkmcnt(0)
  v_mfma_f32_32x32x16_bf16 v[64:79], v[184:187], v[40:43], v[64:79]
  v_mfma_f32_32x32x16_bf16 v[80:95], v[188:191], v[40:43], v[80:95]
  v_mfma_f32_32x32x16_bf16 v[96:111], v[184:187], v[44:47], v[96:111]
  v_mfma_f32_32x32x16_bf16 v[112:127], v[188:191], v[44:47], v[112:127]
  s_barrier
  s_mov_b32 s50, s40
  s_add_u32 s40, s40, 2
  s_min_u32 s40, s40, 15
  s_lshl_b32 s30, s40, 7
  s_lshl_b32 s31, s24, 5
  s_add_u32 s30, s30, s31
  s_mul_i32 s27, s30, 1280
  s_add_u32 s27, s27, 0
  s_add_u32 s30, s27, 0
  s_add_u32 m0, s35, 0
  s_nop 0
  buffer_load_dwordx4 v1, s[4:7], s30 offen lds
  s_add_u32 s30, s27, 10240
  s_add_u32 m0, s35, 1024
  s_nop 0
  buffer_load_dwordx4 v2, s[4:7], s30 offen lds
  s_add_u32 s30, s27, 20480
  s_add_u32 m0, s35, 2048
  s_nop 0
  buffer_load_dwordx4 v1, s[4:7], s30 offen lds
  s_add_u32 s30, s27, 30720
  s_add_u32 m0, s35, 3072
  s_nop 0
  buffer_load_dwordx4 v2, s[4:7], s30 offen lds
  s_add_u32 s30, s27, 128
  s_add_u32 m0, s35, 16384
  s_nop 0
  buffer_load_dwordx4 v1, s[4:7], s30 offen lds
  s_add_u32 s30, s27, 10368
  s_add_u32 m0, s35, 17408
  s_nop 0
  buffer_load_dwordx4 v2, s[4:7], s30 offen lds
  s_add_u32 s30, s27, 20608
  s_add_u32 m0, s35, 18432
  s_nop 0
  buffer_load_dwordx4 v1, s[4:7], s30 offen lds
  s_add_u32 s30, s27, 30848
  s_add_u32 m0, s35, 19456
  s_nop 0
  buffer_load_dwordx4 v2, s[4:7], s30 offen lds
  s_add_u32 s30, s27, 256
  s_add_u32 m0, s35, 32768
  s_nop 0
  buffer_load_dwordx4 v1, s[4:7], s30 offen lds
  s_add_u32 s30, s27, 10496
  s_add_u32 m0, s35, 33792
  s_nop 0
  buffer_load_dwordx4 v2, s[4:7], s30 offen lds
  s_add_u32 s30, s27, 20736
  s_add_u32 m0, s35, 34816
  s_nop 0
  buffer_load_dwordx4 v1, s[4:7], s30 offen lds
  s_add_u32 s30, s27, 30976
  s_add_u32 m0, s35, 35840
  s_nop 0
  buffer_load_dwordx4 v2, s[4:7], s30 offen lds
  s_add_u32 s30, s27, 384
  s_add_u32 m0, s35, 49152
  s_nop 0
  buffer_load_dwordx4 v1, s[4:7], s30 offen lds
  s_add_u32 s30, s27, 10624
  s_add_u32 m0, s35, 50176
  s_nop 0
  buffer_load_dwordx4 v2, s[4:7], s30 offen lds
  s_add_u32 s30, s27, 20864
  s_add_u32 m0, s35, 51200
  s_nop 0
  buffer_load_dwordx4 v1, s[4:7], s30 offen lds
  s_add_u32 s30, s27, 31104
  s_add_u32 m0, s35, 52224
  s_nop 0
  buffer_load_dwordx4 v2, s[4:7], s30 offen lds
  s_mov_b32 s40, s50
  s_mov_b32 s45, 4194304
  s_lshl_b32 s46, s40, 7
  s_lshl_b32 s47, s25, 6
  s_add_u32 s46, s46, s47
  s_lshl_b32 s46, s46, 13
  s_add_u32 s45, s45, s46
  s_lshl_b32 s46, s43, 8
  s_add_u32 s45, s45, s46
  s_lshl_b32 s46, s26, 7
  s_add_u32 s45, s45, s46
  v_and_b32 v22, 31, v0
  v_lshlrev_b32 v23, 7, v22
  v_and_b32 v24, 7, v0
  v_lshrrev_b32 v25, 5, v0
  s_lshl_b32 s46, s24, 13
  s_add_u32 s46, s46, 131072
  v_add_u32 v23, s46, v23
  v_cvt_pk_bf16_f32 v32, v64, v65
  v_cvt_pk_bf16_f32 v33, v66, v67
  v_cvt_pk_bf16_f32 v34, v68, v69
  v_cvt_pk_bf16_f32 v35, v70, v71
  v_cvt_pk_bf16_f32 v36, v72, v73
  v_cvt_pk_bf16_f32 v37, v74, v75
  v_cvt_pk_bf16_f32 v38, v76, v77
  v_cvt_pk_bf16_f32 v39, v78, v79
  v_permlane32_swap_b32 v32, v34
  v_permlane32_swap_b32 v33, v35
  v_permlane32_swap_b32 v36, v38
  v_permlane32_swap_b32 v37, v39
  v_add_u32 v26, 0, v25
  v_xor_b32 v26, v26, v24
  v_lshlrev_b32 v26, 4, v26
  v_add_u32 v26, v26, v23
  ds_write_b128 v26, v[32:35] offset:0
  v_add_u32 v26, 2, v25
  v_xor_b32 v26, v26, v24
  v_lshlrev_b32 v26, 4, v26
  v_add_u32 v26, v26, v23
  ds_write_b128 v26, v[36:39] offset:0
  v_cvt_pk_bf16_f32 v40, v80, v81
  v_cvt_pk_bf16_f32 v41, v82, v83
  v_cvt_pk_bf16_f32 v42, v84, v85
  v_cvt_pk_bf16_f32 v43, v86, v87
  v_cvt_pk_bf16_f32 v44, v88, v89
  v_cvt_pk_bf16_f32 v45, v90, v91
  v_cvt_pk_bf16_f32 v46, v92, v93
  v_cvt_pk_bf16_f32 v47, v94, v95
  v_permlane32_swap_b32 v40, v42
  v_permlane32_swap_b32 v41, v43
  v_permlane32_swap_b32 v44, v46
  v_permlane32_swap_b32 v45, v47
  v_add_u32 v26, 4, v25
  v_xor_b32 v26, v26, v24
  v_lshlrev_b32 v26, 4, v26
  v_add_u32 v26, v26, v23
  ds_write_b128 v26, v[40:43] offset:0
  v_add_u32 v26, 6, v25
  v_xor_b32 v26, v26, v24
  v_lshlrev_b32 v26, 4, v26
  v_add_u32 v26, v26, v23
  ds_write_b128 v26, v[44:47] offset:0
  v_cvt_pk_bf16_f32 v32, v96, v97
  v_cvt_pk_bf16_f32 v33, v98, v99
  v_cvt_pk_bf16_f32 v34, v100, v101
  v_cvt_pk_bf16_f32 v35, v102, v103
  v_cvt_pk_bf16_f32 v36, v104, v105
  v_cvt_pk_bf16_f32 v37, v106, v107
  v_cvt_pk_bf16_f32 v38, v108, v109
  v_cvt_pk_bf16_f32 v39, v110, v111
  v_permlane32_swap_b32 v32, v34
  v_permlane32_swap_b32 v33, v35
  v_permlane32_swap_b32 v36, v38
  v_permlane32_swap_b32 v37, v39
  v_add_u32 v26, 0, v25
  v_xor_b32 v26, v26, v24
  v_lshlrev_b32 v26, 4, v26
  v_add_u32 v26, v26, v23
  ds_write_b128 v26, v[32:35] offset:4096
  v_add_u32 v26, 2, v25
  v_xor_b32 v26, v26, v24
  v_lshlrev_b32 v26, 4, v26
  v_add_u32 v26, v26, v23
  ds_write_b128 v26, v[36:39] offset:4096
  v_cvt_pk_bf16_f32 v40, v112, v113
  v_cvt_pk_bf16_f32 v41, v114, v115
  v_cvt_pk_bf16_f32 v42, v116, v117
  v_cvt_pk_bf16_f32 v43, v118, v119
  v_cvt_pk_bf16_f32 v44, v120, v121
  v_cvt_pk_bf16_f32 v45, v122, v123
  v_cvt_pk_bf16_f32 v46, v124, v125
  v_cvt_pk_bf16_f32 v47, v126, v127
  v_permlane32_swap_b32 v40, v42
  v_permlane32_swap_b32 v41, v43
  v_permlane32_swap_b32 v44, v46
  v_permlane32_swap_b32 v45, v47
  v_add_u32 v26, 4, v25
  v_xor_b32 v26, v26, v24
  v_lshlrev_b32 v26, 4, v26
  v_add_u32 v26, v26, v23
  ds_write_b128 v26, v[40:43] offset:4096
  v_add_u32 v26, 6, v25
  v_xor_b32 v26, v26, v24
  v_lshlrev_b32 v26, 4, v26
  v_add_u32 v26, v26, v23
  ds_write_b128 v26, v[44:47] offset:4096
  v_lshrrev_b32 v22, 3, v0
  v_and_b32 v24, 7, v0
  v_xor_b32 v25, v24, v22
  v_lshlrev_b32 v25, 4, v25
  v_lshlrev_b32 v26, 7, v22
  v_add_u32 v25, v25, v26
  v_add_u32 v25, s46, v25
  s_mov_b32 s47, 8192
  v_mul_lo_u32 v22, v22, s47
  v_lshlrev_b32 v24, 4, v24
  v_add_u32 v22, v22, v24
  s_waitcnt lgkmcnt(0)
  ds_read_b128 v[32:35], v25 offset:0
  ds_read_b128 v[36:39], v25 offset:1024
  ds_read_b128 v[40:43], v25 offset:2048
  ds_read_b128 v[44:47], v25 offset:3072
  ds_read_b128 v[48:51], v25 offset:4096
  ds_read_b128 v[52:55], v25 offset:5120
  ds_read_b128 v[56:59], v25 offset:6144
  ds_read_b128 v[60:63], v25 offset:7168
  s_waitcnt lgkmcnt(7)
  s_add_u32 s47, s45, 0
  buffer_store_dwordx4 v[32:35], v22, s[4:7], s47 offen sc1
  s_waitcnt lgkmcnt(6)
  s_add_u32 s47, s45, 65536
  buffer_store_dwordx4 v[36:39], v22, s[4:7], s47 offen sc1
  s_waitcnt lgkmcnt(5)
  s_add_u32 s47, s45, 131072
  buffer_store_dwordx4 v[40:43], v22, s[4:7], s47 offen sc1
  s_waitcnt lgkmcnt(4)
  s_add_u32 s47, s45, 196608
  buffer_store_dwordx4 v[44:47], v22, s[4:7], s47 offen sc1
  s_waitcnt lgkmcnt(3)
  s_add_u32 s47, s45, 262144
  buffer_store_dwordx4 v[48:51], v22, s[4:7], s47 offen sc1
  s_waitcnt lgkmcnt(2)
  s_add_u32 s47, s45, 327680
  buffer_store_dwordx4 v[52:55], v22, s[4:7], s47 offen sc1
  s_waitcnt lgkmcnt(1)
  s_add_u32 s47, s45, 393216
  buffer_store_dwordx4 v[56:59], v22, s[4:7], s47 offen sc1
  s_waitcnt lgkmcnt(0)
  s_add_u32 s47, s45, 458752
  buffer_store_dwordx4 v[60:63], v22, s[4:7], s47 offen sc1
  s_add_u32 s30, s27, 512
  s_add_u32 m0, s35, 65536
  s_nop 0
  buffer_load_dwordx4 v1, s[4:7], s30 offen lds
  s_add_u32 s30, s27, 10752
  s_add_u32 m0, s35, 66560
  s_nop 0
  buffer_load_dwordx4 v2, s[4:7], s30 offen lds
  s_add_u32 s30, s27, 20992
  s_add_u32 m0, s35, 67584
  s_nop 0
  buffer_load_dwordx4 v1, s[4:7], s30 offen lds
  s_add_u32 s30, s27, 31232
  s_add_u32 m0, s35, 68608
  s_nop 0
  buffer_load_dwordx4 v2, s[4:7], s30 offen lds
  s_add_u32 s30, s27, 640
  s_add_u32 m0, s35, 81920
  s_nop 0
  buffer_load_dwordx4 v1, s[4:7], s30 offen lds
  s_add_u32 s30, s27, 10880
  s_add_u32 m0, s35, 82944
  s_nop 0
  buffer_load_dwordx4 v2, s[4:7], s30 offen lds
  s_add_u32 s30, s27, 21120
  s_add_u32 m0, s35, 83968
  s_nop 0
  buffer_load_dwordx4 v1, s[4:7], s30 offen lds
  s_add_u32 s30, s27, 31360
  s_add_u32 m0, s35, 84992
  s_nop 0
  buffer_load_dwordx4 v2, s[4:7], s30 offen lds
  s_add_u32 s30, s27, 768
  s_add_u32 m0, s35, 98304
  s_nop 0
  buffer_load_dwordx4 v1, s[4:7], s30 offen lds
  s_add_u32 s30, s27, 11008
  s_add_u32 m0, s35, 99328
  s_nop 0
  buffer_load_dwordx4 v2, s[4:7], s30 offen lds
  s_add_u32 s30, s27, 21248
  s_add_u32 m0, s35, 100352
  s_nop 0
  buffer_load_dwordx4 v1, s[4:7], s30 offen lds
  s_add_u32 s30, s27, 31488
  s_add_u32 m0, s35, 101376
  s_nop 0
  buffer_load_dwordx4 v2, s[4:7], s30 offen lds
  s_add_u32 s30, s27, 896
  s_add_u32 m0, s35, 114688
  s_nop 0
  buffer_load_dwordx4 v1, s[4:7], s30 offen lds
  s_add_u32 s30, s27, 11136
  s_add_u32 m0, s35, 115712
  s_nop 0
  buffer_load_dwordx4 v2, s[4:7], s30 offen lds
  s_add_u32 s30, s27, 21376
  s_add_u32 m0, s35, 116736
  s_nop 0
  buffer_load_dwordx4 v1, s[4:7], s30 offen lds
  s_add_u32 s30, s27, 31616
  s_add_u32 m0, s35, 117760
  s_nop 0
  buffer_load_dwordx4 v2, s[4:7], s30 offen lds
  s_lshl_b32 s49, s40, 7
  s_add_u32 s49, s49, 85069824
  s_waitcnt vmcnt(16)
  s_barrier
  v_cmp_eq_u32 vcc, 0, v254
  s_nop 0
  s_and_saveexec_b64 s[56:57], vcc
  s_nop 0
  s_cbranch_execz sig_4400073
  v_mov_b32 v250, 1
  v_mov_b32 v251, 0
  buffer_atomic_add v250, v251, s[4:7], s49 offen
sig_4400073:
  s_mov_b64 exec, s[56:57]
  s_add_u32 s40, s40, 2
  s_cmp_lt_u32 s40, 16
  s_cbranch_scc1 qs_4400072
  s_waitcnt vmcnt(0)
  s_barrier
qd_4400061:
  v_mov_b32 v251, 0
rzw_4400074:
  buffer_load_dword v248, v251, s[84:87], 0 offen offset:16 sc1
  s_waitcnt vmcnt(0)
  v_readfirstlane_b32 s56, v248
  s_nop 0
  s_cmp_ge_u32 s56, 64
  s_nop 0
  s_cbranch_scc1 rzok_4400075
  s_add_u32 s63, s63, 1
  s_cmp_gt_u32 s63, 4194304
  s_cbranch_scc1 fz_fail
  s_sleep 8
  s_branch rzw_4400074
rzok_4400075:
  s_mov_b32 s39, s60
  s_cmp_ge_u32 s39, 32
  s_nop 0
  s_cbranch_scc1 rk_4400076
  s_mov_b32 s38, 0
  s_cmp_ge_u32 s39, 16
  s_cselect_b32 s56, 16, 0
  s_cselect_b32 s57, 1, 0
  s_sub_u32 s39, s39, s56
  s_add_u32 s38, s38, s57
  s_mov_b32 s62, s39
rlp_4400077:
  s_mov_b32 s39, s62
  v_mov_b32 v0, v254
  s_lshr_b32 s48, s38, 1
  s_lshl_b32 s49, s48, 7
  s_add_u32 s49, s49, 85069824
  v_readfirstlane_b32 s56, v254
  s_nop 0
  s_cmp_ge_u32 s56, 64
  s_nop 0
  s_cbranch_scc1 wok_4400079
  v_mov_b32 v251, 0
wc_4400078:
  buffer_load_dword v250, v251, s[4:7], s49 offen sc1
  s_waitcnt vmcnt(0)
  v_readfirstlane_b32 s56, v250
  s_nop 0
  s_cmp_ge_u32 s56, 32
  s_nop 0
  s_cbranch_scc1 wok_4400079
  s_add_u32 s63, s63, 1
  s_cmp_gt_u32 s63, 4194304
  s_cbranch_scc1 fz_fail
  s_cmp_ge_u32 s38, 31
  s_cbranch_scc1 nap_4400080
  s_sleep 24
  s_branch nape_4400081
nap_4400080:
  s_sleep 12
nape_4400081:
  s_branch wc_4400078
wok_4400079:
  s_barrier
  v_lshrrev_b32 v1, 6, v0
  s_nop 0
  v_readfirstlane_b32 s8, v1
  v_and_b32 v0, 63, v0
  s_lshl_b32 s10, s38, 1
  s_lshr_b32 s9, s39, 3
  s_add_u32 s10, s10, s9
  s_and_b32 s11, s39, 7
  s_lshl_b32 s11, s11, 2
  s_add_u32 s11, s11, s8
  v_and_b32 v6, 15, v0
  v_lshlrev_b32 v1, 13, v6
  v_lshrrev_b32 v7, 4, v0
  v_lshlrev_b32 v8, 4, v7
  v_add_u32 v1, v1, v8
  v_bfe_u32 v2, v0, 2, 1
  v_lshlrev_b32 v2, 4, v2
  v_bfe_u32 v9, v0, 3, 1
  v_lshlrev_b32 v9, 2, v9
  v_add_u32 v2, v2, v9
  v_and_b32 v9, 3, v0
  v_add_u32 v2, v2, v9
  v_lshlrev_b32 v2, 13, v2
  v_add_u32 v2, v2, v8
  v_lshlrev_b32 v3, 4, v0
  v_lshlrev_b32 v4, 3, v0
  v_lshlrev_b32 v5, 13, v6
  v_bfe_u32 v9, v0, 4, 1
  v_lshlrev_b32 v9, 5, v9
  v_add_u32 v5, v5, v9
  v_lshrrev_b32 v9, 5, v0
  v_lshlrev_b32 v9, 4, v9
  v_add_u32 v5, v5, v9
  v_and_b32 v9, 1, v7
  v_lshlrev_b32 v9, 4, v9
  v_lshrrev_b32 v10, 1, v7
  v_lshlrev_b32 v10, 2, v10
  v_add_u32 v9, v9, v10
  v_sub_u32 v10, v6, v9
  s_lshl_b32 s12, s10, 18
  s_lshl_b32 s13, s11, 8
  s_add_u32 s12, s12, s13
  s_add_u32 s14, s12, 4194304
  s_add_u32 s15, s12, 20971520
  s_add_u32 s16, s12, 54525952
  s_lshl_b32 s17, s10, 5
  s_add_u32 s17, s17, s11
  s_lshl_b32 s18, s17, 12
  s_add_u32 s18, s18, 71303168
  s_lshl_b32 s19, s17, 13
  s_add_u32 s19, s19, 37748736
  s_lshl_b32 s20, s17, 11
  s_add_u32 s20, s20, 79691776
  s_mov_b32 s21, 0x3e0293ee
  s_add_u32 s22, s14, 0
  buffer_load_dwordx4 v[16:19], v1, s[4:7], s22 offen offset:0
  buffer_load_dwordx4 v[20:23], v1, s[4:7], s22 offen offset:64
  buffer_load_dwordx4 v[24:27], v1, s[4:7], s22 offen offset:128
  buffer_load_dwordx4 v[28:31], v1, s[4:7], s22 offen offset:192
  s_add_u32 s22, s14, 131072
  buffer_load_dwordx4 v[32:35], v1, s[4:7], s22 offen offset:0
  buffer_load_dwordx4 v[36:39], v1, s[4:7], s22 offen offset:64
  buffer_load_dwordx4 v[40:43], v1, s[4:7], s22 offen offset:128
  buffer_load_dwordx4 v[44:47], v1, s[4:7], s22 offen offset:192
  s_add_u32 s22, s15, 0
  buffer_load_dwordx4 v[48:51], v2, s[4:7], s22 offen offset:0
  buffer_load_dwordx4 v[52:55], v2, s[4:7], s22 offen offset:64
  buffer_load_dwordx4 v[56:59], v2, s[4:7], s22 offen offset:128
  buffer_load_dwordx4 v[60:63], v2, s[4:7], s22 offen offset:192
  s_add_u32 s22, s15, 65536
  buffer_load_dwordx4 v[64:67], v2, s[4:7], s22 offen offset:0
  buffer_load_dwordx4 v[68:71], v2, s[4:7], s22 offen offset:64
  buffer_load_dwordx4 v[72:75], v2, s[4:7], s22 offen offset:128
  buffer_load_dwordx4 v[76:79], v2, s[4:7], s22 offen offset:192
  s_add_u32 s22, s19, 0
  buffer_load_dwordx4 v[120:123], v3, s[4:7], s22 offen offset:0
  s_add_u32 s22, s19, 0
  buffer_load_dwordx4 v[124:127], v3, s[4:7], s22 offen offset:1024
  s_add_u32 s22, s19, 0
  buffer_load_dwordx4 v[128:131], v3, s[4:7], s22 offen offset:2048
  s_add_u32 s22, s19, 0
  buffer_load_dwordx4 v[132:135], v3, s[4:7], s22 offen offset:3072
  s_add_u32 s22, s19, 4096
  buffer_load_dwordx4 v[136:139], v3, s[4:7], s22 offen offset:0
  s_add_u32 s22, s19, 4096
  buffer_load_dwordx4 v[140:143], v3, s[4:7], s22 offen offset:1024
  s_add_u32 s22, s19, 4096
  buffer_load_dwordx4 v[144:147], v3, s[4:7], s22 offen offset:2048
  s_add_u32 s22, s19, 4096
  buffer_load_dwordx4 v[148:151], v3, s[4:7], s22 offen offset:3072
  s_add_u32 s23, s10, 2
  s_min_u32 s23, s23, 64
  s_mov_b32 s22, 85094400
  v_mov_b32 v11, 0
pw_4400082:
  buffer_load_dword v12, v11, s[4:7], s22 offen sc1
  s_waitcnt vmcnt(0)
  v_readfirstlane_b32 s56, v12
  s_nop 0
  s_cmp_ge_u32 s56, s23
  s_cbranch_scc1 pwok_4400083
  s_add_u32 s63, s63, 1
  s_cmp_gt_u32 s63, 4194304
  s_cbranch_scc1 fz_fail
  s_cmp_ge_u32 s38, 31
  s_cbranch_scc1 nap_4400084
  s_sleep 24
  s_branch nape_4400085
nap_4400084:
  s_sleep 2
nape_4400085:
  s_branch pw_4400082
pwok_4400083:
atp_4400086:
  buffer_load_dwordx4 v[80:83], v3, s[4:7], s18 offen offset:0 sc1
  buffer_load_dwordx4 v[84:87], v3, s[4:7], s18 offen offset:1024 sc1
  buffer_load_dwordx4 v[88:91], v3, s[4:7], s18 offen offset:2048 sc1
  buffer_load_dwordx4 v[92:95], v3, s[4:7], s18 offen offset:3072 sc1
  buffer_load_dwordx2 v[152:153], v4, s[4:7], s20 offen offset:0 sc1
  buffer_load_dwordx2 v[154:155], v4, s[4:7], s20 offen offset:512 sc1
  buffer_load_dwordx2 v[156:157], v4, s[4:7], s20 offen offset:1024 sc1
  buffer_load_dwordx2 v[158:159], v4, s[4:7], s20 offen offset:1536 sc1
  s_waitcnt vmcnt(0)
  v_max3_u32 v11, v80, v81, v82
  v_max3_u32 v11, v11, v83, v84
  v_max3_u32 v11, v11, v85, v86
  v_max3_u32 v11, v11, v87, v88
  v_max3_u32 v11, v11, v89, v90
  v_max3_u32 v11, v11, v91, v92
  v_max3_u32 v11, v11, v93, v94
  v_max3_u32 v11, v11, v95, v152
  v_max3_u32 v11, v11, v153, v154
  v_max3_u32 v11, v11, v155, v156
  v_max3_u32 v11, v11, v157, v158
  v_max_u32 v11, v11, v159
  v_cmp_eq_u32 vcc, -1, v11
  s_nop 0
  s_cbranch_vccz atok_4400087
  s_add_u32 s63, s63, 1
  s_cmp_gt_u32 s63, 4194304
  s_cbranch_scc1 fz_fail
  s_cmp_ge_u32 s38, 31
  s_cbranch_scc1 nap_4400088
  s_sleep 24
  s_branch nape_4400089
nap_4400088:
  s_sleep 2
nape_4400089:
  s_branch atp_4400086
atok_4400087:
  v_mfma_f32_16x16x32_bf16 v[96:99], v[80:83], v[16:19], 0
  v_mfma_f32_16x16x32_bf16 v[104:107], v[48:51], v[16:19], 0
  v_mfma_f32_16x16x32_bf16 v[112:115], v[64:67], v[16:19], 0
  v_mfma_f32_16x16x32_bf16 v[100:103], v[80:83], v[32:35], 0
  v_mfma_f32_16x16x32_bf16 v[108:111], v[48:51], v[32:35], 0
  v_mfma_f32_16x16x32_bf16 v[116:119], v[64:67], v[32:35], 0
  v_mfma_f32_16x16x32_bf16 v[96:99], v[84:87], v[20:23], v[96:99]
  v_mfma_f32_16x16x32_bf16 v[104:107], v[52:55], v[20:23], v[104:107]
  v_mfma_f32_16x16x32_bf16 v[112:115], v[68:71], v[20:23], v[112:115]
  v_mfma_f32_16x16x32_bf16 v[100:103], v[84:87], v[36:39], v[100:103]
  v_mfma_f32_16x16x32_bf16 v[108:111], v[52:55], v[36:39], v[108:111]
  v_mfma_f32_16x16x32_bf16 v[116:119], v[68:71], v[36:39], v[116:119]
  v_mfma_f32_16x16x32_bf16 v[96:99], v[88:91], v[24:27], v[96:99]
  v_mfma_f32_16x16x32_bf16 v[104:107], v[56:59], v[24:27], v[104:107]
  v_mfma_f32_16x16x32_bf16 v[112:115], v[72:75], v[24:27], v[112:115]
  v_mfma_f32_16x16x32_bf16 v[100:103], v[88:91], v[40:43], v[100:103]
  v_mfma_f32_16x16x32_bf16 v[108:111], v[56:59], v[40:43], v[108:111]
  v_mfma_f32_16x16x32_bf16 v[116:119], v[72:75], v[40:43], v[116:119]
  v_mfma_f32_16x16x32_bf16 v[96:99], v[92:95], v[28:31], v[96:99]
  v_mfma_f32_16x16x32_bf16 v[104:107], v[60:63], v[28:31], v[104:107]
  v_mfma_f32_16x16x32_bf16 v[112:115], v[76:79], v[28:31], v[112:115]
  v_mfma_f32_16x16x32_bf16 v[100:103], v[92:95], v[44:47], v[100:103]
  v_mfma_f32_16x16x32_bf16 v[108:111], v[60:63], v[44:47], v[108:111]
  v_mfma_f32_16x16x32_bf16 v[116:119], v[76:79], v[44:47], v[116:119]
  v_mov_b32 v11, 0xff800000
  v_cmp_le_i32 vcc, 0, v10
  s_nop 1
  v_cndmask_b32 v104, v11, v104, vcc
  v_cmp_le_i32 vcc, 1, v10
  s_nop 1
  v_cndmask_b32 v105, v11, v105, vcc
  v_cmp_le_i32 vcc, 2, v10
  s_nop 1
  v_cndmask_b32 v106, v11, v106, vcc
  v_cmp_le_i32 vcc, 3, v10
  s_nop 1
  v_cndmask_b32 v107, v11, v107, vcc
  v_cmp_le_i32 vcc, 8, v10
  s_nop 1
  v_cndmask_b32 v112, v11, v112, vcc
  v_cmp_le_i32 vcc, 9, v10
  s_nop 1
  v_cndmask_b32 v113, v11, v113, vcc
  v_cmp_le_i32 vcc, 10, v10
  s_nop 1
  v_cndmask_b32 v114, v11, v114, vcc
  v_cmp_le_i32 vcc, 11, v10
  s_nop 1
  v_cndmask_b32 v115, v11, v115, vcc
  v_max3_f32 v12, v96, v97, v104
  v_max3_f32 v12, v12, v105, v106
  v_max3_f32 v12, v12, v107, v112
  v_max3_f32 v12, v12, v113, v114
  v_max_f32 v12, v12, v115
  v_mov_b32 v13, v12
  s_nop 1
  v_permlane32_swap_b32 v12, v13
  v_max_f32 v12, v12, v13
  v_mov_b32 v13, v12
  s_nop 1
  v_permlane16_swap_b32 v12, v13
  v_max_f32 v12, v12, v13
  v_mul_f32 v12, s21, v12
  v_fma_f32 v96, v96, s21, -v12
  v_fma_f32 v97, v97, s21, -v12
  v_fma_f32 v104, v104, s21, -v12
  v_fma_f32 v105, v105, s21, -v12
  v_fma_f32 v106, v106, s21, -v12
  v_fma_f32 v107, v107, s21, -v12
  v_fma_f32 v112, v112, s21, -v12
  v_fma_f32 v113, v113, s21, -v12
  v_fma_f32 v114, v114, s21, -v12
  v_fma_f32 v115, v115, s21, -v12
  v_exp_f32 v96, v96
  v_exp_f32 v97, v97
  v_exp_f32 v104, v104
  v_exp_f32 v105, v105
  v_exp_f32 v106, v106
  v_exp_f32 v107, v107
  v_exp_f32 v112, v112
  v_exp_f32 v113, v113
  v_exp_f32 v114, v114
  v_exp_f32 v115, v115
  v_cvt_pk_bf16_f32 v160, v104, v105
  v_cvt_pk_bf16_f32 v161, v106, v107
  v_cvt_pk_bf16_f32 v162, v112, v113
  v_cvt_pk_bf16_f32 v163, v114, v115
  v_cvt_pk_bf16_f32 v164, v96, v97
  v_mov_b32 v165, 0
  v_mov_b32 v166, 0
  v_mov_b32 v167, v164
  v_add_f32 v14, v96, v97
  v_add_f32 v14, v14, v104
  v_add_f32 v14, v14, v105
  v_add_f32 v14, v14, v106
  v_add_f32 v14, v14, v107
  v_add_f32 v14, v14, v112
  v_add_f32 v14, v14, v113
  v_add_f32 v14, v14, v114
  v_add_f32 v14, v14, v115
  v_mov_b32 v13, v14
  s_nop 1
  v_permlane32_swap_b32 v14, v13
  v_add_f32 v14, v14, v13
  v_mov_b32 v13, v14
  s_nop 1
  v_permlane16_swap_b32 v14, v13
  v_add_f32 v14, v14, v13
  v_rcp_f32 v14, v14
  v_cmp_le_i32 vcc, -16, v10
  s_nop 1
  v_cndmask_b32 v108, v11, v108, vcc
  v_cmp_le_i32 vcc, -15, v10
  s_nop 1
  v_cndmask_b32 v109, v11, v109, vcc
  v_cmp_le_i32 vcc, -14, v10
  s_nop 1
  v_cndmask_b32 v110, v11, v110, vcc
  v_cmp_le_i32 vcc, -13, v10
  s_nop 1
  v_cndmask_b32 v111, v11, v111, vcc
  v_cmp_le_i32 vcc, -8, v10
  s_nop 1
  v_cndmask_b32 v116, v11, v116, vcc
  v_cmp_le_i32 vcc, -7, v10
  s_nop 1
  v_cndmask_b32 v117, v11, v117, vcc
  v_cmp_le_i32 vcc, -6, v10
  s_nop 1
  v_cndmask_b32 v118, v11, v118, vcc
  v_cmp_le_i32 vcc, -5, v10
  s_nop 1
  v_cndmask_b32 v119, v11, v119, vcc
  v_max3_f32 v12, v100, v101, v108
  v_max3_f32 v12, v12, v109, v110
  v_max3_f32 v12, v12, v111, v116
  v_max3_f32 v12, v12, v117, v118
  v_max_f32 v12, v12, v119
  v_mov_b32 v13, v12
  s_nop 1
  v_permlane32_swap_b32 v12, v13
  v_max_f32 v12, v12, v13
  v_mov_b32 v13, v12
  s_nop 1
  v_permlane16_swap_b32 v12, v13
  v_max_f32 v12, v12, v13
  v_mul_f32 v12, s21, v12
  v_fma_f32 v100, v100, s21, -v12
  v_fma_f32 v101, v101, s21, -v12
  v_fma_f32 v108, v108, s21, -v12
  v_fma_f32 v109, v109, s21, -v12
  v_fma_f32 v110, v110, s21, -v12
  v_fma_f32 v111, v111, s21, -v12
  v_fma_f32 v116, v116, s21, -v12
  v_fma_f32 v117, v117, s21, -v12
  v_fma_f32 v118, v118, s21, -v12
  v_fma_f32 v119, v119, s21, -v12
  v_exp_f32 v100, v100
  v_exp_f32 v101, v101
  v_exp_f32 v108, v108
  v_exp_f32 v109, v109
  v_exp_f32 v110, v110
  v_exp_f32 v111, v111
  v_exp_f32 v116, v116
  v_exp_f32 v117, v117
  v_exp_f32 v118, v118
  v_exp_f32 v119, v119
  v_cvt_pk_bf16_f32 v168, v108, v109
  v_cvt_pk_bf16_f32 v169, v110, v111
  v_cvt_pk_bf16_f32 v170, v116, v117
  v_cvt_pk_bf16_f32 v171, v118, v119
  v_cvt_pk_bf16_f32 v172, v100, v101
  v_mov_b32 v173, 0
  v_mov_b32 v174, 0
  v_mov_b32 v175, v172
  v_add_f32 v15, v100, v101
  v_add_f32 v15, v15, v108
  v_add_f32 v15, v15, v109
  v_add_f32 v15, v15, v110
  v_add_f32 v15, v15, v111
  v_add_f32 v15, v15, v116
  v_add_f32 v15, v15, v117
  v_add_f32 v15, v15, v118
  v_add_f32 v15, v15, v119
  v_mov_b32 v13, v15
  s_nop 1
  v_permlane32_swap_b32 v15, v13
  v_add_f32 v15, v15, v13
  v_mov_b32 v13, v15
  s_nop 1
  v_permlane16_swap_b32 v15, v13
  v_add_f32 v15, v15, v13
  v_rcp_f32 v15, v15
  v_mfma_f32_16x16x32_bf16 v[176:179], v[120:123], v[160:163], 0
  v_mfma_f32_16x16x32_bf16 v[180:183], v[124:127], v[160:163], 0
  v_mfma_f32_16x16x32_bf16 v[184:187], v[128:131], v[160:163], 0
  v_mfma_f32_16x16x32_bf16 v[188:191], v[132:135], v[160:163], 0
  v_mfma_f32_16x16x32_bf16 v[192:195], v[136:139], v[160:163], 0
  v_mfma_f32_16x16x32_bf16 v[196:199], v[140:143], v[160:163], 0
  v_mfma_f32_16x16x32_bf16 v[200:203], v[144:147], v[160:163], 0
  v_mfma_f32_16x16x32_bf16 v[204:207], v[148:151], v[160:163], 0
  v_mfma_f32_16x16x16_bf16 v[176:179], v[152:153], v[164:165], v[176:179]
  v_mfma_f32_16x16x16_bf16 v[180:183], v[152:153], v[166:167], v[180:183]
  v_mfma_f32_16x16x16_bf16 v[184:187], v[154:155], v[164:165], v[184:187]
  v_mfma_f32_16x16x16_bf16 v[188:191], v[154:155], v[166:167], v[188:191]
  v_mfma_f32_16x16x16_bf16 v[192:195], v[156:157], v[164:165], v[192:195]
  v_mfma_f32_16x16x16_bf16 v[196:199], v[156:157], v[166:167], v[196:199]
  v_mfma_f32_16x16x16_bf16 v[200:203], v[158:159], v[164:165], v[200:203]
  v_mfma_f32_16x16x16_bf16 v[204:207], v[158:159], v[166:167], v[204:207]
  v_mfma_f32_16x16x32_bf16 v[208:211], v[120:123], v[168:171], 0
  v_mfma_f32_16x16x32_bf16 v[212:215], v[124:127], v[168:171], 0
  v_mfma_f32_16x16x32_bf16 v[216:219], v[128:131], v[168:171], 0
  v_mfma_f32_16x16x32_bf16 v[220:223], v[132:135], v[168:171], 0
  v_mfma_f32_16x16x32_bf16 v[224:227], v[136:139], v[168:171], 0
  v_mfma_f32_16x16x32_bf16 v[228:231], v[140:143], v[168:171], 0
  v_mfma_f32_16x16x32_bf16 v[232:235], v[144:147], v[168:171], 0
  v_mfma_f32_16x16x32_bf16 v[236:239], v[148:151], v[168:171], 0
  v_mfma_f32_16x16x16_bf16 v[208:211], v[152:153], v[172:173], v[208:211]
  v_mfma_f32_16x16x16_bf16 v[212:215], v[152:153], v[174:175], v[212:215]
  v_mfma_f32_16x16x16_bf16 v[216:219], v[154:155], v[172:173], v[216:219]
  v_mfma_f32_16x16x16_bf16 v[220:223], v[154:155], v[174:175], v[220:223]
  v_mfma_f32_16x16x16_bf16 v[224:227], v[156:157], v[172:173], v[224:227]
  v_mfma_f32_16x16x16_bf16 v[228:231], v[156:157], v[174:175], v[228:231]
  v_mfma_f32_16x16x16_bf16 v[232:235], v[158:159], v[172:173], v[232:235]
  v_mfma_f32_16x16x16_bf16 v[236:239], v[158:159], v[174:175], v[236:239]
  s_lshl_b32 s22, s8, 13
  s_add_u32 s22, s22, 98304
  v_lshlrev_b32 v1, 8, v6
  v_add_u32 v1, s22, v1
  v_bfe_u32 v2, v0, 4, 1
  v_lshlrev_b32 v2, 1, v2
  v_lshrrev_b32 v3, 5, v0
  v_add_u32 v2, v2, v3
  v_and_b32 v3, 7, v0
  v_mul_f32 v176, v176, v14
  v_mul_f32 v180, v180, v14
  v_mul_f32 v177, v177, v14
  v_mul_f32 v181, v181, v14
  v_mul_f32 v178, v178, v14
  v_mul_f32 v182, v182, v14
  v_mul_f32 v179, v179, v14
  v_mul_f32 v183, v183, v14
  v_cvt_pk_bf16_f32 v16, v176, v177
  v_cvt_pk_bf16_f32 v17, v178, v179
  v_cvt_pk_bf16_f32 v18, v180, v181
  v_cvt_pk_bf16_f32 v19, v182, v183
  s_nop 0
  v_permlane16_swap_b32 v16, v18
  v_permlane16_swap_b32 v17, v19
  v_add_u32 v4, 0, v2
  v_xor_b32 v4, v4, v3
  v_lshlrev_b32 v4, 4, v4
  v_add_u32 v4, v4, v1
  ds_write_b128 v4, v[16:19] offset:0
  v_mul_f32 v184, v184, v14
  v_mul_f32 v188, v188, v14
  v_mul_f32 v185, v185, v14
  v_mul_f32 v189, v189, v14
  v_mul_f32 v186, v186, v14
  v_mul_f32 v190, v190, v14
  v_mul_f32 v187, v187, v14
  v_mul_f32 v191, v191, v14
  v_cvt_pk_bf16_f32 v20, v184, v185
  v_cvt_pk_bf16_f32 v21, v186, v187
  v_cvt_pk_bf16_f32 v22, v188, v189
  v_cvt_pk_bf16_f32 v23, v190, v191
  s_nop 0
  v_permlane16_swap_b32 v20, v22
  v_permlane16_swap_b32 v21, v23
  v_add_u32 v4, 4, v2
  v_xor_b32 v4, v4, v3
  v_lshlrev_b32 v4, 4, v4
  v_add_u32 v4, v4, v1
  ds_write_b128 v4, v[20:23] offset:0
  v_mul_f32 v192, v192, v14
  v_mul_f32 v196, v196, v14
  v_mul_f32 v193, v193, v14
  v_mul_f32 v197, v197, v14
  v_mul_f32 v194, v194, v14
  v_mul_f32 v198, v198, v14
  v_mul_f32 v195, v195, v14
  v_mul_f32 v199, v199, v14
  v_cvt_pk_bf16_f32 v16, v192, v193
  v_cvt_pk_bf16_f32 v17, v194, v195
  v_cvt_pk_bf16_f32 v18, v196, v197
  v_cvt_pk_bf16_f32 v19, v198, v199
  s_nop 0
  v_permlane16_swap_b32 v16, v18
  v_permlane16_swap_b32 v17, v19
  v_add_u32 v4, 8, v2
  v_xor_b32 v4, v4, v3
  v_lshlrev_b32 v4, 4, v4
  v_add_u32 v4, v4, v1
  ds_write_b128 v4, v[16:19] offset:0
  v_mul_f32 v200, v200, v14
  v_mul_f32 v204, v204, v14
  v_mul_f32 v201, v201, v14
  v_mul_f32 v205, v205, v14
  v_mul_f32 v202, v202, v14
  v_mul_f32 v206, v206, v14
  v_mul_f32 v203, v203, v14
  v_mul_f32 v207, v207, v14
  v_cvt_pk_bf16_f32 v20, v200, v201
  v_cvt_pk_bf16_f32 v21, v202, v203
  v_cvt_pk_bf16_f32 v22, v204, v205
  v_cvt_pk_bf16_f32 v23, v206, v207
  s_nop 0
  v_permlane16_swap_b32 v20, v22
  v_permlane16_swap_b32 v21, v23
  v_add_u32 v4, 12, v2
  v_xor_b32 v4, v4, v3
  v_lshlrev_b32 v4, 4, v4
  v_add_u32 v4, v4, v1
  ds_write_b128 v4, v[20:23] offset:0
  v_mul_f32 v208, v208, v15
  v_mul_f32 v212, v212, v15
  v_mul_f32 v209, v209, v15
  v_mul_f32 v213, v213, v15
  v_mul_f32 v210, v210, v15
  v_mul_f32 v214, v214, v15
  v_mul_f32 v211, v211, v15
  v_mul_f32 v215, v215, v15
  v_cvt_pk_bf16_f32 v16, v208, v209
  v_cvt_pk_bf16_f32 v17, v210, v211
  v_cvt_pk_bf16_f32 v18, v212, v213
  v_cvt_pk_bf16_f32 v19, v214, v215
  s_nop 0
  v_permlane16_swap_b32 v16, v18
  v_permlane16_swap_b32 v17, v19
  v_add_u32 v4, 0, v2
  v_xor_b32 v4, v4, v3
  v_lshlrev_b32 v4, 4, v4
  v_add_u32 v4, v4, v1
  ds_write_b128 v4, v[16:19] offset:4096
  v_mul_f32 v216, v216, v15
  v_mul_f32 v220, v220, v15
  v_mul_f32 v217, v217, v15
  v_mul_f32 v221, v221, v15
  v_mul_f32 v218, v218, v15
  v_mul_f32 v222, v222, v15
  v_mul_f32 v219, v219, v15
  v_mul_f32 v223, v223, v15
  v_cvt_pk_bf16_f32 v20, v216, v217
  v_cvt_pk_bf16_f32 v21, v218, v219
  v_cvt_pk_bf16_f32 v22, v220, v221
  v_cvt_pk_bf16_f32 v23, v222, v223
  s_nop 0
  v_permlane16_swap_b32 v20, v22
  v_permlane16_swap_b32 v21, v23
  v_add_u32 v4, 4, v2
  v_xor_b32 v4, v4, v3
  v_lshlrev_b32 v4, 4, v4
  v_add_u32 v4, v4, v1
  ds_write_b128 v4, v[20:23] offset:4096
  v_mul_f32 v224, v224, v15
  v_mul_f32 v228, v228, v15
  v_mul_f32 v225, v225, v15
  v_mul_f32 v229, v229, v15
  v_mul_f32 v226, v226, v15
  v_mul_f32 v230, v230, v15
  v_mul_f32 v227, v227, v15
  v_mul_f32 v231, v231, v15
  v_cvt_pk_bf16_f32 v16, v224, v225
  v_cvt_pk_bf16_f32 v17, v226, v227
  v_cvt_pk_bf16_f32 v18, v228, v229
  v_cvt_pk_bf16_f32 v19, v230, v231
  s_nop 0
  v_permlane16_swap_b32 v16, v18
  v_permlane16_swap_b32 v17, v19
  v_add_u32 v4, 8, v2
  v_xor_b32 v4, v4, v3
  v_lshlrev_b32 v4, 4, v4
  v_add_u32 v4, v4, v1
  ds_write_b128 v4, v[16:19] offset:4096
  v_mul_f32 v232, v232, v15
  v_mul_f32 v236, v236, v15
  v_mul_f32 v233, v233, v15
  v_mul_f32 v237, v237, v15
  v_mul_f32 v234, v234, v15
  v_mul_f32 v238, v238, v15
  v_mul_f32 v235, v235, v15
  v_mul_f32 v239, v239, v15
  v_cvt_pk_bf16_f32 v20, v232, v233
  v_cvt_pk_bf16_f32 v21, v234, v235
  v_cvt_pk_bf16_f32 v22, v236, v237
  v_cvt_pk_bf16_f32 v23, v238, v239
  s_nop 0
  v_permlane16_swap_b32 v20, v22
  v_permlane16_swap_b32 v21, v23
  v_add_u32 v4, 12, v2
  v_xor_b32 v4, v4, v3
  v_lshlrev_b32 v4, 4, v4
  v_add_u32 v4, v4, v1
  ds_write_b128 v4, v[20:23] offset:4096
  v_lshrrev_b32 v7, 4, v0
  v_xor_b32 v2, v6, v7
  v_xor_b32 v3, 4, v2
  v_lshlrev_b32 v2, 4, v2
  v_lshlrev_b32 v3, 4, v3
  v_lshlrev_b32 v4, 8, v7
  v_add_u32 v4, s22, v4
  v_add_u32 v2, v2, v4
  v_add_u32 v3, v3, v4
  v_lshlrev_b32 v5, 13, v7
  v_lshlrev_b32 v4, 4, v6
  v_add_u32 v5, v5, v4
  s_waitcnt lgkmcnt(0)
  ds_read_b128 v[48:51], v2 offset:0
  ds_read_b128 v[52:55], v3 offset:1024
  ds_read_b128 v[56:59], v2 offset:2048
  ds_read_b128 v[60:63], v3 offset:3072
  ds_read_b128 v[64:67], v2 offset:4096
  ds_read_b128 v[68:71], v3 offset:5120
  ds_read_b128 v[72:75], v2 offset:6144
  ds_read_b128 v[76:79], v3 offset:7168
  s_waitcnt lgkmcnt(7)
  s_add_u32 s22, s16, 0
  buffer_store_dwordx4 v[48:51], v5, s[4:7], s22 offen sc1
  s_waitcnt lgkmcnt(6)
  s_add_u32 s22, s16, 32768
  buffer_store_dwordx4 v[52:55], v5, s[4:7], s22 offen sc1
  s_waitcnt lgkmcnt(5)
  s_add_u32 s22, s16, 65536
  buffer_store_dwordx4 v[56:59], v5, s[4:7], s22 offen sc1
  s_waitcnt lgkmcnt(4)
  s_add_u32 s22, s16, 98304
  buffer_store_dwordx4 v[60:63], v5, s[4:7], s22 offen sc1
  s_waitcnt lgkmcnt(3)
  s_add_u32 s22, s16, 131072
  buffer_store_dwordx4 v[64:67], v5, s[4:7], s22 offen sc1
  s_waitcnt lgkmcnt(2)
  s_add_u32 s22, s16, 163840
  buffer_store_dwordx4 v[68:71], v5, s[4:7], s22 offen sc1
  s_waitcnt lgkmcnt(1)
  s_add_u32 s22, s16, 196608
  buffer_store_dwordx4 v[72:75], v5, s[4:7], s22 offen sc1
  s_waitcnt lgkmcnt(0)
  s_add_u32 s22, s16, 229376
  buffer_store_dwordx4 v[76:79], v5, s[4:7], s22 offen sc1
  s_lshl_b32 s49, s38, 7
  s_add_u32 s49, s49, 85073920
  s_waitcnt vmcnt(0)
  s_barrier
  v_cmp_eq_u32 vcc, 0, v254
  s_nop 0
  s_and_saveexec_b64 s[56:57], vcc
  s_cbranch_execz sig_4400090
  v_mov_b32 v250, 1
  v_mov_b32 v251, 0
  buffer_atomic_add v250, v251, s[4:7], s49 offen
sig_4400090:
  s_mov_b64 exec, s[56:57]
  s_barrier
  s_add_u32 s38, s38, 2
  s_cmp_lt_u32 s38, 32
  s_cbranch_scc1 rlp_4400077
  s_branch post_done
rk_4400076:
  s_sub_u32 s39, s39, 32
  s_cmp_ge_u32 s39, 40
  s_nop 0
  s_cbranch_scc1 rk_4400091
  s_mov_b32 s38, 0
  s_mov_b32 s62, s39
  s_load_dwordx2 s[8:9], s[0:1], 40
  s_mov_b32 s10, 5242880
  s_mov_b32 s11, 0x00020000
  s_and_b32 s42, s39, 7
  s_lshr_b32 s41, s39, 3
  v_mov_b32 v0, v254
  v_lshrrev_b32 v22, 6, v0
  s_nop 0
  v_readfirstlane_b32 s24, v22
  v_and_b32 v0, 63, v0
  s_lshr_b32 s25, s24, 1
  s_and_b32 s26, s24, 1
  v_lshrrev_b32 v22, 3, v0
  s_mov_b32 s30, 8192
  v_mul_lo_u32 v22, v22, s30
  v_and_b32 v23, 7, v0
  v_lshrrev_b32 v24, 4, v0
  v_xor_b32 v23, v23, v24
  v_lshlrev_b32 v24, 4, v23
  v_add_u32 v1, v22, v24
  v_xor_b32 v23, 4, v23
  v_lshlrev_b32 v24, 4, v23
  v_add_u32 v2, v22, v24
  v_lshrrev_b32 v22, 4, v0
  s_mov_b32 s30, 1280
  v_mul_lo_u32 v23, v22, s30
  v_bfe_u32 v24, v0, 2, 2
  v_xor_b32 v24, v24, v22
  v_lshlrev_b32 v24, 6, v24
  v_add_u32 v23, v23, v24
  v_and_b32 v24, 3, v0
  v_lshlrev_b32 v24, 4, v24
  v_add_u32 v3, v23, v24
  v_and_b32 v22, 31, v0
  s_lshl_b32 s30, s25, 5
  v_add_u32 v23, s30, v22
  v_lshlrev_b32 v23, 7, v23
  v_bfe_u32 v24, v0, 1, 3
  v_lshrrev_b32 v25, 5, v0
  v_add_u32 v26, 0, v25
  v_xor_b32 v26, v26, v24
  v_lshlrev_b32 v26, 4, v26
  v_add_u32 v4, v23, v26
  v_add_u32 v8, 65536, v4
  v_add_u32 v26, 2, v25
  v_xor_b32 v26, v26, v24
  v_lshlrev_b32 v26, 4, v26
  v_add_u32 v5, v23, v26
  v_add_u32 v9, 65536, v5
  v_add_u32 v26, 4, v25
  v_xor_b32 v26, v26, v24
  v_lshlrev_b32 v26, 4, v26
  v_add_u32 v6, v23, v26
  v_add_u32 v10, 65536, v6
  v_add_u32 v26, 6, v25
  v_xor_b32 v26, v26, v24
  v_lshlrev_b32 v26, 4, v26
  v_add_u32 v7, v23, v26
  v_add_u32 v11, 65536, v7
  v_lshrrev_b32 v22, 5, v0
  v_lshlrev_b32 v22, 3, v22
  v_bfe_u32 v23, v0, 2, 2
  v_add_u32 v22, v22, v23
  v_lshlrev_b32 v22, 8, v22
  v_bfe_u32 v24, v0, 4, 1
  v_lshlrev_b32 v24, 5, v24
  v_add_u32 v22, v22, v24
  v_and_b32 v24, 3, v0
  v_lshlrev_b32 v24, 3, v24
  v_add_u32 v22, v22, v24
  s_lshl_b32 s30, s26, 1
  s_add_u32 s31, s30, 0
  v_xor_b32 v24, s31, v23
  v_lshlrev_b32 v24, 6, v24
  v_add_u32 v24, v22, v24
  v_add_u32 v16, 131072, v24
  s_add_u32 s31, s30, 1
  v_xor_b32 v24, s31, v23
  v_lshlrev_b32 v24, 6, v24
  v_add_u32 v24, v22, v24
  v_add_u32 v17, 131072, v24
  s_lshl_b32 s35, s24, 11
  s_lshl_b32 s36, s24, 12
  s_add_u32 s36, s36, 131072
  s_mul_i32 s28, s42, 655360
  s_lshl_b32 s31, s41, 8
  s_add_u32 s28, s28, s31
  s_mul_i32 s31, s24, 20480
  s_add_u32 s28, s28, s31
  s_waitcnt lgkmcnt(0)
  s_barrier
  s_add_u32 s30, s28, 0
  s_sub_u32 m0, s36, 131072
  s_nop 0
  buffer_load_dwordx4 v3, s[8:11], s30 offen lds
  s_add_u32 s30, s28, 5120
  s_sub_u32 m0, s36, 130048
  s_nop 0
  buffer_load_dwordx4 v3, s[8:11], s30 offen lds
  s_add_u32 s30, s28, 10240
  s_sub_u32 m0, s36, 129024
  s_nop 0
  buffer_load_dwordx4 v3, s[8:11], s30 offen lds
  s_add_u32 s30, s28, 15360
  s_sub_u32 m0, s36, 128000
  s_nop 0
  buffer_load_dwordx4 v3, s[8:11], s30 offen lds
  s_add_u32 s30, s28, 81920
  s_sub_u32 m0, s36, 114688
  s_nop 0
  buffer_load_dwordx4 v3, s[8:11], s30 offen lds
  s_add_u32 s30, s28, 87040
  s_sub_u32 m0, s36, 113664
  s_nop 0
  buffer_load_dwordx4 v3, s[8:11], s30 offen lds
  s_add_u32 s30, s28, 92160
  s_sub_u32 m0, s36, 112640
  s_nop 0
  buffer_load_dwordx4 v3, s[8:11], s30 offen lds
  s_add_u32 s30, s28, 97280
  s_sub_u32 m0, s36, 111616
  s_nop 0
  buffer_load_dwordx4 v3, s[8:11], s30 offen lds
  s_add_u32 s30, s28, 163840
  s_sub_u32 m0, s36, 98304
  s_nop 0
  buffer_load_dwordx4 v3, s[8:11], s30 offen lds
  s_add_u32 s30, s28, 168960
  s_sub_u32 m0, s36, 97280
  s_nop 0
  buffer_load_dwordx4 v3, s[8:11], s30 offen lds
  s_add_u32 s30, s28, 174080
  s_sub_u32 m0, s36, 96256
  s_nop 0
  buffer_load_dwordx4 v3, s[8:11], s30 offen lds
  s_add_u32 s30, s28, 179200
  s_sub_u32 m0, s36, 95232
  s_nop 0
  buffer_load_dwordx4 v3, s[8:11], s30 offen lds
  s_add_u32 s30, s28, 245760
  s_sub_u32 m0, s36, 81920
  s_nop 0
  buffer_load_dwordx4 v3, s[8:11], s30 offen lds
  s_add_u32 s30, s28, 250880
  s_sub_u32 m0, s36, 80896
  s_nop 0
  buffer_load_dwordx4 v3, s[8:11], s30 offen lds
  s_add_u32 s30, s28, 256000
  s_sub_u32 m0, s36, 79872
  s_nop 0
  buffer_load_dwordx4 v3, s[8:11], s30 offen lds
  s_add_u32 s30, s28, 261120
  s_sub_u32 m0, s36, 78848
  s_nop 0
  buffer_load_dwordx4 v3, s[8:11], s30 offen lds
  s_add_u32 s30, s28, 327680
  s_sub_u32 m0, s36, 65536
  s_nop 0
  buffer_load_dwordx4 v3, s[8:11], s30 offen lds
  s_add_u32 s30, s28, 332800
  s_sub_u32 m0, s36, 64512
  s_nop 0
  buffer_load_dwordx4 v3, s[8:11], s30 offen lds
  s_add_u32 s30, s28, 337920
  s_sub_u32 m0, s36, 63488
  s_nop 0
  buffer_load_dwordx4 v3, s[8:11], s30 offen lds
  s_add_u32 s30, s28, 343040
  s_sub_u32 m0, s36, 62464
  s_nop 0
  buffer_load_dwordx4 v3, s[8:11], s30 offen lds
  s_add_u32 s30, s28, 409600
  s_sub_u32 m0, s36, 49152
  s_nop 0
  buffer_load_dwordx4 v3, s[8:11], s30 offen lds
  s_add_u32 s30, s28, 414720
  s_sub_u32 m0, s36, 48128
  s_nop 0
  buffer_load_dwordx4 v3, s[8:11], s30 offen lds
  s_add_u32 s30, s28, 419840
  s_sub_u32 m0, s36, 47104
  s_nop 0
  buffer_load_dwordx4 v3, s[8:11], s30 offen lds
  s_add_u32 s30, s28, 424960
  s_sub_u32 m0, s36, 46080
  s_nop 0
  buffer_load_dwordx4 v3, s[8:11], s30 offen lds
  s_add_u32 s30, s28, 491520
  s_sub_u32 m0, s36, 32768
  s_nop 0
  buffer_load_dwordx4 v3, s[8:11], s30 offen lds
  s_add_u32 s30, s28, 496640
  s_sub_u32 m0, s36, 31744
  s_nop 0
  buffer_load_dwordx4 v3, s[8:11], s30 offen lds
  s_add_u32 s30, s28, 501760
  s_sub_u32 m0, s36, 30720
  s_nop 0
  buffer_load_dwordx4 v3, s[8:11], s30 offen lds
  s_add_u32 s30, s28, 506880
  s_sub_u32 m0, s36, 29696
  s_nop 0
  buffer_load_dwordx4 v3, s[8:11], s30 offen lds
  s_add_u32 s30, s28, 573440
  s_sub_u32 m0, s36, 16384
  s_nop 0
  buffer_load_dwordx4 v3, s[8:11], s30 offen lds
  s_add_u32 s30, s28, 578560
  s_sub_u32 m0, s36, 15360
  s_nop 0
  buffer_load_dwordx4 v3, s[8:11], s30 offen lds
  s_add_u32 s30, s28, 583680
  s_sub_u32 m0, s36, 14336
  s_nop 0
  buffer_load_dwordx4 v3, s[8:11], s30 offen lds
  s_add_u32 s30, s28, 588800
  s_sub_u32 m0, s36, 13312
  s_nop 0
  buffer_load_dwordx4 v3, s[8:11], s30 offen lds
  s_waitcnt vmcnt(28)
  s_barrier
  v_subrev_u32 v22, 131072, v16
  v_subrev_u32 v23, 131072, v17
  ds_read_b64_tr_b16 a[0:1], v22 offset:0
  ds_read_b64_tr_b16 a[2:3], v22 offset:1024
  ds_read_b64_tr_b16 a[4:5], v23 offset:0
  ds_read_b64_tr_b16 a[6:7], v23 offset:1024
  ds_read_b64_tr_b16 a[8:9], v22 offset:4096
  ds_read_b64_tr_b16 a[10:11], v22 offset:5120
  ds_read_b64_tr_b16 a[12:13], v23 offset:4096
  ds_read_b64_tr_b16 a[14:15], v23 offset:5120
  ds_read_b64_tr_b16 a[16:17], v22 offset:8192
  ds_read_b64_tr_b16 a[18:19], v22 offset:9216
  ds_read_b64_tr_b16 a[20:21], v23 offset:8192
  ds_read_b64_tr_b16 a[22:23], v23 offset:9216
  ds_read_b64_tr_b16 a[24:25], v22 offset:12288
  ds_read_b64_tr_b16 a[26:27], v22 offset:13312
  ds_read_b64_tr_b16 a[28:29], v23 offset:12288
  ds_read_b64_tr_b16 a[30:31], v23 offset:13312
  s_waitcnt vmcnt(24)
  s_barrier
  v_subrev_u32 v22, 114688, v16
  v_subrev_u32 v23, 114688, v17
  ds_read_b64_tr_b16 a[32:33], v22 offset:0
  ds_read_b64_tr_b16 a[34:35], v22 offset:1024
  ds_read_b64_tr_b16 a[36:37], v23 offset:0
  ds_read_b64_tr_b16 a[38:39], v23 offset:1024
  ds_read_b64_tr_b16 a[40:41], v22 offset:4096
  ds_read_b64_tr_b16 a[42:43], v22 offset:5120
  ds_read_b64_tr_b16 a[44:45], v23 offset:4096
  ds_read_b64_tr_b16 a[46:47], v23 offset:5120
  ds_read_b64_tr_b16 a[48:49], v22 offset:8192
  ds_read_b64_tr_b16 a[50:51], v22 offset:9216
  ds_read_b64_tr_b16 a[52:53], v23 offset:8192
  ds_read_b64_tr_b16 a[54:55], v23 offset:9216
  ds_read_b64_tr_b16 a[56:57], v22 offset:12288
  ds_read_b64_tr_b16 a[58:59], v22 offset:13312
  ds_read_b64_tr_b16 a[60:61], v23 offset:12288
  ds_read_b64_tr_b16 a[62:63], v23 offset:13312
  s_waitcnt vmcnt(20)
  s_barrier
  v_subrev_u32 v22, 98304, v16
  v_subrev_u32 v23, 98304, v17
  ds_read_b64_tr_b16 a[64:65], v22 offset:0
  ds_read_b64_tr_b16 a[66:67], v22 offset:1024
  ds_read_b64_tr_b16 a[68:69], v23 offset:0
  ds_read_b64_tr_b16 a[70:71], v23 offset:1024
  ds_read_b64_tr_b16 a[72:73], v22 offset:4096
  ds_read_b64_tr_b16 a[74:75], v22 offset:5120
  ds_read_b64_tr_b16 a[76:77], v23 offset:4096
  ds_read_b64_tr_b16 a[78:79], v23 offset:5120
  ds_read_b64_tr_b16 a[80:81], v22 offset:8192
  ds_read_b64_tr_b16 a[82:83], v22 offset:9216
  ds_read_b64_tr_b16 a[84:85], v23 offset:8192
  ds_read_b64_tr_b16 a[86:87], v23 offset:9216
  ds_read_b64_tr_b16 a[88:89], v22 offset:12288
  ds_read_b64_tr_b16 a[90:91], v22 offset:13312
  ds_read_b64_tr_b16 a[92:93], v23 offset:12288
  ds_read_b64_tr_b16 a[94:95], v23 offset:13312
  s_waitcnt vmcnt(16)
  s_barrier
  v_subrev_u32 v22, 81920, v16
  v_subrev_u32 v23, 81920, v17
  ds_read_b64_tr_b16 a[96:97], v22 offset:0
  ds_read_b64_tr_b16 a[98:99], v22 offset:1024
  ds_read_b64_tr_b16 a[100:101], v23 offset:0
  ds_read_b64_tr_b16 a[102:103], v23 offset:1024
  ds_read_b64_tr_b16 a[104:105], v22 offset:4096
  ds_read_b64_tr_b16 a[106:107], v22 offset:5120
  ds_read_b64_tr_b16 a[108:109], v23 offset:4096
  ds_read_b64_tr_b16 a[110:111], v23 offset:5120
  ds_read_b64_tr_b16 a[112:113], v22 offset:8192
  ds_read_b64_tr_b16 a[114:115], v22 offset:9216
  ds_read_b64_tr_b16 a[116:117], v23 offset:8192
  ds_read_b64_tr_b16 a[118:119], v23 offset:9216
  ds_read_b64_tr_b16 a[120:121], v22 offset:12288
  ds_read_b64_tr_b16 a[122:123], v22 offset:13312
  ds_read_b64_tr_b16 a[124:125], v23 offset:12288
  ds_read_b64_tr_b16 a[126:127], v23 offset:13312
  s_waitcnt vmcnt(12)
  s_barrier
  v_subrev_u32 v22, 65536, v16
  v_subrev_u32 v23, 65536, v17
  ds_read_b64_tr_b16 a[128:129], v22 offset:0
  ds_read_b64_tr_b16 a[130:131], v22 offset:1024
  ds_read_b64_tr_b16 a[132:133], v23 offset:0
  ds_read_b64_tr_b16 a[134:135], v23 offset:1024
  ds_read_b64_tr_b16 a[136:137], v22 offset:4096
  ds_read_b64_tr_b16 a[138:139], v22 offset:5120
  ds_read_b64_tr_b16 a[140:141], v23 offset:4096
  ds_read_b64_tr_b16 a[142:143], v23 offset:5120
  ds_read_b64_tr_b16 a[144:145], v22 offset:8192
  ds_read_b64_tr_b16 a[146:147], v22 offset:9216
  ds_read_b64_tr_b16 a[148:149], v23 offset:8192
  ds_read_b64_tr_b16 a[150:151], v23 offset:9216
  ds_read_b64_tr_b16 a[152:153], v22 offset:12288
  ds_read_b64_tr_b16 a[154:155], v22 offset:13312
  ds_read_b64_tr_b16 a[156:157], v23 offset:12288
  ds_read_b64_tr_b16 a[158:159], v23 offset:13312
  s_waitcnt vmcnt(8)
  s_barrier
  v_subrev_u32 v22, 49152, v16
  v_subrev_u32 v23, 49152, v17
  ds_read_b64_tr_b16 a[160:161], v22 offset:0
  ds_read_b64_tr_b16 a[162:163], v22 offset:1024
  ds_read_b64_tr_b16 a[164:165], v23 offset:0
  ds_read_b64_tr_b16 a[166:167], v23 offset:1024
  ds_read_b64_tr_b16 a[168:169], v22 offset:4096
  ds_read_b64_tr_b16 a[170:171], v22 offset:5120
  ds_read_b64_tr_b16 a[172:173], v23 offset:4096
  ds_read_b64_tr_b16 a[174:175], v23 offset:5120
  ds_read_b64_tr_b16 a[176:177], v22 offset:8192
  ds_read_b64_tr_b16 a[178:179], v22 offset:9216
  ds_read_b64_tr_b16 a[180:181], v23 offset:8192
  ds_read_b64_tr_b16 a[182:183], v23 offset:9216
  ds_read_b64_tr_b16 a[184:185], v22 offset:12288
  ds_read_b64_tr_b16 a[186:187], v22 offset:13312
  ds_read_b64_tr_b16 a[188:189], v23 offset:12288
  ds_read_b64_tr_b16 a[190:191], v23 offset:13312
  s_waitcnt vmcnt(4)
  s_barrier
  v_subrev_u32 v22, 32768, v16
  v_subrev_u32 v23, 32768, v17
  ds_read_b64_tr_b16 a[192:193], v22 offset:0
  ds_read_b64_tr_b16 a[194:195], v22 offset:1024
  ds_read_b64_tr_b16 a[196:197], v23 offset:0
  ds_read_b64_tr_b16 a[198:199], v23 offset:1024
  ds_read_b64_tr_b16 a[200:201], v22 offset:4096
  ds_read_b64_tr_b16 a[202:203], v22 offset:5120
  ds_read_b64_tr_b16 a[204:205], v23 offset:4096
  ds_read_b64_tr_b16 a[206:207], v23 offset:5120
  ds_read_b64_tr_b16 a[208:209], v22 offset:8192
  ds_read_b64_tr_b16 a[210:211], v22 offset:9216
  ds_read_b64_tr_b16 a[212:213], v23 offset:8192
  ds_read_b64_tr_b16 a[214:215], v23 offset:9216
  ds_read_b64_tr_b16 a[216:217], v22 offset:12288
  ds_read_b64_tr_b16 a[218:219], v22 offset:13312
  ds_read_b64_tr_b16 a[220:221], v23 offset:12288
  ds_read_b64_tr_b16 a[222:223], v23 offset:13312
  s_waitcnt vmcnt(0)
  s_barrier
  v_subrev_u32 v22, 16384, v16
  v_subrev_u32 v23, 16384, v17
  ds_read_b64_tr_b16 a[224:225], v22 offset:0
  ds_read_b64_tr_b16 a[226:227], v22 offset:1024
  ds_read_b64_tr_b16 a[228:229], v23 offset:0
  ds_read_b64_tr_b16 a[230:231], v23 offset:1024
  ds_read_b64_tr_b16 a[232:233], v22 offset:4096
  ds_read_b64_tr_b16 a[234:235], v22 offset:5120
  ds_read_b64_tr_b16 a[236:237], v23 offset:4096
  ds_read_b64_tr_b16 a[238:239], v23 offset:5120
  ds_read_b64_tr_b16 a[240:241], v22 offset:8192
  ds_read_b64_tr_b16 a[242:243], v22 offset:9216
  ds_read_b64_tr_b16 a[244:245], v23 offset:8192
  ds_read_b64_tr_b16 a[246:247], v23 offset:9216
  ds_read_b64_tr_b16 a[248:249], v22 offset:12288
  ds_read_b64_tr_b16 a[250:251], v22 offset:13312
  ds_read_b64_tr_b16 a[252:253], v23 offset:12288
  ds_read_b64_tr_b16 a[254:255], v23 offset:13312
  s_waitcnt lgkmcnt(0)
  s_barrier
rlp_4400092:
  s_mov_b32 s39, s62
  s_lshl_b32 s49, s38, 7
  s_add_u32 s49, s49, 85073920
  v_readfirstlane_b32 s56, v254
  s_nop 0
  s_cmp_ge_u32 s56, 64
  s_nop 0
  s_cbranch_scc1 wok_4400094
  v_mov_b32 v251, 0
wc_4400093:
  buffer_load_dword v250, v251, s[4:7], s49 offen sc1
  s_waitcnt vmcnt(0)
  v_readfirstlane_b32 s56, v250
  s_nop 0
  s_cmp_ge_u32 s56, 16
  s_nop 0
  s_cbranch_scc1 wok_4400094
  s_add_u32 s63, s63, 1
  s_cmp_gt_u32 s63, 4194304
  s_cbranch_scc1 fz_fail
  s_cmp_ge_u32 s38, 31
  s_cbranch_scc1 nap_4400095
  s_sleep 24
  s_branch nape_4400096
nap_4400095:
  s_sleep 12
nape_4400096:
  s_branch wc_4400093
wok_4400094:
  s_barrier
  s_lshl_b32 s30, s38, 6
  s_lshl_b32 s31, s24, 4
  s_add_u32 s30, s30, s31
  s_lshl_b32 s27, s30, 13
  s_add_u32 s27, s27, 54525952
  s_mul_i32 s31, s42, 1024
  s_add_u32 s27, s27, s31
  s_add_u32 s30, s27, 0
  s_add_u32 m0, s35, 0
  s_nop 0
  buffer_load_dwordx4 v1, s[4:7], s30 offen lds
  s_add_u32 s30, s27, 65536
  s_add_u32 m0, s35, 1024
  s_nop 0
  buffer_load_dwordx4 v2, s[4:7], s30 offen lds
  s_add_u32 s30, s27, 128
  s_add_u32 m0, s35, 8192
  s_nop 0
  buffer_load_dwordx4 v1, s[4:7], s30 offen lds
  s_add_u32 s30, s27, 65664
  s_add_u32 m0, s35, 9216
  s_nop 0
  buffer_load_dwordx4 v2, s[4:7], s30 offen lds
  s_add_u32 s30, s27, 256
  s_add_u32 m0, s35, 16384
  s_nop 0
  buffer_load_dwordx4 v1, s[4:7], s30 offen lds
  s_add_u32 s30, s27, 65792
  s_add_u32 m0, s35, 17408
  s_nop 0
  buffer_load_dwordx4 v2, s[4:7], s30 offen lds
  s_add_u32 s30, s27, 384
  s_add_u32 m0, s35, 24576
  s_nop 0
  buffer_load_dwordx4 v1, s[4:7], s30 offen lds
  s_add_u32 s30, s27, 65920
  s_add_u32 m0, s35, 25600
  s_nop 0
  buffer_load_dwordx4 v2, s[4:7], s30 offen lds
  s_add_u32 s30, s27, 512
  s_add_u32 m0, s35, 32768
  s_nop 0
  buffer_load_dwordx4 v1, s[4:7], s30 offen lds
  s_add_u32 s30, s27, 66048
  s_add_u32 m0, s35, 33792
  s_nop 0
  buffer_load_dwordx4 v2, s[4:7], s30 offen lds
  s_add_u32 s30, s27, 640
  s_add_u32 m0, s35, 40960
  s_nop 0
  buffer_load_dwordx4 v1, s[4:7], s30 offen lds
  s_add_u32 s30, s27, 66176
  s_add_u32 m0, s35, 41984
  s_nop 0
  buffer_load_dwordx4 v2, s[4:7], s30 offen lds
  s_add_u32 s30, s27, 768
  s_add_u32 m0, s35, 49152
  s_nop 0
  buffer_load_dwordx4 v1, s[4:7], s30 offen lds
  s_add_u32 s30, s27, 66304
  s_add_u32 m0, s35, 50176
  s_nop 0
  buffer_load_dwordx4 v2, s[4:7], s30 offen lds
  s_add_u32 s30, s27, 896
  s_add_u32 m0, s35, 57344
  s_nop 0
  buffer_load_dwordx4 v1, s[4:7], s30 offen lds
  s_add_u32 s30, s27, 66432
  s_add_u32 m0, s35, 58368
  s_nop 0
  buffer_load_dwordx4 v2, s[4:7], s30 offen lds
  v_mov_b64 v[64:65], 0
  v_mov_b64 v[66:67], 0
  v_mov_b64 v[68:69], 0
  v_mov_b64 v[70:71], 0
  v_mov_b64 v[72:73], 0
  v_mov_b64 v[74:75], 0
  v_mov_b64 v[76:77], 0
  v_mov_b64 v[78:79], 0
  v_mov_b64 v[80:81], 0
  v_mov_b64 v[82:83], 0
  v_mov_b64 v[84:85], 0
  v_mov_b64 v[86:87], 0
  v_mov_b64 v[88:89], 0
  v_mov_b64 v[90:91], 0
  v_mov_b64 v[92:93], 0
  v_mov_b64 v[94:95], 0
  s_waitcnt vmcnt(14) lgkmcnt(0)
  s_barrier
  ds_read_b128 v[32:35], v4 offset:0
  s_waitcnt lgkmcnt(0)
  ds_read_b128 v[40:43], v5 offset:0
  v_mfma_f32_32x32x16_bf16 v[64:79], a[0:3], v[32:35], v[64:79]
  v_mfma_f32_32x32x16_bf16 v[80:95], a[4:7], v[32:35], v[80:95]
  s_waitcnt lgkmcnt(0)
  ds_read_b128 v[32:35], v6 offset:0
  v_mfma_f32_32x32x16_bf16 v[64:79], a[8:11], v[40:43], v[64:79]
  v_mfma_f32_32x32x16_bf16 v[80:95], a[12:15], v[40:43], v[80:95]
  s_waitcnt lgkmcnt(0)
  ds_read_b128 v[40:43], v7 offset:0
  v_mfma_f32_32x32x16_bf16 v[64:79], a[16:19], v[32:35], v[64:79]
  v_mfma_f32_32x32x16_bf16 v[80:95], a[20:23], v[32:35], v[80:95]
  s_waitcnt vmcnt(12) lgkmcnt(0)
  s_barrier
  ds_read_b128 v[32:35], v4 offset:8192
  v_mfma_f32_32x32x16_bf16 v[64:79], a[24:27], v[40:43], v[64:79]
  v_mfma_f32_32x32x16_bf16 v[80:95], a[28:31], v[40:43], v[80:95]
  s_waitcnt lgkmcnt(0)
  ds_read_b128 v[40:43], v5 offset:8192
  v_mfma_f32_32x32x16_bf16 v[64:79], a[32:35], v[32:35], v[64:79]
  v_mfma_f32_32x32x16_bf16 v[80:95], a[36:39], v[32:35], v[80:95]
  s_waitcnt lgkmcnt(0)
  ds_read_b128 v[32:35], v6 offset:8192
  v_mfma_f32_32x32x16_bf16 v[64:79], a[40:43], v[40:43], v[64:79]
  v_mfma_f32_32x32x16_bf16 v[80:95], a[44:47], v[40:43], v[80:95]
  s_waitcnt lgkmcnt(0)
  ds_read_b128 v[40:43], v7 offset:8192
  v_mfma_f32_32x32x16_bf16 v[64:79], a[48:51], v[32:35], v[64:79]
  v_mfma_f32_32x32x16_bf16 v[80:95], a[52:55], v[32:35], v[80:95]
  s_waitcnt vmcnt(10) lgkmcnt(0)
  s_barrier
  ds_read_b128 v[32:35], v4 offset:16384
  v_mfma_f32_32x32x16_bf16 v[64:79], a[56:59], v[40:43], v[64:79]
  v_mfma_f32_32x32x16_bf16 v[80:95], a[60:63], v[40:43], v[80:95]
  s_waitcnt lgkmcnt(0)
  ds_read_b128 v[40:43], v5 offset:16384
  v_mfma_f32_32x32x16_bf16 v[64:79], a[64:67], v[32:35], v[64:79]
  v_mfma_f32_32x32x16_bf16 v[80:95], a[68:71], v[32:35], v[80:95]
  s_waitcnt lgkmcnt(0)
  ds_read_b128 v[32:35], v6 offset:16384
  v_mfma_f32_32x32x16_bf16 v[64:79], a[72:75], v[40:43], v[64:79]
  v_mfma_f32_32x32x16_bf16 v[80:95], a[76:79], v[40:43], v[80:95]
  s_waitcnt lgkmcnt(0)
  ds_read_b128 v[40:43], v7 offset:16384
  v_mfma_f32_32x32x16_bf16 v[64:79], a[80:83], v[32:35], v[64:79]
  v_mfma_f32_32x32x16_bf16 v[80:95], a[84:87], v[32:35], v[80:95]
  s_waitcnt vmcnt(8) lgkmcnt(0)
  s_barrier
  ds_read_b128 v[32:35], v4 offset:24576
  v_mfma_f32_32x32x16_bf16 v[64:79], a[88:91], v[40:43], v[64:79]
  v_mfma_f32_32x32x16_bf16 v[80:95], a[92:95], v[40:43], v[80:95]
  s_waitcnt lgkmcnt(0)
  ds_read_b128 v[40:43], v5 offset:24576
  v_mfma_f32_32x32x16_bf16 v[64:79], a[96:99], v[32:35], v[64:79]
  v_mfma_f32_32x32x16_bf16 v[80:95], a[100:103], v[32:35], v[80:95]
  s_waitcnt lgkmcnt(0)
  ds_read_b128 v[32:35], v6 offset:24576
  v_mfma_f32_32x32x16_bf16 v[64:79], a[104:107], v[40:43], v[64:79]
  v_mfma_f32_32x32x16_bf16 v[80:95], a[108:111], v[40:43], v[80:95]
  s_waitcnt lgkmcnt(0)
  ds_read_b128 v[40:43], v7 offset:24576
  v_mfma_f32_32x32x16_bf16 v[64:79], a[112:115], v[32:35], v[64:79]
  v_mfma_f32_32x32x16_bf16 v[80:95], a[116:119], v[32:35], v[80:95]
  s_waitcnt vmcnt(6) lgkmcnt(0)
  s_barrier
  ds_read_b128 v[32:35], v4 offset:32768
  v_mfma_f32_32x32x16_bf16 v[64:79], a[120:123], v[40:43], v[64:79]
  v_mfma_f32_32x32x16_bf16 v[80:95], a[124:127], v[40:43], v[80:95]
  s_waitcnt lgkmcnt(0)
  ds_read_b128 v[40:43], v5 offset:32768
  v_mfma_f32_32x32x16_bf16 v[64:79], a[128:131], v[32:35], v[64:79]
  v_mfma_f32_32x32x16_bf16 v[80:95], a[132:135], v[32:35], v[80:95]
  s_waitcnt lgkmcnt(0)
  ds_read_b128 v[32:35], v6 offset:32768
  v_mfma_f32_32x32x16_bf16 v[64:79], a[136:139], v[40:43], v[64:79]
  v_mfma_f32_32x32x16_bf16 v[80:95], a[140:143], v[40:43], v[80:95]
  s_waitcnt lgkmcnt(0)
  ds_read_b128 v[40:43], v7 offset:32768
  v_mfma_f32_32x32x16_bf16 v[64:79], a[144:147], v[32:35], v[64:79]
  v_mfma_f32_32x32x16_bf16 v[80:95], a[148:151], v[32:35], v[80:95]
  s_waitcnt vmcnt(4) lgkmcnt(0)
  s_barrier
  ds_read_b128 v[32:35], v4 offset:40960
  v_mfma_f32_32x32x16_bf16 v[64:79], a[152:155], v[40:43], v[64:79]
  v_mfma_f32_32x32x16_bf16 v[80:95], a[156:159], v[40:43], v[80:95]
  s_waitcnt lgkmcnt(0)
  ds_read_b128 v[40:43], v5 offset:40960
  v_mfma_f32_32x32x16_bf16 v[64:79], a[160:163], v[32:35], v[64:79]
  v_mfma_f32_32x32x16_bf16 v[80:95], a[164:167], v[32:35], v[80:95]
  s_waitcnt lgkmcnt(0)
  ds_read_b128 v[32:35], v6 offset:40960
  v_mfma_f32_32x32x16_bf16 v[64:79], a[168:171], v[40:43], v[64:79]
  v_mfma_f32_32x32x16_bf16 v[80:95], a[172:175], v[40:43], v[80:95]
  s_waitcnt lgkmcnt(0)
  ds_read_b128 v[40:43], v7 offset:40960
  v_mfma_f32_32x32x16_bf16 v[64:79], a[176:179], v[32:35], v[64:79]
  v_mfma_f32_32x32x16_bf16 v[80:95], a[180:183], v[32:35], v[80:95]
  s_waitcnt vmcnt(2) lgkmcnt(0)
  s_barrier
  ds_read_b128 v[32:35], v4 offset:49152
  v_mfma_f32_32x32x16_bf16 v[64:79], a[184:187], v[40:43], v[64:79]
  v_mfma_f32_32x32x16_bf16 v[80:95], a[188:191], v[40:43], v[80:95]
  s_waitcnt lgkmcnt(0)
  ds_read_b128 v[40:43], v5 offset:49152
  v_mfma_f32_32x32x16_bf16 v[64:79], a[192:195], v[32:35], v[64:79]
  v_mfma_f32_32x32x16_bf16 v[80:95], a[196:199], v[32:35], v[80:95]
  s_waitcnt lgkmcnt(0)
  ds_read_b128 v[32:35], v6 offset:49152
  v_mfma_f32_32x32x16_bf16 v[64:79], a[200:203], v[40:43], v[64:79]
  v_mfma_f32_32x32x16_bf16 v[80:95], a[204:207], v[40:43], v[80:95]
  s_waitcnt lgkmcnt(0)
  ds_read_b128 v[40:43], v7 offset:49152
  v_mfma_f32_32x32x16_bf16 v[64:79], a[208:211], v[32:35], v[64:79]
  v_mfma_f32_32x32x16_bf16 v[80:95], a[212:215], v[32:35], v[80:95]
  s_waitcnt vmcnt(0) lgkmcnt(0)
  s_barrier
  ds_read_b128 v[32:35], v4 offset:57344
  v_mfma_f32_32x32x16_bf16 v[64:79], a[216:219], v[40:43], v[64:79]
  v_mfma_f32_32x32x16_bf16 v[80:95], a[220:223], v[40:43], v[80:95]
  s_waitcnt lgkmcnt(0)
  ds_read_b128 v[40:43], v5 offset:57344
  v_mfma_f32_32x32x16_bf16 v[64:79], a[224:227], v[32:35], v[64:79]
  v_mfma_f32_32x32x16_bf16 v[80:95], a[228:231], v[32:35], v[80:95]
  s_waitcnt lgkmcnt(0)
  ds_read_b128 v[32:35], v6 offset:57344
  v_mfma_f32_32x32x16_bf16 v[64:79], a[232:235], v[40:43], v[64:79]
  v_mfma_f32_32x32x16_bf16 v[80:95], a[236:239], v[40:43], v[80:95]
  s_waitcnt lgkmcnt(0)
  ds_read_b128 v[40:43], v7 offset:57344
  v_mfma_f32_32x32x16_bf16 v[64:79], a[240:243], v[32:35], v[64:79]
  v_mfma_f32_32x32x16_bf16 v[80:95], a[244:247], v[32:35], v[80:95]
  s_waitcnt lgkmcnt(0)
  v_mfma_f32_32x32x16_bf16 v[64:79], a[248:251], v[40:43], v[64:79]
  v_mfma_f32_32x32x16_bf16 v[80:95], a[252:255], v[40:43], v[80:95]
  s_barrier
  s_mul_i32 s45, s42, 5242880
  s_add_u32 s45, s45, 101711872
  s_lshl_b32 s46, s38, 6
  s_lshl_b32 s47, s25, 5
  s_add_u32 s46, s46, s47
  s_mul_i32 s46, s46, 2560
  s_add_u32 s45, s45, s46
  s_lshl_b32 s46, s41, 9
  s_add_u32 s45, s45, s46
  s_lshl_b32 s46, s26, 8
  s_add_u32 s45, s45, s46
  v_and_b32 v22, 31, v0
  v_lshlrev_b32 v23, 8, v22
  v_and_b32 v24, 7, v0
  v_lshrrev_b32 v25, 5, v0
  s_lshl_b32 s46, s24, 13
  s_add_u32 s46, s46, 0
  v_add_u32 v23, s46, v23
  v_add_u32 v26, 0, v25
  v_xor_b32 v26, v26, v24
  v_lshlrev_b32 v26, 4, v26
  v_add_u32 v26, v26, v23
  ds_write_b128 v26, v[64:67] offset:0
  v_add_u32 v26, 2, v25
  v_xor_b32 v26, v26, v24
  v_lshlrev_b32 v26, 4, v26
  v_add_u32 v26, v26, v23
  ds_write_b128 v26, v[68:71] offset:0
  v_add_u32 v26, 4, v25
  v_xor_b32 v26, v26, v24
  v_lshlrev_b32 v26, 4, v26
  v_add_u32 v26, v26, v23
  ds_write_b128 v26, v[72:75] offset:0
  v_add_u32 v26, 6, v25
  v_xor_b32 v26, v26, v24
  v_lshlrev_b32 v26, 4, v26
  v_add_u32 v26, v26, v23
  ds_write_b128 v26, v[76:79] offset:0
  v_add_u32 v26, 8, v25
  v_xor_b32 v26, v26, v24
  v_lshlrev_b32 v26, 4, v26
  v_add_u32 v26, v26, v23
  ds_write_b128 v26, v[80:83] offset:0
  v_add_u32 v26, 10, v25
  v_xor_b32 v26, v26, v24
  v_lshlrev_b32 v26, 4, v26
  v_add_u32 v26, v26, v23
  ds_write_b128 v26, v[84:87] offset:0
  v_add_u32 v26, 12, v25
  v_xor_b32 v26, v26, v24
  v_lshlrev_b32 v26, 4, v26
  v_add_u32 v26, v26, v23
  ds_write_b128 v26, v[88:91] offset:0
  v_add_u32 v26, 14, v25
  v_xor_b32 v26, v26, v24
  v_lshlrev_b32 v26, 4, v26
  v_add_u32 v26, v26, v23
  ds_write_b128 v26, v[92:95] offset:0
  v_lshrrev_b32 v22, 4, v0
  v_and_b32 v24, 15, v0
  v_xor_b32 v25, v24, v22
  v_xor_b32 v27, 4, v25
  v_lshlrev_b32 v25, 4, v25
  v_lshlrev_b32 v27, 4, v27
  v_lshlrev_b32 v26, 8, v22
  v_add_u32 v26, s46, v26
  v_add_u32 v25, v25, v26
  v_add_u32 v27, v27, v26
  s_mov_b32 s47, 2560
  v_mul_lo_u32 v22, v22, s47
  v_lshlrev_b32 v24, 4, v24
  v_add_u32 v22, v22, v24
  s_waitcnt lgkmcnt(0)
  ds_read_b128 v[64:67], v25 offset:0
  ds_read_b128 v[68:71], v27 offset:1024
  ds_read_b128 v[72:75], v25 offset:2048
  ds_read_b128 v[76:79], v27 offset:3072
  ds_read_b128 v[80:83], v25 offset:4096
  ds_read_b128 v[84:87], v27 offset:5120
  ds_read_b128 v[88:91], v25 offset:6144
  ds_read_b128 v[92:95], v27 offset:7168
  s_waitcnt lgkmcnt(7)
  s_add_u32 s47, s45, 0
  buffer_store_dwordx4 v[64:67], v22, s[4:7], s47 offen sc1
  s_waitcnt lgkmcnt(6)
  s_add_u32 s47, s45, 10240
  buffer_store_dwordx4 v[68:71], v22, s[4:7], s47 offen sc1
  s_waitcnt lgkmcnt(5)
  s_add_u32 s47, s45, 20480
  buffer_store_dwordx4 v[72:75], v22, s[4:7], s47 offen sc1
  s_waitcnt lgkmcnt(4)
  s_add_u32 s47, s45, 30720
  buffer_store_dwordx4 v[76:79], v22, s[4:7], s47 offen sc1
  s_waitcnt lgkmcnt(3)
  s_add_u32 s47, s45, 40960
  buffer_store_dwordx4 v[80:83], v22, s[4:7], s47 offen sc1
  s_waitcnt lgkmcnt(2)
  s_add_u32 s47, s45, 51200
  buffer_store_dwordx4 v[84:87], v22, s[4:7], s47 offen sc1
  s_waitcnt lgkmcnt(1)
  s_add_u32 s47, s45, 61440
  buffer_store_dwordx4 v[88:91], v22, s[4:7], s47 offen sc1
  s_waitcnt lgkmcnt(0)
  s_add_u32 s47, s45, 71680
  buffer_store_dwordx4 v[92:95], v22, s[4:7], s47 offen sc1
  s_lshl_b32 s49, s38, 7
  s_add_u32 s49, s49, 85078016
  s_waitcnt vmcnt(0)
  s_barrier
  v_cmp_eq_u32 vcc, 0, v254
  s_nop 0
  s_and_saveexec_b64 s[56:57], vcc
  s_cbranch_execz sig_4400097
  v_mov_b32 v250, 1
  v_mov_b32 v251, 0
  buffer_atomic_add v250, v251, s[4:7], s49 offen
sig_4400097:
  s_mov_b64 exec, s[56:57]
  s_barrier
  s_add_u32 s38, s38, 1
  s_cmp_lt_u32 s38, 32
  s_cbranch_scc1 rlp_4400092
  s_branch post_done
rk_4400091:
  s_sub_u32 s39, s39, 40
  s_cmp_ge_u32 s39, 16
  s_nop 0
  s_cbranch_scc1 rk_4400098
  s_mov_b32 s38, 0
  s_mov_b32 s62, s39
rlp_4400099:
  s_mov_b32 s39, s62
  s_lshl_b32 s49, s38, 7
  s_add_u32 s49, s49, 85078016
  v_readfirstlane_b32 s56, v254
  s_nop 0
  s_cmp_ge_u32 s56, 64
  s_cbranch_scc1 wok_4400101
  v_mov_b32 v251, 0
wc_4400100:
  buffer_load_dword v250, v251, s[4:7], s49 offen sc1
  s_waitcnt vmcnt(0)
  v_readfirstlane_b32 s56, v250
  s_nop 0
  s_cmp_ge_u32 s56, 40
  s_cbranch_scc1 wok_4400101
  s_add_u32 s63, s63, 1
  s_cmp_gt_u32 s63, 4194304
  s_cbranch_scc1 fz_fail
  s_cmp_ge_u32 s38, 31
  s_cbranch_scc1 nap_4400102
  s_sleep 24
  s_branch nape_4400103
nap_4400102:
  s_sleep 12
nape_4400103:
  s_branch wc_4400100
wok_4400101:
  s_barrier
  s_load_dwordx2 s[8:9], s[0:1], 0
  s_mov_b32 s10, 2621440
  s_mov_b32 s11, 0x00020000
  v_mov_b32 v0, v254
  v_lshrrev_b32 v1, 6, v0
  v_and_b32 v0, 63, v0
  s_lshl_b32 s41, s38, 6
  s_lshl_b32 s42, s39, 2
  s_add_u32 s41, s41, s42
  v_add_u32 v1, s41, v1
  v_mul_u32_u24 v1, 1280, v1
  v_lshlrev_b32 v5, 2, v0
  v_add_u32 v1, v1, v5
  v_lshlrev_b32 v6, 1, v1
  s_waitcnt lgkmcnt(0)
  buffer_load_dword v8, v1, s[8:11], 0 offen offset:0
  buffer_load_dword v9, v1, s[8:11], 0 offen offset:256
  buffer_load_dword v10, v1, s[8:11], 0 offen offset:512
  buffer_load_dword v11, v1, s[8:11], 0 offen offset:768
  buffer_load_dword v12, v1, s[8:11], 0 offen offset:1024
  s_mov_b32 s41, 101711872
  buffer_load_dwordx2 v[48:49], v6, s[4:7], s41 offen offset:0
  buffer_load_dwordx2 v[50:51], v6, s[4:7], s41 offen offset:512
  buffer_load_dwordx2 v[52:53], v6, s[4:7], s41 offen offset:1024
  buffer_load_dwordx2 v[54:55], v6, s[4:7], s41 offen offset:1536
  buffer_load_dwordx2 v[56:57], v6, s[4:7], s41 offen offset:2048
  s_mov_b32 s41, 106954752
  buffer_load_dwordx2 v[58:59], v6, s[4:7], s41 offen offset:0
  buffer_load_dwordx2 v[60:61], v6, s[4:7], s41 offen offset:512
  buffer_load_dwordx2 v[62:63], v6, s[4:7], s41 offen offset:1024
  buffer_load_dwordx2 v[64:65], v6, s[4:7], s41 offen offset:1536
  buffer_load_dwordx2 v[66:67], v6, s[4:7], s41 offen offset:2048
  s_mov_b32 s41, 112197632
  buffer_load_dwordx2 v[68:69], v6, s[4:7], s41 offen offset:0
  buffer_load_dwordx2 v[70:71], v6, s[4:7], s41 offen offset:512
  buffer_load_dwordx2 v[72:73], v6, s[4:7], s41 offen offset:1024
  buffer_load_dwordx2 v[74:75], v6, s[4:7], s41 offen offset:1536
  buffer_load_dwordx2 v[76:77], v6, s[4:7], s41 offen offset:2048
  s_mov_b32 s41, 117440512
  buffer_load_dwordx2 v[78:79], v6, s[4:7], s41 offen offset:0
  buffer_load_dwordx2 v[80:81], v6, s[4:7], s41 offen offset:512
  buffer_load_dwordx2 v[82:83], v6, s[4:7], s41 offen offset:1024
  buffer_load_dwordx2 v[84:85], v6, s[4:7], s41 offen offset:1536
  buffer_load_dwordx2 v[86:87], v6, s[4:7], s41 offen offset:2048
  s_mov_b32 s41, 122683392
  buffer_load_dwordx2 v[88:89], v6, s[4:7], s41 offen offset:0
  buffer_load_dwordx2 v[90:91], v6, s[4:7], s41 offen offset:512
  buffer_load_dwordx2 v[92:93], v6, s[4:7], s41 offen offset:1024
  buffer_load_dwordx2 v[94:95], v6, s[4:7], s41 offen offset:1536
  buffer_load_dwordx2 v[96:97], v6, s[4:7], s41 offen offset:2048
  s_mov_b32 s41, 127926272
  buffer_load_dwordx2 v[98:99], v6, s[4:7], s41 offen offset:0
  buffer_load_dwordx2 v[100:101], v6, s[4:7], s41 offen offset:512
  buffer_load_dwordx2 v[102:103], v6, s[4:7], s41 offen offset:1024
  buffer_load_dwordx2 v[104:105], v6, s[4:7], s41 offen offset:1536
  buffer_load_dwordx2 v[106:107], v6, s[4:7], s41 offen offset:2048
  s_mov_b32 s41, 133169152
  buffer_load_dwordx2 v[108:109], v6, s[4:7], s41 offen offset:0
  buffer_load_dwordx2 v[110:111], v6, s[4:7], s41 offen offset:512
  buffer_load_dwordx2 v[112:113], v6, s[4:7], s41 offen offset:1024
  buffer_load_dwordx2 v[114:115], v6, s[4:7], s41 offen offset:1536
  buffer_load_dwordx2 v[116:117], v6, s[4:7], s41 offen offset:2048
  s_mov_b32 s41, 138412032
  buffer_load_dwordx2 v[118:119], v6, s[4:7], s41 offen offset:0
  buffer_load_dwordx2 v[120:121], v6, s[4:7], s41 offen offset:512
  buffer_load_dwordx2 v[122:123], v6, s[4:7], s41 offen offset:1024
  buffer_load_dwordx2 v[124:125], v6, s[4:7], s41 offen offset:1536
  buffer_load_dwordx2 v[126:127], v6, s[4:7], s41 offen offset:2048
  s_waitcnt vmcnt(40)
  v_lshlrev_b32 v32, 16, v8
  v_and_b32 v33, 0xffff0000, v8
  v_lshlrev_b32 v34, 16, v9
  v_and_b32 v35, 0xffff0000, v9
  v_lshlrev_b32 v36, 16, v10
  v_and_b32 v37, 0xffff0000, v10
  v_lshlrev_b32 v38, 16, v11
  v_and_b32 v39, 0xffff0000, v11
  v_lshlrev_b32 v40, 16, v12
  v_and_b32 v41, 0xffff0000, v12
  s_waitcnt vmcnt(35)
  v_add_f32 v32, v32, v48
  v_add_f32 v33, v33, v49
  v_add_f32 v34, v34, v50
  v_add_f32 v35, v35, v51
  v_add_f32 v36, v36, v52
  v_add_f32 v37, v37, v53
  v_add_f32 v38, v38, v54
  v_add_f32 v39, v39, v55
  v_add_f32 v40, v40, v56
  v_add_f32 v41, v41, v57
  s_waitcnt vmcnt(30)
  v_add_f32 v32, v32, v58
  v_add_f32 v33, v33, v59
  v_add_f32 v34, v34, v60
  v_add_f32 v35, v35, v61
  v_add_f32 v36, v36, v62
  v_add_f32 v37, v37, v63
  v_add_f32 v38, v38, v64
  v_add_f32 v39, v39, v65
  v_add_f32 v40, v40, v66
  v_add_f32 v41, v41, v67
  s_waitcnt vmcnt(25)
  v_add_f32 v32, v32, v68
  v_add_f32 v33, v33, v69
  v_add_f32 v34, v34, v70
  v_add_f32 v35, v35, v71
  v_add_f32 v36, v36, v72
  v_add_f32 v37, v37, v73
  v_add_f32 v38, v38, v74
  v_add_f32 v39, v39, v75
  v_add_f32 v40, v40, v76
  v_add_f32 v41, v41, v77
  s_waitcnt vmcnt(20)
  v_add_f32 v32, v32, v78
  v_add_f32 v33, v33, v79
  v_add_f32 v34, v34, v80
  v_add_f32 v35, v35, v81
  v_add_f32 v36, v36, v82
  v_add_f32 v37, v37, v83
  v_add_f32 v38, v38, v84
  v_add_f32 v39, v39, v85
  v_add_f32 v40, v40, v86
  v_add_f32 v41, v41, v87
  s_waitcnt vmcnt(15)
  v_add_f32 v32, v32, v88
  v_add_f32 v33, v33, v89
  v_add_f32 v34, v34, v90
  v_add_f32 v35, v35, v91
  v_add_f32 v36, v36, v92
  v_add_f32 v37, v37, v93
  v_add_f32 v38, v38, v94
  v_add_f32 v39, v39, v95
  v_add_f32 v40, v40, v96
  v_add_f32 v41, v41, v97
  s_waitcnt vmcnt(10)
  v_add_f32 v32, v32, v98
  v_add_f32 v33, v33, v99
  v_add_f32 v34, v34, v100
  v_add_f32 v35, v35, v101
  v_add_f32 v36, v36, v102
  v_add_f32 v37, v37, v103
  v_add_f32 v38, v38, v104
  v_add_f32 v39, v39, v105
  v_add_f32 v40, v40, v106
  v_add_f32 v41, v41, v107
  s_waitcnt vmcnt(5)
  v_add_f32 v32, v32, v108
  v_add_f32 v33, v33, v109
  v_add_f32 v34, v34, v110
  v_add_f32 v35, v35, v111
  v_add_f32 v36, v36, v112
  v_add_f32 v37, v37, v113
  v_add_f32 v38, v38, v114
  v_add_f32 v39, v39, v115
  v_add_f32 v40, v40, v116
  v_add_f32 v41, v41, v117
  s_waitcnt vmcnt(0)
  v_add_f32 v32, v32, v118
  v_add_f32 v33, v33, v119
  v_add_f32 v34, v34, v120
  v_add_f32 v35, v35, v121
  v_add_f32 v36, v36, v122
  v_add_f32 v37, v37, v123
  v_add_f32 v38, v38, v124
  v_add_f32 v39, v39, v125
  v_add_f32 v40, v40, v126
  v_add_f32 v41, v41, v127
  s_mov_b32 s41, 85983232
  buffer_store_dwordx2 v[32:33], v6, s[4:7], s41 offen offset:0 sc1
  buffer_store_dwordx2 v[34:35], v6, s[4:7], s41 offen offset:512 sc1
  buffer_store_dwordx2 v[36:37], v6, s[4:7], s41 offen offset:1024 sc1
  buffer_store_dwordx2 v[38:39], v6, s[4:7], s41 offen offset:1536 sc1
  buffer_store_dwordx2 v[40:41], v6, s[4:7], s41 offen offset:2048 sc1
  v_mov_b32 v48, v32
  v_mov_b32 v49, v33
  v_mov_b32 v50, v34
  v_mov_b32 v51, v35
  v_mov_b32 v52, v36
  v_mov_b32 v53, v37
  v_mov_b32 v54, v38
  v_mov_b32 v55, v39
  v_mov_b32 v56, v40
  v_mov_b32 v57, v41
  v_add_f32 v2, v48, v49
  v_add_f32 v2, v2, v50
  v_add_f32 v2, v2, v51
  v_add_f32 v2, v2, v52
  v_add_f32 v2, v2, v53
  v_add_f32 v2, v2, v54
  v_add_f32 v2, v2, v55
  v_add_f32 v2, v2, v56
  v_add_f32 v2, v2, v57
  s_nop 1
  v_add_f32_dpp v2, v2, v2 row_ror:8 row_mask:0xf bank_mask:0xf
  s_nop 1
  v_add_f32_dpp v2, v2, v2 row_ror:4 row_mask:0xf bank_mask:0xf
  s_nop 1
  v_add_f32_dpp v2, v2, v2 row_ror:2 row_mask:0xf bank_mask:0xf
  s_nop 1
  v_add_f32_dpp v2, v2, v2 row_ror:1 row_mask:0xf bank_mask:0xf
  v_mov_b32 v3, v2
  s_nop 1
  v_permlane16_swap_b32 v2, v3
  v_add_f32 v2, v2, v3
  v_mov_b32 v3, v2
  s_nop 1
  v_permlane32_swap_b32 v2, v3
  v_add_f32 v2, v2, v3
  v_mul_f32 v2, 0x3acccccd, v2
  v_sub_f32 v48, v48, v2
  v_sub_f32 v49, v49, v2
  v_sub_f32 v50, v50, v2
  v_sub_f32 v51, v51, v2
  v_sub_f32 v52, v52, v2
  v_sub_f32 v53, v53, v2
  v_sub_f32 v54, v54, v2
  v_sub_f32 v55, v55, v2
  v_sub_f32 v56, v56, v2
  v_sub_f32 v57, v57, v2
  v_mul_f32 v3, v48, v48
  v_fmac_f32 v3, v49, v49
  v_fmac_f32 v3, v50, v50
  v_fmac_f32 v3, v51, v51
  v_fmac_f32 v3, v52, v52
  v_fmac_f32 v3, v53, v53
  v_fmac_f32 v3, v54, v54
  v_fmac_f32 v3, v55, v55
  v_fmac_f32 v3, v56, v56
  v_fmac_f32 v3, v57, v57
  s_nop 1
  v_add_f32_dpp v3, v3, v3 row_ror:8 row_mask:0xf bank_mask:0xf
  s_nop 1
  v_add_f32_dpp v3, v3, v3 row_ror:4 row_mask:0xf bank_mask:0xf
  s_nop 1
  v_add_f32_dpp v3, v3, v3 row_ror:2 row_mask:0xf bank_mask:0xf
  s_nop 1
  v_add_f32_dpp v3, v3, v3 row_ror:1 row_mask:0xf bank_mask:0xf
  v_mov_b32 v4, v3
  s_nop 1
  v_permlane16_swap_b32 v3, v4
  v_add_f32 v3, v3, v4
  v_mov_b32 v4, v3
  s_nop 1
  v_permlane32_swap_b32 v3, v4
  v_add_f32 v3, v3, v4
  v_mov_b32 v4, 0x3727c5ac
  v_mul_f32 v3, 0x3acccccd, v3
  v_add_f32 v3, v3, v4
  v_rsq_f32 v3, v3
  s_nop 0
  v_mul_f32 v48, v48, v3
  v_mul_f32 v49, v49, v3
  v_mul_f32 v50, v50, v3
  v_mul_f32 v51, v51, v3
  v_mul_f32 v52, v52, v3
  v_mul_f32 v53, v53, v3
  v_mul_f32 v54, v54, v3
  v_mul_f32 v55, v55, v3
  v_mul_f32 v56, v56, v3
  v_mul_f32 v57, v57, v3
  v_cvt_pk_bf16_f32 v8, v48, v49
  v_cvt_pk_bf16_f32 v9, v50, v51
  v_cvt_pk_bf16_f32 v10, v52, v53
  v_cvt_pk_bf16_f32 v11, v54, v55
  v_cvt_pk_bf16_f32 v12, v56, v57
  s_mov_b32 s41, 91226112
  buffer_store_dword v8, v1, s[4:7], s41 offen offset:0 sc1
  buffer_store_dword v9, v1, s[4:7], s41 offen offset:256 sc1
  buffer_store_dword v10, v1, s[4:7], s41 offen offset:512 sc1
  buffer_store_dword v11, v1, s[4:7], s41 offen offset:768 sc1
  buffer_store_dword v12, v1, s[4:7], s41 offen offset:1024 sc1
  s_lshl_b32 s49, s38, 7
  s_add_u32 s49, s49, 85082112
  s_waitcnt vmcnt(0)
  s_barrier
  v_cmp_eq_u32 vcc, 0, v254
  s_nop 0
  s_and_saveexec_b64 s[56:57], vcc
  s_cbranch_execz sig_4400104
  v_mov_b32 v250, 1
  v_mov_b32 v251, 0
  buffer_atomic_add v250, v251, s[4:7], s49 offen
sig_4400104:
  s_mov_b64 exec, s[56:57]
  s_barrier
  s_add_u32 s38, s38, 1
  s_cmp_lt_u32 s38, 32
  s_cbranch_scc1 rlp_4400099
  s_branch post_done
rk_4400098:
  s_sub_u32 s39, s39, 16
  s_cmp_ge_u32 s39, 54
  s_cbranch_scc1 rk_4400105
  s_mov_b32 s38, 0
  s_cmp_ge_u32 s39, 27
  s_cselect_b32 s56, 27, 0
  s_cselect_b32 s57, 1, 0
  s_sub_u32 s39, s39, s56
  s_add_u32 s38, s38, s57
  s_mov_b32 s62, s39
  s_load_dwordx2 s[8:9], s[0:1], 64
  s_mov_b32 s10, 2211840
  s_mov_b32 s11, 0x00020000
  s_load_dwordx2 s[12:13], s[0:1], 72
  s_mov_b32 s14, 2211840
  s_mov_b32 s15, 0x00020000
  v_mov_b32 v0, v254
  v_lshrrev_b32 v22, 6, v0
  s_nop 0
  v_readfirstlane_b32 s24, v22
  v_and_b32 v0, 63, v0
  s_lshr_b32 s25, s24, 1
  s_and_b32 s26, s24, 1
  v_lshrrev_b32 v22, 3, v0
  s_mov_b32 s30, 1280
  v_mul_lo_u32 v22, v22, s30
  v_and_b32 v23, 7, v0
  v_lshrrev_b32 v24, 4, v0
  v_xor_b32 v23, v23, v24
  v_lshlrev_b32 v24, 4, v23
  v_add_u32 v1, v22, v24
  v_xor_b32 v23, 4, v23
  v_lshlrev_b32 v24, 4, v23
  v_add_u32 v2, v22, v24
  v_lshrrev_b32 v22, 3, v0
  s_mov_b32 s30, 3456
  v_mul_lo_u32 v23, v22, s30
  v_bfe_u32 v24, v0, 2, 1
  v_bfe_u32 v25, v0, 4, 1
  v_xor_b32 v24, v24, v25
  v_lshlrev_b32 v24, 6, v24
  v_add_u32 v23, v23, v24
  v_and_b32 v24, 3, v0
  v_lshlrev_b32 v24, 4, v24
  v_add_u32 v3, v23, v24
  v_and_b32 v22, 31, v0
  s_lshl_b32 s30, s25, 5
  v_add_u32 v23, s30, v22
  v_lshlrev_b32 v23, 7, v23
  v_bfe_u32 v24, v0, 1, 3
  v_lshrrev_b32 v25, 5, v0
  v_add_u32 v26, 0, v25
  v_xor_b32 v26, v26, v24
  v_lshlrev_b32 v26, 4, v26
  v_add_u32 v4, v23, v26
  v_add_u32 v8, 65536, v4
  v_add_u32 v26, 2, v25
  v_xor_b32 v26, v26, v24
  v_lshlrev_b32 v26, 4, v26
  v_add_u32 v5, v23, v26
  v_add_u32 v9, 65536, v5
  v_add_u32 v26, 4, v25
  v_xor_b32 v26, v26, v24
  v_lshlrev_b32 v26, 4, v26
  v_add_u32 v6, v23, v26
  v_add_u32 v10, 65536, v6
  v_add_u32 v26, 6, v25
  v_xor_b32 v26, v26, v24
  v_lshlrev_b32 v26, 4, v26
  v_add_u32 v7, v23, v26
  v_add_u32 v11, 65536, v7
  v_lshrrev_b32 v22, 5, v0
  v_lshlrev_b32 v22, 3, v22
  v_bfe_u32 v23, v0, 2, 2
  v_add_u32 v22, v22, v23
  v_lshlrev_b32 v22, 7, v22
  v_bfe_u32 v24, v0, 4, 1
  v_lshlrev_b32 v24, 5, v24
  v_add_u32 v22, v22, v24
  v_and_b32 v24, 3, v0
  v_lshlrev_b32 v24, 3, v24
  v_add_u32 v22, v22, v24
  v_bfe_u32 v23, v0, 3, 1
  v_xor_b32 v23, s26, v23
  v_lshlrev_b32 v23, 6, v23
  v_add_u32 v22, v22, v23
  v_add_u32 v16, 131072, v22
  v_add_u32 v17, 139264, v22
  s_lshl_b32 s35, s24, 11
  s_lshl_b32 s36, s24, 11
  s_add_u32 s36, s36, 131072
  s_lshl_b32 s28, s39, 7
  s_mul_i32 s31, s24, 55296
  s_add_u32 s28, s28, s31
  s_waitcnt lgkmcnt(0)
  s_barrier
  s_add_u32 s30, s28, 0
  s_sub_u32 m0, s36, 131072
  s_nop 0
  buffer_load_dwordx4 v3, s[8:11], s30 offen lds
  s_add_u32 s30, s28, 27648
  s_sub_u32 m0, s36, 130048
  s_nop 0
  buffer_load_dwordx4 v3, s[8:11], s30 offen lds
  s_add_u32 s30, s28, 0
  s_sub_u32 m0, s36, 122880
  s_nop 0
  buffer_load_dwordx4 v3, s[12:15], s30 offen lds
  s_add_u32 s30, s28, 27648
  s_sub_u32 m0, s36, 121856
  s_nop 0
  buffer_load_dwordx4 v3, s[12:15], s30 offen lds
  s_add_u32 s30, s28, 221184
  s_sub_u32 m0, s36, 114688
  s_nop 0
  buffer_load_dwordx4 v3, s[8:11], s30 offen lds
  s_add_u32 s30, s28, 248832
  s_sub_u32 m0, s36, 113664
  s_nop 0
  buffer_load_dwordx4 v3, s[8:11], s30 offen lds
  s_add_u32 s30, s28, 221184
  s_sub_u32 m0, s36, 106496
  s_nop 0
  buffer_load_dwordx4 v3, s[12:15], s30 offen lds
  s_add_u32 s30, s28, 248832
  s_sub_u32 m0, s36, 105472
  s_nop 0
  buffer_load_dwordx4 v3, s[12:15], s30 offen lds
  s_add_u32 s30, s28, 442368
  s_sub_u32 m0, s36, 98304
  s_nop 0
  buffer_load_dwordx4 v3, s[8:11], s30 offen lds
  s_add_u32 s30, s28, 470016
  s_sub_u32 m0, s36, 97280
  s_nop 0
  buffer_load_dwordx4 v3, s[8:11], s30 offen lds
  s_add_u32 s30, s28, 442368
  s_sub_u32 m0, s36, 90112
  s_nop 0
  buffer_load_dwordx4 v3, s[12:15], s30 offen lds
  s_add_u32 s30, s28, 470016
  s_sub_u32 m0, s36, 89088
  s_nop 0
  buffer_load_dwordx4 v3, s[12:15], s30 offen lds
  s_add_u32 s30, s28, 663552
  s_sub_u32 m0, s36, 81920
  s_nop 0
  buffer_load_dwordx4 v3, s[8:11], s30 offen lds
  s_add_u32 s30, s28, 691200
  s_sub_u32 m0, s36, 80896
  s_nop 0
  buffer_load_dwordx4 v3, s[8:11], s30 offen lds
  s_add_u32 s30, s28, 663552
  s_sub_u32 m0, s36, 73728
  s_nop 0
  buffer_load_dwordx4 v3, s[12:15], s30 offen lds
  s_add_u32 s30, s28, 691200
  s_sub_u32 m0, s36, 72704
  s_nop 0
  buffer_load_dwordx4 v3, s[12:15], s30 offen lds
  s_add_u32 s30, s28, 884736
  s_sub_u32 m0, s36, 65536
  s_nop 0
  buffer_load_dwordx4 v3, s[8:11], s30 offen lds
  s_add_u32 s30, s28, 912384
  s_sub_u32 m0, s36, 64512
  s_nop 0
  buffer_load_dwordx4 v3, s[8:11], s30 offen lds
  s_add_u32 s30, s28, 884736
  s_sub_u32 m0, s36, 57344
  s_nop 0
  buffer_load_dwordx4 v3, s[12:15], s30 offen lds
  s_add_u32 s30, s28, 912384
  s_sub_u32 m0, s36, 56320
  s_nop 0
  buffer_load_dwordx4 v3, s[12:15], s30 offen lds
  s_add_u32 s30, s28, 1105920
  s_sub_u32 m0, s36, 49152
  s_nop 0
  buffer_load_dwordx4 v3, s[8:11], s30 offen lds
  s_add_u32 s30, s28, 1133568
  s_sub_u32 m0, s36, 48128
  s_nop 0
  buffer_load_dwordx4 v3, s[8:11], s30 offen lds
  s_add_u32 s30, s28, 1105920
  s_sub_u32 m0, s36, 40960
  s_nop 0
  buffer_load_dwordx4 v3, s[12:15], s30 offen lds
  s_add_u32 s30, s28, 1133568
  s_sub_u32 m0, s36, 39936
  s_nop 0
  buffer_load_dwordx4 v3, s[12:15], s30 offen lds
  s_add_u32 s30, s28, 1327104
  s_sub_u32 m0, s36, 32768
  s_nop 0
  buffer_load_dwordx4 v3, s[8:11], s30 offen lds
  s_add_u32 s30, s28, 1354752
  s_sub_u32 m0, s36, 31744
  s_nop 0
  buffer_load_dwordx4 v3, s[8:11], s30 offen lds
  s_add_u32 s30, s28, 1327104
  s_sub_u32 m0, s36, 24576
  s_nop 0
  buffer_load_dwordx4 v3, s[12:15], s30 offen lds
  s_add_u32 s30, s28, 1354752
  s_sub_u32 m0, s36, 23552
  s_nop 0
  buffer_load_dwordx4 v3, s[12:15], s30 offen lds
  s_add_u32 s30, s28, 1548288
  s_sub_u32 m0, s36, 16384
  s_nop 0
  buffer_load_dwordx4 v3, s[8:11], s30 offen lds
  s_add_u32 s30, s28, 1575936
  s_sub_u32 m0, s36, 15360
  s_nop 0
  buffer_load_dwordx4 v3, s[8:11], s30 offen lds
  s_add_u32 s30, s28, 1548288
  s_sub_u32 m0, s36, 8192
  s_nop 0
  buffer_load_dwordx4 v3, s[12:15], s30 offen lds
  s_add_u32 s30, s28, 1575936
  s_sub_u32 m0, s36, 7168
  s_nop 0
  buffer_load_dwordx4 v3, s[12:15], s30 offen lds
  s_add_u32 s30, s28, 1769472
  s_add_u32 m0, s36, 0
  s_nop 0
  buffer_load_dwordx4 v3, s[8:11], s30 offen lds
  s_add_u32 s30, s28, 1797120
  s_add_u32 m0, s36, 1024
  s_nop 0
  buffer_load_dwordx4 v3, s[8:11], s30 offen lds
  s_add_u32 s30, s28, 1769472
  s_add_u32 m0, s36, 8192
  s_nop 0
  buffer_load_dwordx4 v3, s[12:15], s30 offen lds
  s_add_u32 s30, s28, 1797120
  s_add_u32 m0, s36, 9216
  s_nop 0
  buffer_load_dwordx4 v3, s[12:15], s30 offen lds
  s_add_u32 s30, s28, 1990656
  s_add_u32 m0, s36, 16384
  s_nop 0
  buffer_load_dwordx4 v3, s[8:11], s30 offen lds
  s_add_u32 s30, s28, 2018304
  s_add_u32 m0, s36, 17408
  s_nop 0
  buffer_load_dwordx4 v3, s[8:11], s30 offen lds
  s_add_u32 s30, s28, 1990656
  s_add_u32 m0, s36, 24576
  s_nop 0
  buffer_load_dwordx4 v3, s[12:15], s30 offen lds
  s_add_u32 s30, s28, 2018304
  s_add_u32 m0, s36, 25600
  s_nop 0
  buffer_load_dwordx4 v3, s[12:15], s30 offen lds
  s_waitcnt vmcnt(36)
  s_barrier
  v_subrev_u32 v22, 131072, v16
  v_subrev_u32 v23, 131072, v17
  ds_read_b64_tr_b16 a[0:1], v22 offset:0
  ds_read_b64_tr_b16 a[2:3], v22 offset:512
  ds_read_b64_tr_b16 a[4:5], v23 offset:0
  ds_read_b64_tr_b16 a[6:7], v23 offset:512
  ds_read_b64_tr_b16 a[8:9], v22 offset:2048
  ds_read_b64_tr_b16 a[10:11], v22 offset:2560
  ds_read_b64_tr_b16 a[12:13], v23 offset:2048
  ds_read_b64_tr_b16 a[14:15], v23 offset:2560
  ds_read_b64_tr_b16 a[16:17], v22 offset:4096
  ds_read_b64_tr_b16 a[18:19], v22 offset:4608
  ds_read_b64_tr_b16 a[20:21], v23 offset:4096
  ds_read_b64_tr_b16 a[22:23], v23 offset:4608
  ds_read_b64_tr_b16 a[24:25], v22 offset:6144
  ds_read_b64_tr_b16 a[26:27], v22 offset:6656
  ds_read_b64_tr_b16 a[28:29], v23 offset:6144
  ds_read_b64_tr_b16 a[30:31], v23 offset:6656
  s_waitcnt vmcnt(32)
  s_barrier
  v_subrev_u32 v22, 114688, v16
  v_subrev_u32 v23, 114688, v17
  ds_read_b64_tr_b16 a[32:33], v22 offset:0
  ds_read_b64_tr_b16 a[34:35], v22 offset:512
  ds_read_b64_tr_b16 a[36:37], v23 offset:0
  ds_read_b64_tr_b16 a[38:39], v23 offset:512
  ds_read_b64_tr_b16 a[40:41], v22 offset:2048
  ds_read_b64_tr_b16 a[42:43], v22 offset:2560
  ds_read_b64_tr_b16 a[44:45], v23 offset:2048
  ds_read_b64_tr_b16 a[46:47], v23 offset:2560
  ds_read_b64_tr_b16 a[48:49], v22 offset:4096
  ds_read_b64_tr_b16 a[50:51], v22 offset:4608
  ds_read_b64_tr_b16 a[52:53], v23 offset:4096
  ds_read_b64_tr_b16 a[54:55], v23 offset:4608
  ds_read_b64_tr_b16 a[56:57], v22 offset:6144
  ds_read_b64_tr_b16 a[58:59], v22 offset:6656
  ds_read_b64_tr_b16 a[60:61], v23 offset:6144
  ds_read_b64_tr_b16 a[62:63], v23 offset:6656
  s_waitcnt vmcnt(28)
  s_barrier
  v_subrev_u32 v22, 98304, v16
  v_subrev_u32 v23, 98304, v17
  ds_read_b64_tr_b16 a[64:65], v22 offset:0
  ds_read_b64_tr_b16 a[66:67], v22 offset:512
  ds_read_b64_tr_b16 a[68:69], v23 offset:0
  ds_read_b64_tr_b16 a[70:71], v23 offset:512
  ds_read_b64_tr_b16 a[72:73], v22 offset:2048
  ds_read_b64_tr_b16 a[74:75], v22 offset:2560
  ds_read_b64_tr_b16 a[76:77], v23 offset:2048
  ds_read_b64_tr_b16 a[78:79], v23 offset:2560
  ds_read_b64_tr_b16 a[80:81], v22 offset:4096
  ds_read_b64_tr_b16 a[82:83], v22 offset:4608
  ds_read_b64_tr_b16 a[84:85], v23 offset:4096
  ds_read_b64_tr_b16 a[86:87], v23 offset:4608
  ds_read_b64_tr_b16 a[88:89], v22 offset:6144
  ds_read_b64_tr_b16 a[90:91], v22 offset:6656
  ds_read_b64_tr_b16 a[92:93], v23 offset:6144
  ds_read_b64_tr_b16 a[94:95], v23 offset:6656
  s_waitcnt vmcnt(24)
  s_barrier
  v_subrev_u32 v22, 81920, v16
  v_subrev_u32 v23, 81920, v17
  ds_read_b64_tr_b16 a[96:97], v22 offset:0
  ds_read_b64_tr_b16 a[98:99], v22 offset:512
  ds_read_b64_tr_b16 a[100:101], v23 offset:0
  ds_read_b64_tr_b16 a[102:103], v23 offset:512
  ds_read_b64_tr_b16 a[104:105], v22 offset:2048
  ds_read_b64_tr_b16 a[106:107], v22 offset:2560
  ds_read_b64_tr_b16 a[108:109], v23 offset:2048
  ds_read_b64_tr_b16 a[110:111], v23 offset:2560
  ds_read_b64_tr_b16 a[112:113], v22 offset:4096
  ds_read_b64_tr_b16 a[114:115], v22 offset:4608
  ds_read_b64_tr_b16 a[116:117], v23 offset:4096
  ds_read_b64_tr_b16 a[118:119], v23 offset:4608
  ds_read_b64_tr_b16 a[120:121], v22 offset:6144
  ds_read_b64_tr_b16 a[122:123], v22 offset:6656
  ds_read_b64_tr_b16 a[124:125], v23 offset:6144
  ds_read_b64_tr_b16 a[126:127], v23 offset:6656
  s_waitcnt vmcnt(20)
  s_barrier
  v_subrev_u32 v22, 65536, v16
  v_subrev_u32 v23, 65536, v17
  ds_read_b64_tr_b16 a[128:129], v22 offset:0
  ds_read_b64_tr_b16 a[130:131], v22 offset:512
  ds_read_b64_tr_b16 a[132:133], v23 offset:0
  ds_read_b64_tr_b16 a[134:135], v23 offset:512
  ds_read_b64_tr_b16 a[136:137], v22 offset:2048
  ds_read_b64_tr_b16 a[138:139], v22 offset:2560
  ds_read_b64_tr_b16 a[140:141], v23 offset:2048
  ds_read_b64_tr_b16 a[142:143], v23 offset:2560
  ds_read_b64_tr_b16 a[144:145], v22 offset:4096
  ds_read_b64_tr_b16 a[146:147], v22 offset:4608
  ds_read_b64_tr_b16 a[148:149], v23 offset:4096
  ds_read_b64_tr_b16 a[150:151], v23 offset:4608
  ds_read_b64_tr_b16 a[152:153], v22 offset:6144
  ds_read_b64_tr_b16 a[154:155], v22 offset:6656
  ds_read_b64_tr_b16 a[156:157], v23 offset:6144
  ds_read_b64_tr_b16 a[158:159], v23 offset:6656
  s_waitcnt vmcnt(16)
  s_barrier
  v_subrev_u32 v22, 49152, v16
  v_subrev_u32 v23, 49152, v17
  ds_read_b64_tr_b16 a[160:161], v22 offset:0
  ds_read_b64_tr_b16 a[162:163], v22 offset:512
  ds_read_b64_tr_b16 a[164:165], v23 offset:0
  ds_read_b64_tr_b16 a[166:167], v23 offset:512
  ds_read_b64_tr_b16 a[168:169], v22 offset:2048
  ds_read_b64_tr_b16 a[170:171], v22 offset:2560
  ds_read_b64_tr_b16 a[172:173], v23 offset:2048
  ds_read_b64_tr_b16 a[174:175], v23 offset:2560
  ds_read_b64_tr_b16 a[176:177], v22 offset:4096
  ds_read_b64_tr_b16 a[178:179], v22 offset:4608
  ds_read_b64_tr_b16 a[180:181], v23 offset:4096
  ds_read_b64_tr_b16 a[182:183], v23 offset:4608
  ds_read_b64_tr_b16 a[184:185], v22 offset:6144
  ds_read_b64_tr_b16 a[186:187], v22 offset:6656
  ds_read_b64_tr_b16 a[188:189], v23 offset:6144
  ds_read_b64_tr_b16 a[190:191], v23 offset:6656
  s_waitcnt vmcnt(12)
  s_barrier
  v_subrev_u32 v22, 32768, v16
  v_subrev_u32 v23, 32768, v17
  ds_read_b64_tr_b16 a[192:193], v22 offset:0
  ds_read_b64_tr_b16 a[194:195], v22 offset:512
  ds_read_b64_tr_b16 a[196:197], v23 offset:0
  ds_read_b64_tr_b16 a[198:199], v23 offset:512
  ds_read_b64_tr_b16 a[200:201], v22 offset:2048
  ds_read_b64_tr_b16 a[202:203], v22 offset:2560
  ds_read_b64_tr_b16 a[204:205], v23 offset:2048
  ds_read_b64_tr_b16 a[206:207], v23 offset:2560
  ds_read_b64_tr_b16 a[208:209], v22 offset:4096
  ds_read_b64_tr_b16 a[210:211], v22 offset:4608
  ds_read_b64_tr_b16 a[212:213], v23 offset:4096
  ds_read_b64_tr_b16 a[214:215], v23 offset:4608
  ds_read_b64_tr_b16 a[216:217], v22 offset:6144
  ds_read_b64_tr_b16 a[218:219], v22 offset:6656
  ds_read_b64_tr_b16 a[220:221], v23 offset:6144
  ds_read_b64_tr_b16 a[222:223], v23 offset:6656
  s_waitcnt vmcnt(8)
  s_barrier
  v_subrev_u32 v22, 16384, v16
  v_subrev_u32 v23, 16384, v17
  ds_read_b64_tr_b16 a[224:225], v22 offset:0
  ds_read_b64_tr_b16 a[226:227], v22 offset:512
  ds_read_b64_tr_b16 a[228:229], v23 offset:0
  ds_read_b64_tr_b16 a[230:231], v23 offset:512
  ds_read_b64_tr_b16 a[232:233], v22 offset:2048
  ds_read_b64_tr_b16 a[234:235], v22 offset:2560
  ds_read_b64_tr_b16 a[236:237], v23 offset:2048
  ds_read_b64_tr_b16 a[238:239], v23 offset:2560
  ds_read_b64_tr_b16 a[240:241], v22 offset:4096
  ds_read_b64_tr_b16 a[242:243], v22 offset:4608
  ds_read_b64_tr_b16 a[244:245], v23 offset:4096
  ds_read_b64_tr_b16 a[246:247], v23 offset:4608
  ds_read_b64_tr_b16 a[248:249], v22 offset:6144
  ds_read_b64_tr_b16 a[250:251], v22 offset:6656
  ds_read_b64_tr_b16 a[252:253], v23 offset:6144
  ds_read_b64_tr_b16 a[254:255], v23 offset:6656
  s_waitcnt vmcnt(4)
  s_barrier
  v_add_u32 v22, 0, v16
  v_add_u32 v23, 0, v17
  ds_read_b64_tr_b16 v[128:129], v22 offset:0
  ds_read_b64_tr_b16 v[130:131], v22 offset:512
  ds_read_b64_tr_b16 v[132:133], v23 offset:0
  ds_read_b64_tr_b16 v[134:135], v23 offset:512
  ds_read_b64_tr_b16 v[136:137], v22 offset:2048
  ds_read_b64_tr_b16 v[138:139], v22 offset:2560
  ds_read_b64_tr_b16 v[140:141], v23 offset:2048
  ds_read_b64_tr_b16 v[142:143], v23 offset:2560
  ds_read_b64_tr_b16 v[144:145], v22 offset:4096
  ds_read_b64_tr_b16 v[146:147], v22 offset:4608
  ds_read_b64_tr_b16 v[148:149], v23 offset:4096
  ds_read_b64_tr_b16 v[150:151], v23 offset:4608
  ds_read_b64_tr_b16 v[152:153], v22 offset:6144
  ds_read_b64_tr_b16 v[154:155], v22 offset:6656
  ds_read_b64_tr_b16 v[156:157], v23 offset:6144
  ds_read_b64_tr_b16 v[158:159], v23 offset:6656
  s_waitcnt vmcnt(0)
  s_barrier
  v_add_u32 v22, 16384, v16
  v_add_u32 v23, 16384, v17
  ds_read_b64_tr_b16 v[160:161], v22 offset:0
  ds_read_b64_tr_b16 v[162:163], v22 offset:512
  ds_read_b64_tr_b16 v[164:165], v23 offset:0
  ds_read_b64_tr_b16 v[166:167], v23 offset:512
  ds_read_b64_tr_b16 v[168:169], v22 offset:2048
  ds_read_b64_tr_b16 v[170:171], v22 offset:2560
  ds_read_b64_tr_b16 v[172:173], v23 offset:2048
  ds_read_b64_tr_b16 v[174:175], v23 offset:2560
  ds_read_b64_tr_b16 v[176:177], v22 offset:4096
  ds_read_b64_tr_b16 v[178:179], v22 offset:4608
  ds_read_b64_tr_b16 v[180:181], v23 offset:4096
  ds_read_b64_tr_b16 v[182:183], v23 offset:4608
  ds_read_b64_tr_b16 v[184:185], v22 offset:6144
  ds_read_b64_tr_b16 v[186:187], v22 offset:6656
  ds_read_b64_tr_b16 v[188:189], v23 offset:6144
  ds_read_b64_tr_b16 v[190:191], v23 offset:6656
  s_waitcnt lgkmcnt(0)
  s_barrier
rlp_4400106:
  s_mov_b32 s39, s62
  s_lshl_b32 s49, s38, 7
  s_add_u32 s49, s49, 85082112
  v_readfirstlane_b32 s56, v254
  s_nop 0
  s_cmp_ge_u32 s56, 64
  s_nop 0
  s_cbranch_scc1 wok_4400108
  v_mov_b32 v251, 0
wc_4400107:
  buffer_load_dword v250, v251, s[4:7], s49 offen sc1
  s_waitcnt vmcnt(0)
  v_readfirstlane_b32 s56, v250
  s_nop 0
  s_cmp_ge_u32 s56, 16
  s_nop 0
  s_cbranch_scc1 wok_4400108
  s_add_u32 s63, s63, 1
  s_cmp_gt_u32 s63, 4194304
  s_cbranch_scc1 fz_fail
  s_cmp_ge_u32 s38, 31
  s_cbranch_scc1 nap_4400109
  s_sleep 24
  s_branch nape_4400110
nap_4400109:
  s_sleep 12
nape_4400110:
  s_branch wc_4400107
wok_4400108:
  s_barrier
  s_lshl_b32 s30, s38, 6
  s_lshl_b32 s31, s24, 4
  s_add_u32 s30, s30, s31
  s_mul_i32 s27, s30, 1280
  s_add_u32 s27, s27, 91226112
  s_add_u32 s30, s27, 0
  s_add_u32 m0, s35, 0
  s_nop 0
  buffer_load_dwordx4 v1, s[4:7], s30 offen lds
  s_add_u32 s30, s27, 10240
  s_add_u32 m0, s35, 1024
  s_nop 0
  buffer_load_dwordx4 v2, s[4:7], s30 offen lds
  s_add_u32 s30, s27, 128
  s_add_u32 m0, s35, 8192
  s_nop 0
  buffer_load_dwordx4 v1, s[4:7], s30 offen lds
  s_add_u32 s30, s27, 10368
  s_add_u32 m0, s35, 9216
  s_nop 0
  buffer_load_dwordx4 v2, s[4:7], s30 offen lds
  s_add_u32 s30, s27, 256
  s_add_u32 m0, s35, 16384
  s_nop 0
  buffer_load_dwordx4 v1, s[4:7], s30 offen lds
  s_add_u32 s30, s27, 10496
  s_add_u32 m0, s35, 17408
  s_nop 0
  buffer_load_dwordx4 v2, s[4:7], s30 offen lds
  s_add_u32 s30, s27, 384
  s_add_u32 m0, s35, 24576
  s_nop 0
  buffer_load_dwordx4 v1, s[4:7], s30 offen lds
  s_add_u32 s30, s27, 10624
  s_add_u32 m0, s35, 25600
  s_nop 0
  buffer_load_dwordx4 v2, s[4:7], s30 offen lds
  s_add_u32 s30, s27, 512
  s_add_u32 m0, s35, 32768
  s_nop 0
  buffer_load_dwordx4 v1, s[4:7], s30 offen lds
  s_add_u32 s30, s27, 10752
  s_add_u32 m0, s35, 33792
  s_nop 0
  buffer_load_dwordx4 v2, s[4:7], s30 offen lds
  s_add_u32 s30, s27, 640
  s_add_u32 m0, s35, 40960
  s_nop 0
  buffer_load_dwordx4 v1, s[4:7], s30 offen lds
  s_add_u32 s30, s27, 10880
  s_add_u32 m0, s35, 41984
  s_nop 0
  buffer_load_dwordx4 v2, s[4:7], s30 offen lds
  s_add_u32 s30, s27, 768
  s_add_u32 m0, s35, 49152
  s_nop 0
  buffer_load_dwordx4 v1, s[4:7], s30 offen lds
  s_add_u32 s30, s27, 11008
  s_add_u32 m0, s35, 50176
  s_nop 0
  buffer_load_dwordx4 v2, s[4:7], s30 offen lds
  s_add_u32 s30, s27, 896
  s_add_u32 m0, s35, 57344
  s_nop 0
  buffer_load_dwordx4 v1, s[4:7], s30 offen lds
  s_add_u32 s30, s27, 11136
  s_add_u32 m0, s35, 58368
  s_nop 0
  buffer_load_dwordx4 v2, s[4:7], s30 offen lds
  s_add_u32 s30, s27, 1024
  s_add_u32 m0, s35, 65536
  s_nop 0
  buffer_load_dwordx4 v1, s[4:7], s30 offen lds
  s_add_u32 s30, s27, 11264
  s_add_u32 m0, s35, 66560
  s_nop 0
  buffer_load_dwordx4 v2, s[4:7], s30 offen lds
  s_add_u32 s30, s27, 1152
  s_add_u32 m0, s35, 73728
  s_nop 0
  buffer_load_dwordx4 v1, s[4:7], s30 offen lds
  s_add_u32 s30, s27, 11392
  s_add_u32 m0, s35, 74752
  s_nop 0
  buffer_load_dwordx4 v2, s[4:7], s30 offen lds
  v_mov_b64 v[64:65], 0
  v_mov_b64 v[66:67], 0
  v_mov_b64 v[68:69], 0
  v_mov_b64 v[70:71], 0
  v_mov_b64 v[72:73], 0
  v_mov_b64 v[74:75], 0
  v_mov_b64 v[76:77], 0
  v_mov_b64 v[78:79], 0
  v_mov_b64 v[80:81], 0
  v_mov_b64 v[82:83], 0
  v_mov_b64 v[84:85], 0
  v_mov_b64 v[86:87], 0
  v_mov_b64 v[88:89], 0
  v_mov_b64 v[90:91], 0
  v_mov_b64 v[92:93], 0
  v_mov_b64 v[94:95], 0
  s_waitcnt vmcnt(18) lgkmcnt(0)
  s_barrier
  ds_read_b128 v[32:35], v4 offset:0
  s_waitcnt lgkmcnt(0)
  ds_read_b128 v[40:43], v5 offset:0
  v_mfma_f32_32x32x16_bf16 v[64:79], a[0:3], v[32:35], v[64:79]
  v_mfma_f32_32x32x16_bf16 v[80:95], a[4:7], v[32:35], v[80:95]
  s_waitcnt lgkmcnt(0)
  ds_read_b128 v[32:35], v6 offset:0
  v_mfma_f32_32x32x16_bf16 v[64:79], a[8:11], v[40:43], v[64:79]
  v_mfma_f32_32x32x16_bf16 v[80:95], a[12:15], v[40:43], v[80:95]
  s_waitcnt lgkmcnt(0)
  ds_read_b128 v[40:43], v7 offset:0
  v_mfma_f32_32x32x16_bf16 v[64:79], a[16:19], v[32:35], v[64:79]
  v_mfma_f32_32x32x16_bf16 v[80:95], a[20:23], v[32:35], v[80:95]
  s_waitcnt vmcnt(16) lgkmcnt(0)
  s_barrier
  ds_read_b128 v[32:35], v4 offset:8192
  v_mfma_f32_32x32x16_bf16 v[64:79], a[24:27], v[40:43], v[64:79]
  v_mfma_f32_32x32x16_bf16 v[80:95], a[28:31], v[40:43], v[80:95]
  s_waitcnt lgkmcnt(0)
  ds_read_b128 v[40:43], v5 offset:8192
  v_mfma_f32_32x32x16_bf16 v[64:79], a[32:35], v[32:35], v[64:79]
  v_mfma_f32_32x32x16_bf16 v[80:95], a[36:39], v[32:35], v[80:95]
  s_waitcnt lgkmcnt(0)
  ds_read_b128 v[32:35], v6 offset:8192
  v_mfma_f32_32x32x16_bf16 v[64:79], a[40:43], v[40:43], v[64:79]
  v_mfma_f32_32x32x16_bf16 v[80:95], a[44:47], v[40:43], v[80:95]
  s_waitcnt lgkmcnt(0)
  ds_read_b128 v[40:43], v7 offset:8192
  v_mfma_f32_32x32x16_bf16 v[64:79], a[48:51], v[32:35], v[64:79]
  v_mfma_f32_32x32x16_bf16 v[80:95], a[52:55], v[32:35], v[80:95]
  s_waitcnt vmcnt(14) lgkmcnt(0)
  s_barrier
  ds_read_b128 v[32:35], v4 offset:16384
  v_mfma_f32_32x32x16_bf16 v[64:79], a[56:59], v[40:43], v[64:79]
  v_mfma_f32_32x32x16_bf16 v[80:95], a[60:63], v[40:43], v[80:95]
  s_waitcnt lgkmcnt(0)
  ds_read_b128 v[40:43], v5 offset:16384
  v_mfma_f32_32x32x16_bf16 v[64:79], a[64:67], v[32:35], v[64:79]
  v_mfma_f32_32x32x16_bf16 v[80:95], a[68:71], v[32:35], v[80:95]
  s_waitcnt lgkmcnt(0)
  ds_read_b128 v[32:35], v6 offset:16384
  v_mfma_f32_32x32x16_bf16 v[64:79], a[72:75], v[40:43], v[64:79]
  v_mfma_f32_32x32x16_bf16 v[80:95], a[76:79], v[40:43], v[80:95]
  s_waitcnt lgkmcnt(0)
  ds_read_b128 v[40:43], v7 offset:16384
  v_mfma_f32_32x32x16_bf16 v[64:79], a[80:83], v[32:35], v[64:79]
  v_mfma_f32_32x32x16_bf16 v[80:95], a[84:87], v[32:35], v[80:95]
  s_waitcnt vmcnt(12) lgkmcnt(0)
  s_barrier
  ds_read_b128 v[32:35], v4 offset:24576
  v_mfma_f32_32x32x16_bf16 v[64:79], a[88:91], v[40:43], v[64:79]
  v_mfma_f32_32x32x16_bf16 v[80:95], a[92:95], v[40:43], v[80:95]
  s_waitcnt lgkmcnt(0)
  ds_read_b128 v[40:43], v5 offset:24576
  v_mfma_f32_32x32x16_bf16 v[64:79], a[96:99], v[32:35], v[64:79]
  v_mfma_f32_32x32x16_bf16 v[80:95], a[100:103], v[32:35], v[80:95]
  s_waitcnt lgkmcnt(0)
  ds_read_b128 v[32:35], v6 offset:24576
  v_mfma_f32_32x32x16_bf16 v[64:79], a[104:107], v[40:43], v[64:79]
  v_mfma_f32_32x32x16_bf16 v[80:95], a[108:111], v[40:43], v[80:95]
  s_waitcnt lgkmcnt(0)
  ds_read_b128 v[40:43], v7 offset:24576
  v_mfma_f32_32x32x16_bf16 v[64:79], a[112:115], v[32:35], v[64:79]
  v_mfma_f32_32x32x16_bf16 v[80:95], a[116:119], v[32:35], v[80:95]
  s_waitcnt vmcnt(10) lgkmcnt(0)
  s_barrier
  ds_read_b128 v[32:35], v4 offset:32768
  v_mfma_f32_32x32x16_bf16 v[64:79], a[120:123], v[40:43], v[64:79]
  v_mfma_f32_32x32x16_bf16 v[80:95], a[124:127], v[40:43], v[80:95]
  s_waitcnt lgkmcnt(0)
  ds_read_b128 v[40:43], v5 offset:32768
  v_mfma_f32_32x32x16_bf16 v[64:79], a[128:131], v[32:35], v[64:79]
  v_mfma_f32_32x32x16_bf16 v[80:95], a[132:135], v[32:35], v[80:95]
  s_waitcnt lgkmcnt(0)
  ds_read_b128 v[32:35], v6 offset:32768
  v_mfma_f32_32x32x16_bf16 v[64:79], a[136:139], v[40:43], v[64:79]
  v_mfma_f32_32x32x16_bf16 v[80:95], a[140:143], v[40:43], v[80:95]
  s_waitcnt lgkmcnt(0)
  ds_read_b128 v[40:43], v7 offset:32768
  v_mfma_f32_32x32x16_bf16 v[64:79], a[144:147], v[32:35], v[64:79]
  v_mfma_f32_32x32x16_bf16 v[80:95], a[148:151], v[32:35], v[80:95]
  s_waitcnt vmcnt(8) lgkmcnt(0)
  s_barrier
  ds_read_b128 v[32:35], v4 offset:40960
  v_mfma_f32_32x32x16_bf16 v[64:79], a[152:155], v[40:43], v[64:79]
  v_mfma_f32_32x32x16_bf16 v[80:95], a[156:159], v[40:43], v[80:95]
  s_waitcnt lgkmcnt(0)
  ds_read_b128 v[40:43], v5 offset:40960
  v_mfma_f32_32x32x16_bf16 v[64:79], a[160:163], v[32:35], v[64:79]
  v_mfma_f32_32x32x16_bf16 v[80:95], a[164:167], v[32:35], v[80:95]
  s_waitcnt lgkmcnt(0)
  ds_read_b128 v[32:35], v6 offset:40960
  v_mfma_f32_32x32x16_bf16 v[64:79], a[168:171], v[40:43], v[64:79]
  v_mfma_f32_32x32x16_bf16 v[80:95], a[172:175], v[40:43], v[80:95]
  s_waitcnt lgkmcnt(0)
  ds_read_b128 v[40:43], v7 offset:40960
  v_mfma_f32_32x32x16_bf16 v[64:79], a[176:179], v[32:35], v[64:79]
  v_mfma_f32_32x32x16_bf16 v[80:95], a[180:183], v[32:35], v[80:95]
  s_waitcnt vmcnt(6) lgkmcnt(0)
  s_barrier
  ds_read_b128 v[32:35], v4 offset:49152
  v_mfma_f32_32x32x16_bf16 v[64:79], a[184:187], v[40:43], v[64:79]
  v_mfma_f32_32x32x16_bf16 v[80:95], a[188:191], v[40:43], v[80:95]
  s_waitcnt lgkmcnt(0)
  ds_read_b128 v[40:43], v5 offset:49152
  v_mfma_f32_32x32x16_bf16 v[64:79], a[192:195], v[32:35], v[64:79]
  v_mfma_f32_32x32x16_bf16 v[80:95], a[196:199], v[32:35], v[80:95]
  s_waitcnt lgkmcnt(0)
  ds_read_b128 v[32:35], v6 offset:49152
  v_mfma_f32_32x32x16_bf16 v[64:79], a[200:203], v[40:43], v[64:79]
  v_mfma_f32_32x32x16_bf16 v[80:95], a[204:207], v[40:43], v[80:95]
  s_waitcnt lgkmcnt(0)
  ds_read_b128 v[40:43], v7 offset:49152
  v_mfma_f32_32x32x16_bf16 v[64:79], a[208:211], v[32:35], v[64:79]
  v_mfma_f32_32x32x16_bf16 v[80:95], a[212:215], v[32:35], v[80:95]
  s_waitcnt vmcnt(4) lgkmcnt(0)
  s_barrier
  ds_read_b128 v[32:35], v4 offset:57344
  v_mfma_f32_32x32x16_bf16 v[64:79], a[216:219], v[40:43], v[64:79]
  v_mfma_f32_32x32x16_bf16 v[80:95], a[220:223], v[40:43], v[80:95]
  s_waitcnt lgkmcnt(0)
  ds_read_b128 v[40:43], v5 offset:57344
  v_mfma_f32_32x32x16_bf16 v[64:79], a[224:227], v[32:35], v[64:79]
  v_mfma_f32_32x32x16_bf16 v[80:95], a[228:231], v[32:35], v[80:95]
  s_waitcnt lgkmcnt(0)
  ds_read_b128 v[32:35], v6 offset:57344
  v_mfma_f32_32x32x16_bf16 v[64:79], a[232:235], v[40:43], v[64:79]
  v_mfma_f32_32x32x16_bf16 v[80:95], a[236:239], v[40:43], v[80:95]
  s_waitcnt lgkmcnt(0)
  ds_read_b128 v[40:43], v7 offset:57344
  v_mfma_f32_32x32x16_bf16 v[64:79], a[240:243], v[32:35], v[64:79]
  v_mfma_f32_32x32x16_bf16 v[80:95], a[244:247], v[32:35], v[80:95]
  s_waitcnt vmcnt(2) lgkmcnt(0)
  s_barrier
  ds_read_b128 v[32:35], v8 offset:0
  v_mfma_f32_32x32x16_bf16 v[64:79], a[248:251], v[40:43], v[64:79]
  v_mfma_f32_32x32x16_bf16 v[80:95], a[252:255], v[40:43], v[80:95]
  s_waitcnt lgkmcnt(0)
  ds_read_b128 v[40:43], v9 offset:0
  v_mfma_f32_32x32x16_bf16 v[64:79], v[128:131], v[32:35], v[64:79]
  v_mfma_f32_32x32x16_bf16 v[80:95], v[132:135], v[32:35], v[80:95]
  s_waitcnt lgkmcnt(0)
  ds_read_b128 v[32:35], v10 offset:0
  v_mfma_f32_32x32x16_bf16 v[64:79], v[136:139], v[40:43], v[64:79]
  v_mfma_f32_32x32x16_bf16 v[80:95], v[140:143], v[40:43], v[80:95]
  s_waitcnt lgkmcnt(0)
  ds_read_b128 v[40:43], v11 offset:0
  v_mfma_f32_32x32x16_bf16 v[64:79], v[144:147], v[32:35], v[64:79]
  v_mfma_f32_32x32x16_bf16 v[80:95], v[148:151], v[32:35], v[80:95]
  s_waitcnt vmcnt(0) lgkmcnt(0)
  s_barrier
  ds_read_b128 v[32:35], v8 offset:8192
  v_mfma_f32_32x32x16_bf16 v[64:79], v[152:155], v[40:43], v[64:79]
  v_mfma_f32_32x32x16_bf16 v[80:95], v[156:159], v[40:43], v[80:95]
  s_waitcnt lgkmcnt(0)
  ds_read_b128 v[40:43], v9 offset:8192
  v_mfma_f32_32x32x16_bf16 v[64:79], v[160:163], v[32:35], v[64:79]
  v_mfma_f32_32x32x16_bf16 v[80:95], v[164:167], v[32:35], v[80:95]
  s_waitcnt lgkmcnt(0)
  ds_read_b128 v[32:35], v10 offset:8192
  v_mfma_f32_32x32x16_bf16 v[64:79], v[168:171], v[40:43], v[64:79]
  v_mfma_f32_32x32x16_bf16 v[80:95], v[172:175], v[40:43], v[80:95]
  s_waitcnt lgkmcnt(0)
  ds_read_b128 v[40:43], v11 offset:8192
  v_mfma_f32_32x32x16_bf16 v[64:79], v[176:179], v[32:35], v[64:79]
  v_mfma_f32_32x32x16_bf16 v[80:95], v[180:183], v[32:35], v[80:95]
  s_waitcnt lgkmcnt(0)
  v_mfma_f32_32x32x16_bf16 v[64:79], v[184:187], v[40:43], v[64:79]
  v_mfma_f32_32x32x16_bf16 v[80:95], v[188:191], v[40:43], v[80:95]
  s_barrier
  s_mov_b32 s48, 0xbfb8aa3b
  v_and_b32 v22, 31, v0
  s_lshl_b32 s46, s25, 5
  v_add_u32 v23, s46, v22
  v_lshlrev_b32 v23, 7, v23
  v_and_b32 v28, 7, v0
  v_lshrrev_b32 v29, 5, v0
  s_lshl_b32 s47, s26, 2
  v_add_u32 v29, s47, v29
  s_nop 0
  v_mul_f32 v24, s48, v64
  v_exp_f32 v24, v24
  s_nop 0
  v_add_f32 v24, 1.0, v24
  v_rcp_f32 v24, v24
  s_nop 0
  v_mul_f32 v64, v64, v24
  v_mul_f32 v64, v64, v80
  v_mul_f32 v25, s48, v65
  v_exp_f32 v25, v25
  s_nop 0
  v_add_f32 v25, 1.0, v25
  v_rcp_f32 v25, v25
  s_nop 0
  v_mul_f32 v65, v65, v25
  v_mul_f32 v65, v65, v81
  v_mul_f32 v26, s48, v66
  v_exp_f32 v26, v26
  s_nop 0
  v_add_f32 v26, 1.0, v26
  v_rcp_f32 v26, v26
  s_nop 0
  v_mul_f32 v66, v66, v26
  v_mul_f32 v66, v66, v82
  v_mul_f32 v27, s48, v67
  v_exp_f32 v27, v27
  s_nop 0
  v_add_f32 v27, 1.0, v27
  v_rcp_f32 v27, v27
  s_nop 0
  v_mul_f32 v67, v67, v27
  v_mul_f32 v67, v67, v83
  v_mul_f32 v24, s48, v68
  v_exp_f32 v24, v24
  s_nop 0
  v_add_f32 v24, 1.0, v24
  v_rcp_f32 v24, v24
  s_nop 0
  v_mul_f32 v68, v68, v24
  v_mul_f32 v68, v68, v84
  v_mul_f32 v25, s48, v69
  v_exp_f32 v25, v25
  s_nop 0
  v_add_f32 v25, 1.0, v25
  v_rcp_f32 v25, v25
  s_nop 0
  v_mul_f32 v69, v69, v25
  v_mul_f32 v69, v69, v85
  v_mul_f32 v26, s48, v70
  v_exp_f32 v26, v26
  s_nop 0
  v_add_f32 v26, 1.0, v26
  v_rcp_f32 v26, v26
  s_nop 0
  v_mul_f32 v70, v70, v26
  v_mul_f32 v70, v70, v86
  v_mul_f32 v27, s48, v71
  v_exp_f32 v27, v27
  s_nop 0
  v_add_f32 v27, 1.0, v27
  v_rcp_f32 v27, v27
  s_nop 0
  v_mul_f32 v71, v71, v27
  v_mul_f32 v71, v71, v87
  v_mul_f32 v24, s48, v72
  v_exp_f32 v24, v24
  s_nop 0
  v_add_f32 v24, 1.0, v24
  v_rcp_f32 v24, v24
  s_nop 0
  v_mul_f32 v72, v72, v24
  v_mul_f32 v72, v72, v88
  v_mul_f32 v25, s48, v73
  v_exp_f32 v25, v25
  s_nop 0
  v_add_f32 v25, 1.0, v25
  v_rcp_f32 v25, v25
  s_nop 0
  v_mul_f32 v73, v73, v25
  v_mul_f32 v73, v73, v89
  v_mul_f32 v26, s48, v74
  v_exp_f32 v26, v26
  s_nop 0
  v_add_f32 v26, 1.0, v26
  v_rcp_f32 v26, v26
  s_nop 0
  v_mul_f32 v74, v74, v26
  v_mul_f32 v74, v74, v90
  v_mul_f32 v27, s48, v75
  v_exp_f32 v27, v27
  s_nop 0
  v_add_f32 v27, 1.0, v27
  v_rcp_f32 v27, v27
  s_nop 0
  v_mul_f32 v75, v75, v27
  v_mul_f32 v75, v75, v91
  v_mul_f32 v24, s48, v76
  v_exp_f32 v24, v24
  s_nop 0
  v_add_f32 v24, 1.0, v24
  v_rcp_f32 v24, v24
  s_nop 0
  v_mul_f32 v76, v76, v24
  v_mul_f32 v76, v76, v92
  v_mul_f32 v25, s48, v77
  v_exp_f32 v25, v25
  s_nop 0
  v_add_f32 v25, 1.0, v25
  v_rcp_f32 v25, v25
  s_nop 0
  v_mul_f32 v77, v77, v25
  v_mul_f32 v77, v77, v93
  v_mul_f32 v26, s48, v78
  v_exp_f32 v26, v26
  s_nop 0
  v_add_f32 v26, 1.0, v26
  v_rcp_f32 v26, v26
  s_nop 0
  v_mul_f32 v78, v78, v26
  v_mul_f32 v78, v78, v94
  v_mul_f32 v27, s48, v79
  v_exp_f32 v27, v27
  s_nop 0
  v_add_f32 v27, 1.0, v27
  v_rcp_f32 v27, v27
  s_nop 0
  v_mul_f32 v79, v79, v27
  v_mul_f32 v79, v79, v95
  v_cvt_pk_bf16_f32 v32, v64, v65
  v_cvt_pk_bf16_f32 v33, v66, v67
  v_cvt_pk_bf16_f32 v34, v68, v69
  v_cvt_pk_bf16_f32 v35, v70, v71
  v_cvt_pk_bf16_f32 v36, v72, v73
  v_cvt_pk_bf16_f32 v37, v74, v75
  v_cvt_pk_bf16_f32 v38, v76, v77
  v_cvt_pk_bf16_f32 v39, v78, v79
  v_permlane32_swap_b32 v32, v34
  v_permlane32_swap_b32 v33, v35
  v_permlane32_swap_b32 v36, v38
  v_permlane32_swap_b32 v37, v39
  v_add_u32 v30, 0, v29
  v_xor_b32 v30, v30, v28
  v_lshlrev_b32 v30, 4, v30
  v_add_u32 v30, v30, v23
  ds_write_b128 v30, v[32:35]
  v_add_u32 v30, 2, v29
  v_xor_b32 v30, v30, v28
  v_lshlrev_b32 v30, 4, v30
  v_add_u32 v30, v30, v23
  ds_write_b128 v30, v[36:39]
  s_waitcnt lgkmcnt(0)
  s_barrier
  v_lshrrev_b32 v22, 3, v0
  v_and_b32 v24, 7, v0
  v_xor_b32 v25, v24, v22
  v_lshlrev_b32 v25, 4, v25
  v_lshlrev_b32 v26, 7, v22
  v_add_u32 v25, v25, v26
  s_lshl_b32 s46, s24, 11
  v_add_u32 v25, s46, v25
  s_mov_b32 s47, 3456
  v_mul_lo_u32 v22, v22, s47
  v_lshlrev_b32 v24, 4, v24
  v_add_u32 v22, v22, v24
  s_lshl_b32 s46, s38, 6
  s_lshl_b32 s47, s24, 4
  s_add_u32 s46, s46, s47
  s_mul_i32 s45, s46, 3456
  s_add_u32 s45, s45, 94371840
  s_lshl_b32 s46, s39, 7
  s_add_u32 s45, s45, s46
  ds_read_b128 v[32:35], v25 offset:0
  ds_read_b128 v[36:39], v25 offset:1024
  s_waitcnt lgkmcnt(1)
  s_add_u32 s47, s45, 0
  buffer_store_dwordx4 v[32:35], v22, s[4:7], s47 offen sc1
  s_waitcnt lgkmcnt(0)
  s_add_u32 s47, s45, 27648
  buffer_store_dwordx4 v[36:39], v22, s[4:7], s47 offen sc1
  s_lshl_b32 s49, s38, 7
  s_add_u32 s49, s49, 85086208
  s_waitcnt vmcnt(0)
  s_barrier
  v_cmp_eq_u32 vcc, 0, v254
  s_nop 0
  s_and_saveexec_b64 s[56:57], vcc
  s_cbranch_execz sig_4400111
  v_mov_b32 v250, 1
  v_mov_b32 v251, 0
  buffer_atomic_add v250, v251, s[4:7], s49 offen
sig_4400111:
  s_mov_b64 exec, s[56:57]
  s_barrier
  s_add_u32 s38, s38, 2
  s_cmp_lt_u32 s38, 32
  s_cbranch_scc1 rlp_4400106
  s_branch post_done
rk_4400105:
  s_sub_u32 s39, s39, 54
  s_cmp_ge_u32 s39, 40
  s_cbranch_scc1 rk_4400112
  s_mov_b32 s38, 0
  s_cmp_ge_u32 s39, 10
  s_cselect_b32 s56, 10, 0
  s_cselect_b32 s57, 1, 0
  s_sub_u32 s39, s39, s56
  s_add_u32 s38, s38, s57
  s_cmp_ge_u32 s39, 10
  s_cselect_b32 s56, 10, 0
  s_cselect_b32 s57, 1, 0
  s_sub_u32 s39, s39, s56
  s_add_u32 s38, s38, s57
  s_cmp_ge_u32 s39, 10
  s_cselect_b32 s56, 10, 0
  s_cselect_b32 s57, 1, 0
  s_sub_u32 s39, s39, s56
  s_add_u32 s38, s38, s57
  s_mov_b32 s62, s39
  s_load_dwordx2 s[8:9], s[0:1], 80
  s_mov_b32 s10, 2211840
  s_mov_b32 s11, 0x00020000
  s_load_dwordx2 s[16:17], s[0:1], 88
  s_mov_b32 s18, 2621440
  s_mov_b32 s19, 0x00020000
  v_mov_b32 v31, v254
  v_mov_b32 v0, v31
  v_lshrrev_b32 v22, 6, v0
  s_nop 0
  v_readfirstlane_b32 s24, v22
  v_and_b32 v0, 63, v0
  s_lshr_b32 s25, s24, 1
  s_and_b32 s26, s24, 1
  v_lshrrev_b32 v22, 3, v0
  s_mov_b32 s30, 3456
  v_mul_lo_u32 v22, v22, s30
  v_and_b32 v23, 7, v0
  v_lshrrev_b32 v24, 4, v0
  v_xor_b32 v23, v23, v24
  v_lshlrev_b32 v24, 4, v23
  v_add_u32 v1, v22, v24
  v_xor_b32 v23, 4, v23
  v_lshlrev_b32 v24, 4, v23
  v_add_u32 v2, v22, v24
  v_lshrrev_b32 v22, 3, v0
  s_mov_b32 s30, 1280
  v_mul_lo_u32 v23, v22, s30
  v_bfe_u32 v24, v0, 2, 1
  v_bfe_u32 v25, v0, 4, 1
  v_xor_b32 v24, v24, v25
  v_lshlrev_b32 v24, 6, v24
  v_add_u32 v23, v23, v24
  v_and_b32 v24, 3, v0
  v_lshlrev_b32 v24, 4, v24
  v_add_u32 v3, v23, v24
  v_and_b32 v22, 31, v0
  s_lshl_b32 s30, s25, 5
  v_add_u32 v23, s30, v22
  v_lshlrev_b32 v23, 7, v23
  v_bfe_u32 v24, v0, 1, 3
  v_lshrrev_b32 v25, 5, v0
  v_add_u32 v26, 0, v25
  v_xor_b32 v26, v26, v24
  v_lshlrev_b32 v26, 4, v26
  v_add_u32 v4, v23, v26
  v_add_u32 v8, 65536, v4
  v_add_u32 v26, 2, v25
  v_xor_b32 v26, v26, v24
  v_lshlrev_b32 v26, 4, v26
  v_add_u32 v5, v23, v26
  v_add_u32 v9, 65536, v5
  v_add_u32 v26, 4, v25
  v_xor_b32 v26, v26, v24
  v_lshlrev_b32 v26, 4, v26
  v_add_u32 v6, v23, v26
  v_add_u32 v10, 65536, v6
  v_add_u32 v26, 6, v25
  v_xor_b32 v26, v26, v24
  v_lshlrev_b32 v26, 4, v26
  v_add_u32 v7, v23, v26
  v_add_u32 v11, 65536, v7
  v_lshrrev_b32 v22, 5, v0
  v_lshlrev_b32 v22, 3, v22
  v_bfe_u32 v23, v0, 2, 2
  v_add_u32 v22, v22, v23
  v_lshlrev_b32 v22, 7, v22
  v_bfe_u32 v24, v0, 4, 1
  v_lshlrev_b32 v24, 5, v24
  v_add_u32 v22, v22, v24
  v_and_b32 v24, 3, v0
  v_lshlrev_b32 v24, 3, v24
  v_add_u32 v22, v22, v24
  v_bfe_u32 v23, v0, 3, 1
  v_xor_b32 v23, s26, v23
  v_lshlrev_b32 v23, 6, v23
  v_add_u32 v22, v22, v23
  v_add_u32 v16, 131072, v22
  v_add_u32 v17, 139264, v22
  s_lshl_b32 s35, s24, 11
  s_lshl_b32 s36, s24, 11
  s_add_u32 s36, s36, 131072
  s_lshl_b32 s28, s39, 7
  s_mul_i32 s31, s24, 20480
  s_add_u32 s28, s28, s31
  s_waitcnt lgkmcnt(0)
  s_add_u32 s30, s28, 0
  s_add_u32 m0, s36, 0
  s_nop 0
  buffer_load_dwordx4 v3, s[8:11], s30 offen lds
  s_add_u32 s30, s28, 10240
  s_add_u32 m0, s36, 1024
  s_nop 0
  buffer_load_dwordx4 v3, s[8:11], s30 offen lds
  s_barrier
  s_add_u32 s30, s28, 81920
  s_add_u32 m0, s36, 16384
  s_nop 0
  buffer_load_dwordx4 v3, s[8:11], s30 offen lds
  s_add_u32 s30, s28, 92160
  s_add_u32 m0, s36, 17408
  s_nop 0
  buffer_load_dwordx4 v3, s[8:11], s30 offen lds
  s_waitcnt vmcnt(2)
  s_barrier
  ds_read_b64_tr_b16 a[0:1], v16 offset:0
  ds_read_b64_tr_b16 a[2:3], v16 offset:512
  ds_read_b64_tr_b16 a[4:5], v16 offset:2048
  ds_read_b64_tr_b16 a[6:7], v16 offset:2560
  ds_read_b64_tr_b16 a[8:9], v16 offset:4096
  ds_read_b64_tr_b16 a[10:11], v16 offset:4608
  ds_read_b64_tr_b16 a[12:13], v16 offset:6144
  ds_read_b64_tr_b16 a[14:15], v16 offset:6656
  s_waitcnt lgkmcnt(0)
  s_barrier
  s_add_u32 s30, s28, 163840
  s_add_u32 m0, s36, 0
  s_nop 0
  buffer_load_dwordx4 v3, s[8:11], s30 offen lds
  s_add_u32 s30, s28, 174080
  s_add_u32 m0, s36, 1024
  s_nop 0
  buffer_load_dwordx4 v3, s[8:11], s30 offen lds
  s_waitcnt vmcnt(2)
  s_barrier
  ds_read_b64_tr_b16 a[16:17], v16 offset:16384
  ds_read_b64_tr_b16 a[18:19], v16 offset:16896
  ds_read_b64_tr_b16 a[20:21], v16 offset:18432
  ds_read_b64_tr_b16 a[22:23], v16 offset:18944
  ds_read_b64_tr_b16 a[24:25], v16 offset:20480
  ds_read_b64_tr_b16 a[26:27], v16 offset:20992
  ds_read_b64_tr_b16 a[28:29], v16 offset:22528
  ds_read_b64_tr_b16 a[30:31], v16 offset:23040
  s_waitcnt lgkmcnt(0)
  s_barrier
  s_add_u32 s30, s28, 245760
  s_add_u32 m0, s36, 16384
  s_nop 0
  buffer_load_dwordx4 v3, s[8:11], s30 offen lds
  s_add_u32 s30, s28, 256000
  s_add_u32 m0, s36, 17408
  s_nop 0
  buffer_load_dwordx4 v3, s[8:11], s30 offen lds
  s_waitcnt vmcnt(2)
  s_barrier
  ds_read_b64_tr_b16 a[32:33], v16 offset:0
  ds_read_b64_tr_b16 a[34:35], v16 offset:512
  ds_read_b64_tr_b16 a[36:37], v16 offset:2048
  ds_read_b64_tr_b16 a[38:39], v16 offset:2560
  ds_read_b64_tr_b16 a[40:41], v16 offset:4096
  ds_read_b64_tr_b16 a[42:43], v16 offset:4608
  ds_read_b64_tr_b16 a[44:45], v16 offset:6144
  ds_read_b64_tr_b16 a[46:47], v16 offset:6656
  s_waitcnt lgkmcnt(0)
  s_barrier
  s_add_u32 s30, s28, 327680
  s_add_u32 m0, s36, 0
  s_nop 0
  buffer_load_dwordx4 v3, s[8:11], s30 offen lds
  s_add_u32 s30, s28, 337920
  s_add_u32 m0, s36, 1024
  s_nop 0
  buffer_load_dwordx4 v3, s[8:11], s30 offen lds
  s_waitcnt vmcnt(2)
  s_barrier
  ds_read_b64_tr_b16 a[48:49], v16 offset:16384
  ds_read_b64_tr_b16 a[50:51], v16 offset:16896
  ds_read_b64_tr_b16 a[52:53], v16 offset:18432
  ds_read_b64_tr_b16 a[54:55], v16 offset:18944
  ds_read_b64_tr_b16 a[56:57], v16 offset:20480
  ds_read_b64_tr_b16 a[58:59], v16 offset:20992
  ds_read_b64_tr_b16 a[60:61], v16 offset:22528
  ds_read_b64_tr_b16 a[62:63], v16 offset:23040
  s_waitcnt lgkmcnt(0)
  s_barrier
  s_add_u32 s30, s28, 409600
  s_add_u32 m0, s36, 16384
  s_nop 0
  buffer_load_dwordx4 v3, s[8:11], s30 offen lds
  s_add_u32 s30, s28, 419840
  s_add_u32 m0, s36, 17408
  s_nop 0
  buffer_load_dwordx4 v3, s[8:11], s30 offen lds
  s_waitcnt vmcnt(2)
  s_barrier
  ds_read_b64_tr_b16 a[64:65], v16 offset:0
  ds_read_b64_tr_b16 a[66:67], v16 offset:512
  ds_read_b64_tr_b16 a[68:69], v16 offset:2048
  ds_read_b64_tr_b16 a[70:71], v16 offset:2560
  ds_read_b64_tr_b16 a[72:73], v16 offset:4096
  ds_read_b64_tr_b16 a[74:75], v16 offset:4608
  ds_read_b64_tr_b16 a[76:77], v16 offset:6144
  ds_read_b64_tr_b16 a[78:79], v16 offset:6656
  s_waitcnt lgkmcnt(0)
  s_barrier
  s_add_u32 s30, s28, 491520
  s_add_u32 m0, s36, 0
  s_nop 0
  buffer_load_dwordx4 v3, s[8:11], s30 offen lds
  s_add_u32 s30, s28, 501760
  s_add_u32 m0, s36, 1024
  s_nop 0
  buffer_load_dwordx4 v3, s[8:11], s30 offen lds
  s_waitcnt vmcnt(2)
  s_barrier
  ds_read_b64_tr_b16 a[80:81], v16 offset:16384
  ds_read_b64_tr_b16 a[82:83], v16 offset:16896
  ds_read_b64_tr_b16 a[84:85], v16 offset:18432
  ds_read_b64_tr_b16 a[86:87], v16 offset:18944
  ds_read_b64_tr_b16 a[88:89], v16 offset:20480
  ds_read_b64_tr_b16 a[90:91], v16 offset:20992
  ds_read_b64_tr_b16 a[92:93], v16 offset:22528
  ds_read_b64_tr_b16 a[94:95], v16 offset:23040
  s_waitcnt lgkmcnt(0)
  s_barrier
  s_add_u32 s30, s28, 573440
  s_add_u32 m0, s36, 16384
  s_nop 0
  buffer_load_dwordx4 v3, s[8:11], s30 offen lds
  s_add_u32 s30, s28, 583680
  s_add_u32 m0, s36, 17408
  s_nop 0
  buffer_load_dwordx4 v3, s[8:11], s30 offen lds
  s_waitcnt vmcnt(2)
  s_barrier
  ds_read_b64_tr_b16 a[96:97], v16 offset:0
  ds_read_b64_tr_b16 a[98:99], v16 offset:512
  ds_read_b64_tr_b16 a[100:101], v16 offset:2048
  ds_read_b64_tr_b16 a[102:103], v16 offset:2560
  ds_read_b64_tr_b16 a[104:105], v16 offset:4096
  ds_read_b64_tr_b16 a[106:107], v16 offset:4608
  ds_read_b64_tr_b16 a[108:109], v16 offset:6144
  ds_read_b64_tr_b16 a[110:111], v16 offset:6656
  s_waitcnt lgkmcnt(0)
  s_barrier
  s_add_u32 s30, s28, 655360
  s_add_u32 m0, s36, 0
  s_nop 0
  buffer_load_dwordx4 v3, s[8:11], s30 offen lds
  s_add_u32 s30, s28, 665600
  s_add_u32 m0, s36, 1024
  s_nop 0
  buffer_load_dwordx4 v3, s[8:11], s30 offen lds
  s_waitcnt vmcnt(2)
  s_barrier
  ds_read_b64_tr_b16 a[112:113], v16 offset:16384
  ds_read_b64_tr_b16 a[114:115], v16 offset:16896
  ds_read_b64_tr_b16 a[116:117], v16 offset:18432
  ds_read_b64_tr_b16 a[118:119], v16 offset:18944
  ds_read_b64_tr_b16 a[120:121], v16 offset:20480
  ds_read_b64_tr_b16 a[122:123], v16 offset:20992
  ds_read_b64_tr_b16 a[124:125], v16 offset:22528
  ds_read_b64_tr_b16 a[126:127], v16 offset:23040
  s_waitcnt lgkmcnt(0)
  s_barrier
  s_add_u32 s30, s28, 737280
  s_add_u32 m0, s36, 16384
  s_nop 0
  buffer_load_dwordx4 v3, s[8:11], s30 offen lds
  s_add_u32 s30, s28, 747520
  s_add_u32 m0, s36, 17408
  s_nop 0
  buffer_load_dwordx4 v3, s[8:11], s30 offen lds
  s_waitcnt vmcnt(2)
  s_barrier
  ds_read_b64_tr_b16 a[128:129], v16 offset:0
  ds_read_b64_tr_b16 a[130:131], v16 offset:512
  ds_read_b64_tr_b16 a[132:133], v16 offset:2048
  ds_read_b64_tr_b16 a[134:135], v16 offset:2560
  ds_read_b64_tr_b16 a[136:137], v16 offset:4096
  ds_read_b64_tr_b16 a[138:139], v16 offset:4608
  ds_read_b64_tr_b16 a[140:141], v16 offset:6144
  ds_read_b64_tr_b16 a[142:143], v16 offset:6656
  s_waitcnt lgkmcnt(0)
  s_barrier
  s_add_u32 s30, s28, 819200
  s_add_u32 m0, s36, 0
  s_nop 0
  buffer_load_dwordx4 v3, s[8:11], s30 offen lds
  s_add_u32 s30, s28, 829440
  s_add_u32 m0, s36, 1024
  s_nop 0
  buffer_load_dwordx4 v3, s[8:11], s30 offen lds
  s_waitcnt vmcnt(2)
  s_barrier
  ds_read_b64_tr_b16 a[144:145], v16 offset:16384
  ds_read_b64_tr_b16 a[146:147], v16 offset:16896
  ds_read_b64_tr_b16 a[148:149], v16 offset:18432
  ds_read_b64_tr_b16 a[150:151], v16 offset:18944
  ds_read_b64_tr_b16 a[152:153], v16 offset:20480
  ds_read_b64_tr_b16 a[154:155], v16 offset:20992
  ds_read_b64_tr_b16 a[156:157], v16 offset:22528
  ds_read_b64_tr_b16 a[158:159], v16 offset:23040
  s_waitcnt lgkmcnt(0)
  s_barrier
  s_add_u32 s30, s28, 901120
  s_add_u32 m0, s36, 16384
  s_nop 0
  buffer_load_dwordx4 v3, s[8:11], s30 offen lds
  s_add_u32 s30, s28, 911360
  s_add_u32 m0, s36, 17408
  s_nop 0
  buffer_load_dwordx4 v3, s[8:11], s30 offen lds
  s_waitcnt vmcnt(2)
  s_barrier
  ds_read_b64_tr_b16 a[160:161], v16 offset:0
  ds_read_b64_tr_b16 a[162:163], v16 offset:512
  ds_read_b64_tr_b16 a[164:165], v16 offset:2048
  ds_read_b64_tr_b16 a[166:167], v16 offset:2560
  ds_read_b64_tr_b16 a[168:169], v16 offset:4096
  ds_read_b64_tr_b16 a[170:171], v16 offset:4608
  ds_read_b64_tr_b16 a[172:173], v16 offset:6144
  ds_read_b64_tr_b16 a[174:175], v16 offset:6656
  s_waitcnt lgkmcnt(0)
  s_barrier
  s_add_u32 s30, s28, 983040
  s_add_u32 m0, s36, 0
  s_nop 0
  buffer_load_dwordx4 v3, s[8:11], s30 offen lds
  s_add_u32 s30, s28, 993280
  s_add_u32 m0, s36, 1024
  s_nop 0
  buffer_load_dwordx4 v3, s[8:11], s30 offen lds
  s_waitcnt vmcnt(2)
  s_barrier
  ds_read_b64_tr_b16 a[176:177], v16 offset:16384
  ds_read_b64_tr_b16 a[178:179], v16 offset:16896
  ds_read_b64_tr_b16 a[180:181], v16 offset:18432
  ds_read_b64_tr_b16 a[182:183], v16 offset:18944
  ds_read_b64_tr_b16 a[184:185], v16 offset:20480
  ds_read_b64_tr_b16 a[186:187], v16 offset:20992
  ds_read_b64_tr_b16 a[188:189], v16 offset:22528
  ds_read_b64_tr_b16 a[190:191], v16 offset:23040
  s_waitcnt lgkmcnt(0)
  s_barrier
  s_add_u32 s30, s28, 1064960
  s_add_u32 m0, s36, 16384
  s_nop 0
  buffer_load_dwordx4 v3, s[8:11], s30 offen lds
  s_add_u32 s30, s28, 1075200
  s_add_u32 m0, s36, 17408
  s_nop 0
  buffer_load_dwordx4 v3, s[8:11], s30 offen lds
  s_waitcnt vmcnt(2)
  s_barrier
  ds_read_b64_tr_b16 a[192:193], v16 offset:0
  ds_read_b64_tr_b16 a[194:195], v16 offset:512
  ds_read_b64_tr_b16 a[196:197], v16 offset:2048
  ds_read_b64_tr_b16 a[198:199], v16 offset:2560
  ds_read_b64_tr_b16 a[200:201], v16 offset:4096
  ds_read_b64_tr_b16 a[202:203], v16 offset:4608
  ds_read_b64_tr_b16 a[204:205], v16 offset:6144
  ds_read_b64_tr_b16 a[206:207], v16 offset:6656
  s_waitcnt lgkmcnt(0)
  s_barrier
  s_add_u32 s30, s28, 1146880
  s_add_u32 m0, s36, 0
  s_nop 0
  buffer_load_dwordx4 v3, s[8:11], s30 offen lds
  s_add_u32 s30, s28, 1157120
  s_add_u32 m0, s36, 1024
  s_nop 0
  buffer_load_dwordx4 v3, s[8:11], s30 offen lds
  s_waitcnt vmcnt(2)
  s_barrier
  ds_read_b64_tr_b16 a[208:209], v16 offset:16384
  ds_read_b64_tr_b16 a[210:211], v16 offset:16896
  ds_read_b64_tr_b16 a[212:213], v16 offset:18432
  ds_read_b64_tr_b16 a[214:215], v16 offset:18944
  ds_read_b64_tr_b16 a[216:217], v16 offset:20480
  ds_read_b64_tr_b16 a[218:219], v16 offset:20992
  ds_read_b64_tr_b16 a[220:221], v16 offset:22528
  ds_read_b64_tr_b16 a[222:223], v16 offset:23040
  s_waitcnt lgkmcnt(0)
  s_barrier
  s_add_u32 s30, s28, 1228800
  s_add_u32 m0, s36, 16384
  s_nop 0
  buffer_load_dwordx4 v3, s[8:11], s30 offen lds
  s_add_u32 s30, s28, 1239040
  s_add_u32 m0, s36, 17408
  s_nop 0
  buffer_load_dwordx4 v3, s[8:11], s30 offen lds
  s_waitcnt vmcnt(2)
  s_barrier
  ds_read_b64_tr_b16 a[224:225], v16 offset:0
  ds_read_b64_tr_b16 a[226:227], v16 offset:512
  ds_read_b64_tr_b16 a[228:229], v16 offset:2048
  ds_read_b64_tr_b16 a[230:231], v16 offset:2560
  ds_read_b64_tr_b16 a[232:233], v16 offset:4096
  ds_read_b64_tr_b16 a[234:235], v16 offset:4608
  ds_read_b64_tr_b16 a[236:237], v16 offset:6144
  ds_read_b64_tr_b16 a[238:239], v16 offset:6656
  s_waitcnt lgkmcnt(0)
  s_barrier
  s_add_u32 s30, s28, 1310720
  s_add_u32 m0, s36, 0
  s_nop 0
  buffer_load_dwordx4 v3, s[8:11], s30 offen lds
  s_add_u32 s30, s28, 1320960
  s_add_u32 m0, s36, 1024
  s_nop 0
  buffer_load_dwordx4 v3, s[8:11], s30 offen lds
  s_waitcnt vmcnt(2)
  s_barrier
  ds_read_b64_tr_b16 a[240:241], v16 offset:16384
  ds_read_b64_tr_b16 a[242:243], v16 offset:16896
  ds_read_b64_tr_b16 a[244:245], v16 offset:18432
  ds_read_b64_tr_b16 a[246:247], v16 offset:18944
  ds_read_b64_tr_b16 a[248:249], v16 offset:20480
  ds_read_b64_tr_b16 a[250:251], v16 offset:20992
  ds_read_b64_tr_b16 a[252:253], v16 offset:22528
  ds_read_b64_tr_b16 a[254:255], v16 offset:23040
  s_waitcnt lgkmcnt(0)
  s_barrier
  s_add_u32 s30, s28, 1392640
  s_add_u32 m0, s36, 16384
  s_nop 0
  buffer_load_dwordx4 v3, s[8:11], s30 offen lds
  s_add_u32 s30, s28, 1402880
  s_add_u32 m0, s36, 17408
  s_nop 0
  buffer_load_dwordx4 v3, s[8:11], s30 offen lds
  s_waitcnt vmcnt(2)
  s_barrier
  ds_read_b64_tr_b16 v[80:81], v16 offset:0
  ds_read_b64_tr_b16 v[82:83], v16 offset:512
  ds_read_b64_tr_b16 v[84:85], v16 offset:2048
  ds_read_b64_tr_b16 v[86:87], v16 offset:2560
  ds_read_b64_tr_b16 v[88:89], v16 offset:4096
  ds_read_b64_tr_b16 v[90:91], v16 offset:4608
  ds_read_b64_tr_b16 v[92:93], v16 offset:6144
  ds_read_b64_tr_b16 v[94:95], v16 offset:6656
  s_waitcnt lgkmcnt(0)
  s_barrier
  s_add_u32 s30, s28, 1474560
  s_add_u32 m0, s36, 0
  s_nop 0
  buffer_load_dwordx4 v3, s[8:11], s30 offen lds
  s_add_u32 s30, s28, 1484800
  s_add_u32 m0, s36, 1024
  s_nop 0
  buffer_load_dwordx4 v3, s[8:11], s30 offen lds
  s_waitcnt vmcnt(2)
  s_barrier
  ds_read_b64_tr_b16 v[96:97], v16 offset:16384
  ds_read_b64_tr_b16 v[98:99], v16 offset:16896
  ds_read_b64_tr_b16 v[100:101], v16 offset:18432
  ds_read_b64_tr_b16 v[102:103], v16 offset:18944
  ds_read_b64_tr_b16 v[104:105], v16 offset:20480
  ds_read_b64_tr_b16 v[106:107], v16 offset:20992
  ds_read_b64_tr_b16 v[108:109], v16 offset:22528
  ds_read_b64_tr_b16 v[110:111], v16 offset:23040
  s_waitcnt lgkmcnt(0)
  s_barrier
  s_add_u32 s30, s28, 1556480
  s_add_u32 m0, s36, 16384
  s_nop 0
  buffer_load_dwordx4 v3, s[8:11], s30 offen lds
  s_add_u32 s30, s28, 1566720
  s_add_u32 m0, s36, 17408
  s_nop 0
  buffer_load_dwordx4 v3, s[8:11], s30 offen lds
  s_waitcnt vmcnt(2)
  s_barrier
  ds_read_b64_tr_b16 v[112:113], v16 offset:0
  ds_read_b64_tr_b16 v[114:115], v16 offset:512
  ds_read_b64_tr_b16 v[116:117], v16 offset:2048
  ds_read_b64_tr_b16 v[118:119], v16 offset:2560
  ds_read_b64_tr_b16 v[120:121], v16 offset:4096
  ds_read_b64_tr_b16 v[122:123], v16 offset:4608
  ds_read_b64_tr_b16 v[124:125], v16 offset:6144
  ds_read_b64_tr_b16 v[126:127], v16 offset:6656
  s_waitcnt lgkmcnt(0)
  s_barrier
  s_add_u32 s30, s28, 1638400
  s_add_u32 m0, s36, 0
  s_nop 0
  buffer_load_dwordx4 v3, s[8:11], s30 offen lds
  s_add_u32 s30, s28, 1648640
  s_add_u32 m0, s36, 1024
  s_nop 0
  buffer_load_dwordx4 v3, s[8:11], s30 offen lds
  s_waitcnt vmcnt(2)
  s_barrier
  ds_read_b64_tr_b16 v[128:129], v16 offset:16384
  ds_read_b64_tr_b16 v[130:131], v16 offset:16896
  ds_read_b64_tr_b16 v[132:133], v16 offset:18432
  ds_read_b64_tr_b16 v[134:135], v16 offset:18944
  ds_read_b64_tr_b16 v[136:137], v16 offset:20480
  ds_read_b64_tr_b16 v[138:139], v16 offset:20992
  ds_read_b64_tr_b16 v[140:141], v16 offset:22528
  ds_read_b64_tr_b16 v[142:143], v16 offset:23040
  s_waitcnt lgkmcnt(0)
  s_barrier
  s_add_u32 s30, s28, 1720320
  s_add_u32 m0, s36, 16384
  s_nop 0
  buffer_load_dwordx4 v3, s[8:11], s30 offen lds
  s_add_u32 s30, s28, 1730560
  s_add_u32 m0, s36, 17408
  s_nop 0
  buffer_load_dwordx4 v3, s[8:11], s30 offen lds
  s_waitcnt vmcnt(2)
  s_barrier
  ds_read_b64_tr_b16 v[144:145], v16 offset:0
  ds_read_b64_tr_b16 v[146:147], v16 offset:512
  ds_read_b64_tr_b16 v[148:149], v16 offset:2048
  ds_read_b64_tr_b16 v[150:151], v16 offset:2560
  ds_read_b64_tr_b16 v[152:153], v16 offset:4096
  ds_read_b64_tr_b16 v[154:155], v16 offset:4608
  ds_read_b64_tr_b16 v[156:157], v16 offset:6144
  ds_read_b64_tr_b16 v[158:159], v16 offset:6656
  s_waitcnt lgkmcnt(0)
  s_barrier
  s_add_u32 s30, s28, 1802240
  s_add_u32 m0, s36, 0
  s_nop 0
  buffer_load_dwordx4 v3, s[8:11], s30 offen lds
  s_add_u32 s30, s28, 1812480
  s_add_u32 m0, s36, 1024
  s_nop 0
  buffer_load_dwordx4 v3, s[8:11], s30 offen lds
  s_waitcnt vmcnt(2)
  s_barrier
  ds_read_b64_tr_b16 v[160:161], v16 offset:16384
  ds_read_b64_tr_b16 v[162:163], v16 offset:16896
  ds_read_b64_tr_b16 v[164:165], v16 offset:18432
  ds_read_b64_tr_b16 v[166:167], v16 offset:18944
  ds_read_b64_tr_b16 v[168:169], v16 offset:20480
  ds_read_b64_tr_b16 v[170:171], v16 offset:20992
  ds_read_b64_tr_b16 v[172:173], v16 offset:22528
  ds_read_b64_tr_b16 v[174:175], v16 offset:23040
  s_waitcnt lgkmcnt(0)
  s_barrier
  s_add_u32 s30, s28, 1884160
  s_add_u32 m0, s36, 16384
  s_nop 0
  buffer_load_dwordx4 v3, s[8:11], s30 offen lds
  s_add_u32 s30, s28, 1894400
  s_add_u32 m0, s36, 17408
  s_nop 0
  buffer_load_dwordx4 v3, s[8:11], s30 offen lds
  s_waitcnt vmcnt(2)
  s_barrier
  ds_read_b64_tr_b16 v[176:177], v16 offset:0
  ds_read_b64_tr_b16 v[178:179], v16 offset:512
  ds_read_b64_tr_b16 v[180:181], v16 offset:2048
  ds_read_b64_tr_b16 v[182:183], v16 offset:2560
  ds_read_b64_tr_b16 v[184:185], v16 offset:4096
  ds_read_b64_tr_b16 v[186:187], v16 offset:4608
  ds_read_b64_tr_b16 v[188:189], v16 offset:6144
  ds_read_b64_tr_b16 v[190:191], v16 offset:6656
  s_waitcnt lgkmcnt(0)
  s_barrier
  s_add_u32 s30, s28, 1966080
  s_add_u32 m0, s36, 0
  s_nop 0
  buffer_load_dwordx4 v3, s[8:11], s30 offen lds
  s_add_u32 s30, s28, 1976320
  s_add_u32 m0, s36, 1024
  s_nop 0
  buffer_load_dwordx4 v3, s[8:11], s30 offen lds
  s_waitcnt vmcnt(2)
  s_barrier
  ds_read_b64_tr_b16 v[192:193], v16 offset:16384
  ds_read_b64_tr_b16 v[194:195], v16 offset:16896
  ds_read_b64_tr_b16 v[196:197], v16 offset:18432
  ds_read_b64_tr_b16 v[198:199], v16 offset:18944
  ds_read_b64_tr_b16 v[200:201], v16 offset:20480
  ds_read_b64_tr_b16 v[202:203], v16 offset:20992
  ds_read_b64_tr_b16 v[204:205], v16 offset:22528
  ds_read_b64_tr_b16 v[206:207], v16 offset:23040
  s_waitcnt lgkmcnt(0)
  s_barrier
  s_add_u32 s30, s28, 2048000
  s_add_u32 m0, s36, 16384
  s_nop 0
  buffer_load_dwordx4 v3, s[8:11], s30 offen lds
  s_add_u32 s30, s28, 2058240
  s_add_u32 m0, s36, 17408
  s_nop 0
  buffer_load_dwordx4 v3, s[8:11], s30 offen lds
  s_waitcnt vmcnt(2)
  s_barrier
  ds_read_b64_tr_b16 v[208:209], v16 offset:0
  ds_read_b64_tr_b16 v[210:211], v16 offset:512
  ds_read_b64_tr_b16 v[212:213], v16 offset:2048
  ds_read_b64_tr_b16 v[214:215], v16 offset:2560
  ds_read_b64_tr_b16 v[216:217], v16 offset:4096
  ds_read_b64_tr_b16 v[218:219], v16 offset:4608
  ds_read_b64_tr_b16 v[220:221], v16 offset:6144
  ds_read_b64_tr_b16 v[222:223], v16 offset:6656
  s_waitcnt lgkmcnt(0)
  s_barrier
  s_add_u32 s30, s28, 2129920
  s_add_u32 m0, s36, 0
  s_nop 0
  buffer_load_dwordx4 v3, s[8:11], s30 offen lds
  s_add_u32 s30, s28, 2140160
  s_add_u32 m0, s36, 1024
  s_nop 0
  buffer_load_dwordx4 v3, s[8:11], s30 offen lds
  s_waitcnt vmcnt(2)
  s_barrier
  ds_read_b64_tr_b16 v[224:225], v16 offset:16384
  ds_read_b64_tr_b16 v[226:227], v16 offset:16896
  ds_read_b64_tr_b16 v[228:229], v16 offset:18432
  ds_read_b64_tr_b16 v[230:231], v16 offset:18944
  ds_read_b64_tr_b16 v[232:233], v16 offset:20480
  ds_read_b64_tr_b16 v[234:235], v16 offset:20992
  ds_read_b64_tr_b16 v[236:237], v16 offset:22528
  ds_read_b64_tr_b16 v[238:239], v16 offset:23040
  s_waitcnt lgkmcnt(0)
  s_waitcnt vmcnt(0)
  s_barrier
  ds_read_b64_tr_b16 v[240:241], v16 offset:0
  ds_read_b64_tr_b16 v[242:243], v16 offset:512
  ds_read_b64_tr_b16 v[244:245], v16 offset:2048
  ds_read_b64_tr_b16 v[246:247], v16 offset:2560
  ds_read_b64_tr_b16 v[248:249], v16 offset:4096
  ds_read_b64_tr_b16 v[250:251], v16 offset:4608
  ds_read_b64_tr_b16 v[252:253], v16 offset:6144
  ds_read_b64_tr_b16 v[254:255], v16 offset:6656
  s_waitcnt lgkmcnt(0)
rlp_4400113:
  s_mov_b32 s39, s62
  s_lshl_b32 s49, s38, 7
  s_add_u32 s49, s49, 85086208
  v_readfirstlane_b32 s56, v31
  s_nop 0
  s_cmp_ge_u32 s56, 64
  s_nop 0
  s_cbranch_scc1 wok_4400115
  v_mov_b32 v30, 0
wc_4400114:
  buffer_load_dword v29, v30, s[4:7], s49 offen sc1
  s_waitcnt vmcnt(0)
  v_readfirstlane_b32 s56, v29
  s_nop 0
  s_cmp_ge_u32 s56, 27
  s_nop 0
  s_cbranch_scc1 wok_4400115
  s_add_u32 s63, s63, 1
  s_cmp_gt_u32 s63, 4194304
  s_cbranch_scc1 fz_fail
  s_cmp_ge_u32 s38, 31
  s_cbranch_scc1 nap_4400116
  s_sleep 24
  s_branch nape_4400117
nap_4400116:
  s_sleep 12
nape_4400117:
  s_branch wc_4400114
wok_4400115:
  s_barrier
  s_lshl_b32 s30, s38, 6
  s_lshl_b32 s31, s24, 4
  s_add_u32 s30, s30, s31
  s_mul_i32 s27, s30, 3456
  s_add_u32 s27, s27, 94371840
  s_add_u32 s30, s27, 0
  s_add_u32 m0, s35, 0
  s_nop 0
  buffer_load_dwordx4 v1, s[4:7], s30 offen lds
  s_add_u32 s30, s27, 27648
  s_add_u32 m0, s35, 1024
  s_nop 0
  buffer_load_dwordx4 v2, s[4:7], s30 offen lds
  s_add_u32 s30, s27, 128
  s_add_u32 m0, s35, 8192
  s_nop 0
  buffer_load_dwordx4 v1, s[4:7], s30 offen lds
  s_add_u32 s30, s27, 27776
  s_add_u32 m0, s35, 9216
  s_nop 0
  buffer_load_dwordx4 v2, s[4:7], s30 offen lds
  s_add_u32 s30, s27, 256
  s_add_u32 m0, s35, 16384
  s_nop 0
  buffer_load_dwordx4 v1, s[4:7], s30 offen lds
  s_add_u32 s30, s27, 27904
  s_add_u32 m0, s35, 17408
  s_nop 0
  buffer_load_dwordx4 v2, s[4:7], s30 offen lds
  s_add_u32 s30, s27, 384
  s_add_u32 m0, s35, 24576
  s_nop 0
  buffer_load_dwordx4 v1, s[4:7], s30 offen lds
  s_add_u32 s30, s27, 28032
  s_add_u32 m0, s35, 25600
  s_nop 0
  buffer_load_dwordx4 v2, s[4:7], s30 offen lds
  s_add_u32 s30, s27, 512
  s_add_u32 m0, s35, 32768
  s_nop 0
  buffer_load_dwordx4 v1, s[4:7], s30 offen lds
  s_add_u32 s30, s27, 28160
  s_add_u32 m0, s35, 33792
  s_nop 0
  buffer_load_dwordx4 v2, s[4:7], s30 offen lds
  s_add_u32 s30, s27, 640
  s_add_u32 m0, s35, 40960
  s_nop 0
  buffer_load_dwordx4 v1, s[4:7], s30 offen lds
  s_add_u32 s30, s27, 28288
  s_add_u32 m0, s35, 41984
  s_nop 0
  buffer_load_dwordx4 v2, s[4:7], s30 offen lds
  s_add_u32 s30, s27, 768
  s_add_u32 m0, s35, 49152
  s_nop 0
  buffer_load_dwordx4 v1, s[4:7], s30 offen lds
  s_add_u32 s30, s27, 28416
  s_add_u32 m0, s35, 50176
  s_nop 0
  buffer_load_dwordx4 v2, s[4:7], s30 offen lds
  s_add_u32 s30, s27, 896
  s_add_u32 m0, s35, 57344
  s_nop 0
  buffer_load_dwordx4 v1, s[4:7], s30 offen lds
  s_add_u32 s30, s27, 28544
  s_add_u32 m0, s35, 58368
  s_nop 0
  buffer_load_dwordx4 v2, s[4:7], s30 offen lds
  s_add_u32 s30, s27, 1024
  s_add_u32 m0, s35, 65536
  s_nop 0
  buffer_load_dwordx4 v1, s[4:7], s30 offen lds
  s_add_u32 s30, s27, 28672
  s_add_u32 m0, s35, 66560
  s_nop 0
  buffer_load_dwordx4 v2, s[4:7], s30 offen lds
  s_add_u32 s30, s27, 1152
  s_add_u32 m0, s35, 73728
  s_nop 0
  buffer_load_dwordx4 v1, s[4:7], s30 offen lds
  s_add_u32 s30, s27, 28800
  s_add_u32 m0, s35, 74752
  s_nop 0
  buffer_load_dwordx4 v2, s[4:7], s30 offen lds
  s_add_u32 s30, s27, 1280
  s_add_u32 m0, s35, 81920
  s_nop 0
  buffer_load_dwordx4 v1, s[4:7], s30 offen lds
  s_add_u32 s30, s27, 28928
  s_add_u32 m0, s35, 82944
  s_nop 0
  buffer_load_dwordx4 v2, s[4:7], s30 offen lds
  s_add_u32 s30, s27, 1408
  s_add_u32 m0, s35, 90112
  s_nop 0
  buffer_load_dwordx4 v1, s[4:7], s30 offen lds
  s_add_u32 s30, s27, 29056
  s_add_u32 m0, s35, 91136
  s_nop 0
  buffer_load_dwordx4 v2, s[4:7], s30 offen lds
  s_add_u32 s30, s27, 1536
  s_add_u32 m0, s35, 98304
  s_nop 0
  buffer_load_dwordx4 v1, s[4:7], s30 offen lds
  s_add_u32 s30, s27, 29184
  s_add_u32 m0, s35, 99328
  s_nop 0
  buffer_load_dwordx4 v2, s[4:7], s30 offen lds
  s_add_u32 s30, s27, 1664
  s_add_u32 m0, s35, 106496
  s_nop 0
  buffer_load_dwordx4 v1, s[4:7], s30 offen lds
  s_add_u32 s30, s27, 29312
  s_add_u32 m0, s35, 107520
  s_nop 0
  buffer_load_dwordx4 v2, s[4:7], s30 offen lds
  s_add_u32 s30, s27, 1792
  s_add_u32 m0, s35, 114688
  s_nop 0
  buffer_load_dwordx4 v1, s[4:7], s30 offen lds
  s_add_u32 s30, s27, 29440
  s_add_u32 m0, s35, 115712
  s_nop 0
  buffer_load_dwordx4 v2, s[4:7], s30 offen lds
  s_add_u32 s30, s27, 1920
  s_add_u32 m0, s35, 122880
  s_nop 0
  buffer_load_dwordx4 v1, s[4:7], s30 offen lds
  s_add_u32 s30, s27, 29568
  s_add_u32 m0, s35, 123904
  s_nop 0
  buffer_load_dwordx4 v2, s[4:7], s30 offen lds
  v_mov_b64 v[64:65], 0
  v_mov_b64 v[66:67], 0
  v_mov_b64 v[68:69], 0
  v_mov_b64 v[70:71], 0
  v_mov_b64 v[72:73], 0
  v_mov_b64 v[74:75], 0
  v_mov_b64 v[76:77], 0
  v_mov_b64 v[78:79], 0
  s_waitcnt vmcnt(30) lgkmcnt(0)
  s_barrier
  ds_read_b128 v[32:35], v4 offset:0
  ds_read_b128 v[36:39], v5 offset:0
  ds_read_b128 v[40:43], v6 offset:0
  ds_read_b128 v[44:47], v7 offset:0
  s_waitcnt vmcnt(28) lgkmcnt(0)
  s_barrier
  v_mfma_f32_32x32x16_bf16 v[64:79], a[0:3], v[32:35], v[64:79]
  ds_read_b128 v[48:51], v4 offset:8192
  v_mfma_f32_32x32x16_bf16 v[64:79], a[4:7], v[36:39], v[64:79]
  ds_read_b128 v[52:55], v5 offset:8192
  v_mfma_f32_32x32x16_bf16 v[64:79], a[8:11], v[40:43], v[64:79]
  ds_read_b128 v[56:59], v6 offset:8192
  v_mfma_f32_32x32x16_bf16 v[64:79], a[12:15], v[44:47], v[64:79]
  ds_read_b128 v[60:63], v7 offset:8192
  s_add_u32 s30, s27, 2048
  s_add_u32 m0, s35, 0
  s_nop 0
  buffer_load_dwordx4 v1, s[4:7], s30 offen lds
  s_add_u32 s30, s27, 29696
  s_add_u32 m0, s35, 1024
  s_nop 0
  buffer_load_dwordx4 v2, s[4:7], s30 offen lds
  s_waitcnt vmcnt(28) lgkmcnt(0)
  s_barrier
  v_mfma_f32_32x32x16_bf16 v[64:79], a[16:19], v[48:51], v[64:79]
  ds_read_b128 v[32:35], v4 offset:16384
  v_mfma_f32_32x32x16_bf16 v[64:79], a[20:23], v[52:55], v[64:79]
  ds_read_b128 v[36:39], v5 offset:16384
  v_mfma_f32_32x32x16_bf16 v[64:79], a[24:27], v[56:59], v[64:79]
  ds_read_b128 v[40:43], v6 offset:16384
  v_mfma_f32_32x32x16_bf16 v[64:79], a[28:31], v[60:63], v[64:79]
  ds_read_b128 v[44:47], v7 offset:16384
  s_add_u32 s30, s27, 2176
  s_add_u32 m0, s35, 8192
  s_nop 0
  buffer_load_dwordx4 v1, s[4:7], s30 offen lds
  s_add_u32 s30, s27, 29824
  s_add_u32 m0, s35, 9216
  s_nop 0
  buffer_load_dwordx4 v2, s[4:7], s30 offen lds
  s_waitcnt vmcnt(28) lgkmcnt(0)
  s_barrier
  v_mfma_f32_32x32x16_bf16 v[64:79], a[32:35], v[32:35], v[64:79]
  ds_read_b128 v[48:51], v4 offset:24576
  v_mfma_f32_32x32x16_bf16 v[64:79], a[36:39], v[36:39], v[64:79]
  ds_read_b128 v[52:55], v5 offset:24576
  v_mfma_f32_32x32x16_bf16 v[64:79], a[40:43], v[40:43], v[64:79]
  ds_read_b128 v[56:59], v6 offset:24576
  v_mfma_f32_32x32x16_bf16 v[64:79], a[44:47], v[44:47], v[64:79]
  ds_read_b128 v[60:63], v7 offset:24576
  s_add_u32 s30, s27, 2304
  s_add_u32 m0, s35, 16384
  s_nop 0
  buffer_load_dwordx4 v1, s[4:7], s30 offen lds
  s_add_u32 s30, s27, 29952
  s_add_u32 m0, s35, 17408
  s_nop 0
  buffer_load_dwordx4 v2, s[4:7], s30 offen lds
  s_waitcnt vmcnt(28) lgkmcnt(0)
  s_barrier
  v_mfma_f32_32x32x16_bf16 v[64:79], a[48:51], v[48:51], v[64:79]
  ds_read_b128 v[32:35], v4 offset:32768
  v_mfma_f32_32x32x16_bf16 v[64:79], a[52:55], v[52:55], v[64:79]
  ds_read_b128 v[36:39], v5 offset:32768
  v_mfma_f32_32x32x16_bf16 v[64:79], a[56:59], v[56:59], v[64:79]
  ds_read_b128 v[40:43], v6 offset:32768
  v_mfma_f32_32x32x16_bf16 v[64:79], a[60:63], v[60:63], v[64:79]
  ds_read_b128 v[44:47], v7 offset:32768
  s_add_u32 s30, s27, 2432
  s_add_u32 m0, s35, 24576
  s_nop 0
  buffer_load_dwordx4 v1, s[4:7], s30 offen lds
  s_add_u32 s30, s27, 30080
  s_add_u32 m0, s35, 25600
  s_nop 0
  buffer_load_dwordx4 v2, s[4:7], s30 offen lds
  s_waitcnt vmcnt(28) lgkmcnt(0)
  s_barrier
  v_mfma_f32_32x32x16_bf16 v[64:79], a[64:67], v[32:35], v[64:79]
  ds_read_b128 v[48:51], v4 offset:40960
  v_mfma_f32_32x32x16_bf16 v[64:79], a[68:71], v[36:39], v[64:79]
  ds_read_b128 v[52:55], v5 offset:40960
  v_mfma_f32_32x32x16_bf16 v[64:79], a[72:75], v[40:43], v[64:79]
  ds_read_b128 v[56:59], v6 offset:40960
  v_mfma_f32_32x32x16_bf16 v[64:79], a[76:79], v[44:47], v[64:79]
  ds_read_b128 v[60:63], v7 offset:40960
  s_add_u32 s30, s27, 2560
  s_add_u32 m0, s35, 32768
  s_nop 0
  buffer_load_dwordx4 v1, s[4:7], s30 offen lds
  s_add_u32 s30, s27, 30208
  s_add_u32 m0, s35, 33792
  s_nop 0
  buffer_load_dwordx4 v2, s[4:7], s30 offen lds
  s_waitcnt vmcnt(28) lgkmcnt(0)
  s_barrier
  v_mfma_f32_32x32x16_bf16 v[64:79], a[80:83], v[48:51], v[64:79]
  ds_read_b128 v[32:35], v4 offset:49152
  v_mfma_f32_32x32x16_bf16 v[64:79], a[84:87], v[52:55], v[64:79]
  ds_read_b128 v[36:39], v5 offset:49152
  v_mfma_f32_32x32x16_bf16 v[64:79], a[88:91], v[56:59], v[64:79]
  ds_read_b128 v[40:43], v6 offset:49152
  v_mfma_f32_32x32x16_bf16 v[64:79], a[92:95], v[60:63], v[64:79]
  ds_read_b128 v[44:47], v7 offset:49152
  s_add_u32 s30, s27, 2688
  s_add_u32 m0, s35, 40960
  s_nop 0
  buffer_load_dwordx4 v1, s[4:7], s30 offen lds
  s_add_u32 s30, s27, 30336
  s_add_u32 m0, s35, 41984
  s_nop 0
  buffer_load_dwordx4 v2, s[4:7], s30 offen lds
  s_waitcnt vmcnt(28) lgkmcnt(0)
  s_barrier
  v_mfma_f32_32x32x16_bf16 v[64:79], a[96:99], v[32:35], v[64:79]
  ds_read_b128 v[48:51], v4 offset:57344
  v_mfma_f32_32x32x16_bf16 v[64:79], a[100:103], v[36:39], v[64:79]
  ds_read_b128 v[52:55], v5 offset:57344
  v_mfma_f32_32x32x16_bf16 v[64:79], a[104:107], v[40:43], v[64:79]
  ds_read_b128 v[56:59], v6 offset:57344
  v_mfma_f32_32x32x16_bf16 v[64:79], a[108:111], v[44:47], v[64:79]
  ds_read_b128 v[60:63], v7 offset:57344
  s_add_u32 s30, s27, 2816
  s_add_u32 m0, s35, 49152
  s_nop 0
  buffer_load_dwordx4 v1, s[4:7], s30 offen lds
  s_add_u32 s30, s27, 30464
  s_add_u32 m0, s35, 50176
  s_nop 0
  buffer_load_dwordx4 v2, s[4:7], s30 offen lds
  s_waitcnt vmcnt(28) lgkmcnt(0)
  s_barrier
  v_mfma_f32_32x32x16_bf16 v[64:79], a[112:115], v[48:51], v[64:79]
  ds_read_b128 v[32:35], v8 offset:0
  v_mfma_f32_32x32x16_bf16 v[64:79], a[116:119], v[52:55], v[64:79]
  ds_read_b128 v[36:39], v9 offset:0
  v_mfma_f32_32x32x16_bf16 v[64:79], a[120:123], v[56:59], v[64:79]
  ds_read_b128 v[40:43], v10 offset:0
  v_mfma_f32_32x32x16_bf16 v[64:79], a[124:127], v[60:63], v[64:79]
  ds_read_b128 v[44:47], v11 offset:0
  s_add_u32 s30, s27, 2944
  s_add_u32 m0, s35, 57344
  s_nop 0
  buffer_load_dwordx4 v1, s[4:7], s30 offen lds
  s_add_u32 s30, s27, 30592
  s_add_u32 m0, s35, 58368
  s_nop 0
  buffer_load_dwordx4 v2, s[4:7], s30 offen lds
  s_waitcnt vmcnt(28) lgkmcnt(0)
  s_barrier
  v_mfma_f32_32x32x16_bf16 v[64:79], a[128:131], v[32:35], v[64:79]
  ds_read_b128 v[48:51], v8 offset:8192
  v_mfma_f32_32x32x16_bf16 v[64:79], a[132:135], v[36:39], v[64:79]
  ds_read_b128 v[52:55], v9 offset:8192
  v_mfma_f32_32x32x16_bf16 v[64:79], a[136:139], v[40:43], v[64:79]
  ds_read_b128 v[56:59], v10 offset:8192
  v_mfma_f32_32x32x16_bf16 v[64:79], a[140:143], v[44:47], v[64:79]
  ds_read_b128 v[60:63], v11 offset:8192
  s_add_u32 s30, s27, 3072
  s_add_u32 m0, s35, 65536
  s_nop 0
  buffer_load_dwordx4 v1, s[4:7], s30 offen lds
  s_add_u32 s30, s27, 30720
  s_add_u32 m0, s35, 66560
  s_nop 0
  buffer_load_dwordx4 v2, s[4:7], s30 offen lds
  s_waitcnt vmcnt(28) lgkmcnt(0)
  s_barrier
  v_mfma_f32_32x32x16_bf16 v[64:79], a[144:147], v[48:51], v[64:79]
  ds_read_b128 v[32:35], v8 offset:16384
  v_mfma_f32_32x32x16_bf16 v[64:79], a[148:151], v[52:55], v[64:79]
  ds_read_b128 v[36:39], v9 offset:16384
  v_mfma_f32_32x32x16_bf16 v[64:79], a[152:155], v[56:59], v[64:79]
  ds_read_b128 v[40:43], v10 offset:16384
  v_mfma_f32_32x32x16_bf16 v[64:79], a[156:159], v[60:63], v[64:79]
  ds_read_b128 v[44:47], v11 offset:16384
  s_add_u32 s30, s27, 3200
  s_add_u32 m0, s35, 73728
  s_nop 0
  buffer_load_dwordx4 v1, s[4:7], s30 offen lds
  s_add_u32 s30, s27, 30848
  s_add_u32 m0, s35, 74752
  s_nop 0
  buffer_load_dwordx4 v2, s[4:7], s30 offen lds
  s_waitcnt vmcnt(28) lgkmcnt(0)
  s_barrier
  v_mfma_f32_32x32x16_bf16 v[64:79], a[160:163], v[32:35], v[64:79]
  ds_read_b128 v[48:51], v8 offset:24576
  v_mfma_f32_32x32x16_bf16 v[64:79], a[164:167], v[36:39], v[64:79]
  ds_read_b128 v[52:55], v9 offset:24576
  v_mfma_f32_32x32x16_bf16 v[64:79], a[168:171], v[40:43], v[64:79]
  ds_read_b128 v[56:59], v10 offset:24576
  v_mfma_f32_32x32x16_bf16 v[64:79], a[172:175], v[44:47], v[64:79]
  ds_read_b128 v[60:63], v11 offset:24576
  s_add_u32 s30, s27, 3328
  s_add_u32 m0, s35, 81920
  s_nop 0
  buffer_load_dwordx4 v1, s[4:7], s30 offen lds
  s_add_u32 s30, s27, 30976
  s_add_u32 m0, s35, 82944
  s_nop 0
  buffer_load_dwordx4 v2, s[4:7], s30 offen lds
  s_waitcnt vmcnt(28) lgkmcnt(0)
  s_barrier
  v_mfma_f32_32x32x16_bf16 v[64:79], a[176:179], v[48:51], v[64:79]
  ds_read_b128 v[32:35], v8 offset:32768
  v_mfma_f32_32x32x16_bf16 v[64:79], a[180:183], v[52:55], v[64:79]
  ds_read_b128 v[36:39], v9 offset:32768
  v_mfma_f32_32x32x16_bf16 v[64:79], a[184:187], v[56:59], v[64:79]
  ds_read_b128 v[40:43], v10 offset:32768
  v_mfma_f32_32x32x16_bf16 v[64:79], a[188:191], v[60:63], v[64:79]
  ds_read_b128 v[44:47], v11 offset:32768
  s_waitcnt vmcnt(26) lgkmcnt(0)
  s_barrier
  v_mfma_f32_32x32x16_bf16 v[64:79], a[192:195], v[32:35], v[64:79]
  ds_read_b128 v[48:51], v8 offset:40960
  v_mfma_f32_32x32x16_bf16 v[64:79], a[196:199], v[36:39], v[64:79]
  ds_read_b128 v[52:55], v9 offset:40960
  v_mfma_f32_32x32x16_bf16 v[64:79], a[200:203], v[40:43], v[64:79]
  ds_read_b128 v[56:59], v10 offset:40960
  v_mfma_f32_32x32x16_bf16 v[64:79], a[204:207], v[44:47], v[64:79]
  ds_read_b128 v[60:63], v11 offset:40960
  s_waitcnt vmcnt(24) lgkmcnt(0)
  s_barrier
  v_mfma_f32_32x32x16_bf16 v[64:79], a[208:211], v[48:51], v[64:79]
  ds_read_b128 v[32:35], v8 offset:49152
  v_mfma_f32_32x32x16_bf16 v[64:79], a[212:215], v[52:55], v[64:79]
  ds_read_b128 v[36:39], v9 offset:49152
  v_mfma_f32_32x32x16_bf16 v[64:79], a[216:219], v[56:59], v[64:79]
  ds_read_b128 v[40:43], v10 offset:49152
  v_mfma_f32_32x32x16_bf16 v[64:79], a[220:223], v[60:63], v[64:79]
  ds_read_b128 v[44:47], v11 offset:49152
  s_waitcnt vmcnt(22) lgkmcnt(0)
  s_barrier
  v_mfma_f32_32x32x16_bf16 v[64:79], a[224:227], v[32:35], v[64:79]
  ds_read_b128 v[48:51], v8 offset:57344
  v_mfma_f32_32x32x16_bf16 v[64:79], a[228:231], v[36:39], v[64:79]
  ds_read_b128 v[52:55], v9 offset:57344
  v_mfma_f32_32x32x16_bf16 v[64:79], a[232:235], v[40:43], v[64:79]
  ds_read_b128 v[56:59], v10 offset:57344
  v_mfma_f32_32x32x16_bf16 v[64:79], a[236:239], v[44:47], v[64:79]
  ds_read_b128 v[60:63], v11 offset:57344
  s_waitcnt vmcnt(20) lgkmcnt(0)
  s_barrier
  v_mfma_f32_32x32x16_bf16 v[64:79], a[240:243], v[48:51], v[64:79]
  ds_read_b128 v[32:35], v4 offset:0
  v_mfma_f32_32x32x16_bf16 v[64:79], a[244:247], v[52:55], v[64:79]
  ds_read_b128 v[36:39], v5 offset:0
  v_mfma_f32_32x32x16_bf16 v[64:79], a[248:251], v[56:59], v[64:79]
  ds_read_b128 v[40:43], v6 offset:0
  v_mfma_f32_32x32x16_bf16 v[64:79], a[252:255], v[60:63], v[64:79]
  ds_read_b128 v[44:47], v7 offset:0
  s_waitcnt vmcnt(18) lgkmcnt(0)
  s_barrier
  v_mfma_f32_32x32x16_bf16 v[64:79], v[80:83], v[32:35], v[64:79]
  ds_read_b128 v[48:51], v4 offset:8192
  v_mfma_f32_32x32x16_bf16 v[64:79], v[84:87], v[36:39], v[64:79]
  ds_read_b128 v[52:55], v5 offset:8192
  v_mfma_f32_32x32x16_bf16 v[64:79], v[88:91], v[40:43], v[64:79]
  ds_read_b128 v[56:59], v6 offset:8192
  v_mfma_f32_32x32x16_bf16 v[64:79], v[92:95], v[44:47], v[64:79]
  ds_read_b128 v[60:63], v7 offset:8192
  s_waitcnt vmcnt(16) lgkmcnt(0)
  s_barrier
  v_mfma_f32_32x32x16_bf16 v[64:79], v[96:99], v[48:51], v[64:79]
  ds_read_b128 v[32:35], v4 offset:16384
  v_mfma_f32_32x32x16_bf16 v[64:79], v[100:103], v[52:55], v[64:79]
  ds_read_b128 v[36:39], v5 offset:16384
  v_mfma_f32_32x32x16_bf16 v[64:79], v[104:107], v[56:59], v[64:79]
  ds_read_b128 v[40:43], v6 offset:16384
  v_mfma_f32_32x32x16_bf16 v[64:79], v[108:111], v[60:63], v[64:79]
  ds_read_b128 v[44:47], v7 offset:16384
  s_waitcnt vmcnt(14) lgkmcnt(0)
  s_barrier
  v_mfma_f32_32x32x16_bf16 v[64:79], v[112:115], v[32:35], v[64:79]
  ds_read_b128 v[48:51], v4 offset:24576
  v_mfma_f32_32x32x16_bf16 v[64:79], v[116:119], v[36:39], v[64:79]
  ds_read_b128 v[52:55], v5 offset:24576
  v_mfma_f32_32x32x16_bf16 v[64:79], v[120:123], v[40:43], v[64:79]
  ds_read_b128 v[56:59], v6 offset:24576
  v_mfma_f32_32x32x16_bf16 v[64:79], v[124:127], v[44:47], v[64:79]
  ds_read_b128 v[60:63], v7 offset:24576
  s_waitcnt vmcnt(12) lgkmcnt(0)
  s_barrier
  v_mfma_f32_32x32x16_bf16 v[64:79], v[128:131], v[48:51], v[64:79]
  ds_read_b128 v[32:35], v4 offset:32768
  v_mfma_f32_32x32x16_bf16 v[64:79], v[132:135], v[52:55], v[64:79]
  ds_read_b128 v[36:39], v5 offset:32768
  v_mfma_f32_32x32x16_bf16 v[64:79], v[136:139], v[56:59], v[64:79]
  ds_read_b128 v[40:43], v6 offset:32768
  v_mfma_f32_32x32x16_bf16 v[64:79], v[140:143], v[60:63], v[64:79]
  ds_read_b128 v[44:47], v7 offset:32768
  s_waitcnt vmcnt(10) lgkmcnt(0)
  s_barrier
  v_mfma_f32_32x32x16_bf16 v[64:79], v[144:147], v[32:35], v[64:79]
  ds_read_b128 v[48:51], v4 offset:40960
  v_mfma_f32_32x32x16_bf16 v[64:79], v[148:151], v[36:39], v[64:79]
  ds_read_b128 v[52:55], v5 offset:40960
  v_mfma_f32_32x32x16_bf16 v[64:79], v[152:155], v[40:43], v[64:79]
  ds_read_b128 v[56:59], v6 offset:40960
  v_mfma_f32_32x32x16_bf16 v[64:79], v[156:159], v[44:47], v[64:79]
  ds_read_b128 v[60:63], v7 offset:40960
  s_waitcnt vmcnt(8) lgkmcnt(0)
  s_barrier
  v_mfma_f32_32x32x16_bf16 v[64:79], v[160:163], v[48:51], v[64:79]
  ds_read_b128 v[32:35], v4 offset:49152
  v_mfma_f32_32x32x16_bf16 v[64:79], v[164:167], v[52:55], v[64:79]
  ds_read_b128 v[36:39], v5 offset:49152
  v_mfma_f32_32x32x16_bf16 v[64:79], v[168:171], v[56:59], v[64:79]
  ds_read_b128 v[40:43], v6 offset:49152
  v_mfma_f32_32x32x16_bf16 v[64:79], v[172:175], v[60:63], v[64:79]
  ds_read_b128 v[44:47], v7 offset:49152
  s_waitcnt vmcnt(6) lgkmcnt(0)
  s_barrier
  v_mfma_f32_32x32x16_bf16 v[64:79], v[176:179], v[32:35], v[64:79]
  ds_read_b128 v[48:51], v4 offset:57344
  v_mfma_f32_32x32x16_bf16 v[64:79], v[180:183], v[36:39], v[64:79]
  ds_read_b128 v[52:55], v5 offset:57344
  v_mfma_f32_32x32x16_bf16 v[64:79], v[184:187], v[40:43], v[64:79]
  ds_read_b128 v[56:59], v6 offset:57344
  v_mfma_f32_32x32x16_bf16 v[64:79], v[188:191], v[44:47], v[64:79]
  ds_read_b128 v[60:63], v7 offset:57344
  s_waitcnt vmcnt(4) lgkmcnt(0)
  s_barrier
  v_mfma_f32_32x32x16_bf16 v[64:79], v[192:195], v[48:51], v[64:79]
  ds_read_b128 v[32:35], v8 offset:0
  v_mfma_f32_32x32x16_bf16 v[64:79], v[196:199], v[52:55], v[64:79]
  ds_read_b128 v[36:39], v9 offset:0
  v_mfma_f32_32x32x16_bf16 v[64:79], v[200:203], v[56:59], v[64:79]
  ds_read_b128 v[40:43], v10 offset:0
  v_mfma_f32_32x32x16_bf16 v[64:79], v[204:207], v[60:63], v[64:79]
  ds_read_b128 v[44:47], v11 offset:0
  s_waitcnt vmcnt(2) lgkmcnt(0)
  s_barrier
  v_mfma_f32_32x32x16_bf16 v[64:79], v[208:211], v[32:35], v[64:79]
  ds_read_b128 v[48:51], v8 offset:8192
  v_mfma_f32_32x32x16_bf16 v[64:79], v[212:215], v[36:39], v[64:79]
  ds_read_b128 v[52:55], v9 offset:8192
  v_mfma_f32_32x32x16_bf16 v[64:79], v[216:219], v[40:43], v[64:79]
  ds_read_b128 v[56:59], v10 offset:8192
  v_mfma_f32_32x32x16_bf16 v[64:79], v[220:223], v[44:47], v[64:79]
  ds_read_b128 v[60:63], v11 offset:8192
  s_waitcnt vmcnt(0) lgkmcnt(0)
  s_barrier
  v_mfma_f32_32x32x16_bf16 v[64:79], v[224:227], v[48:51], v[64:79]
  ds_read_b128 v[32:35], v8 offset:16384
  v_mfma_f32_32x32x16_bf16 v[64:79], v[228:231], v[52:55], v[64:79]
  ds_read_b128 v[36:39], v9 offset:16384
  v_mfma_f32_32x32x16_bf16 v[64:79], v[232:235], v[56:59], v[64:79]
  ds_read_b128 v[40:43], v10 offset:16384
  v_mfma_f32_32x32x16_bf16 v[64:79], v[236:239], v[60:63], v[64:79]
  ds_read_b128 v[44:47], v11 offset:16384
  s_waitcnt lgkmcnt(0)
  v_mfma_f32_32x32x16_bf16 v[64:79], v[240:243], v[32:35], v[64:79]
  v_mfma_f32_32x32x16_bf16 v[64:79], v[244:247], v[36:39], v[64:79]
  v_mfma_f32_32x32x16_bf16 v[64:79], v[248:251], v[40:43], v[64:79]
  v_mfma_f32_32x32x16_bf16 v[64:79], v[252:255], v[44:47], v[64:79]
  v_and_b32 v22, 31, v0
  v_mul_u32_u24 v24, 2560, v22
  v_lshrrev_b32 v23, 5, v0
  v_lshlrev_b32 v25, 4, v23
  v_add_u32 v24, v24, v25
  v_mul_u32_u24 v22, 1280, v22
  v_add_u32 v22, v22, v25
  s_lshl_b32 s46, s38, 6
  s_lshl_b32 s47, s25, 5
  s_add_u32 s46, s46, s47
  s_mul_i32 s45, s46, 2560
  s_add_u32 s45, s45, 85983232
  s_lshl_b32 s47, s39, 8
  s_add_u32 s45, s45, s47
  s_lshl_b32 s47, s26, 7
  s_add_u32 s45, s45, s47
  s_mul_i32 s44, s46, 1280
  s_lshl_b32 s47, s39, 7
  s_add_u32 s44, s44, s47
  s_lshl_b32 s47, s26, 6
  s_add_u32 s44, s44, s47
  buffer_load_dwordx4 v[32:35], v24, s[4:7], s45 offen offset:0
  buffer_load_dwordx4 v[36:39], v24, s[4:7], s45 offen offset:32
  buffer_load_dwordx4 v[40:43], v24, s[4:7], s45 offen offset:64
  buffer_load_dwordx4 v[44:47], v24, s[4:7], s45 offen offset:96
  s_waitcnt vmcnt(0)
  v_add_f32 v64, v64, v32
  v_add_f32 v65, v65, v33
  v_add_f32 v66, v66, v34
  v_add_f32 v67, v67, v35
  v_add_f32 v68, v68, v36
  v_add_f32 v69, v69, v37
  v_add_f32 v70, v70, v38
  v_add_f32 v71, v71, v39
  v_add_f32 v72, v72, v40
  v_add_f32 v73, v73, v41
  v_add_f32 v74, v74, v42
  v_add_f32 v75, v75, v43
  v_add_f32 v76, v76, v44
  v_add_f32 v77, v77, v45
  v_add_f32 v78, v78, v46
  v_add_f32 v79, v79, v47
  v_cvt_pk_bf16_f32 v48, v64, v65
  v_cvt_pk_bf16_f32 v49, v66, v67
  v_cvt_pk_bf16_f32 v50, v68, v69
  v_cvt_pk_bf16_f32 v51, v70, v71
  v_cvt_pk_bf16_f32 v52, v72, v73
  v_cvt_pk_bf16_f32 v53, v74, v75
  v_cvt_pk_bf16_f32 v54, v76, v77
  v_cvt_pk_bf16_f32 v55, v78, v79
  v_permlane32_swap_b32 v48, v50
  v_permlane32_swap_b32 v49, v51
  v_permlane32_swap_b32 v52, v54
  v_permlane32_swap_b32 v53, v55
  buffer_store_dwordx4 v[48:51], v22, s[16:19], s44 offen
  buffer_store_dwordx4 v[52:55], v22, s[16:19], s44 offen offset:32
  s_barrier
  s_add_u32 s38, s38, 4
  s_cmp_lt_u32 s38, 32
  s_cbranch_scc1 rlp_4400113
  s_branch post_done
rk_4400112:
  s_sub_u32 s39, s39, 40
post_done:
  s_endpgm
fz_fail:
  s_load_dwordx2 s[8:9], s[0:1], 96
  s_mov_b32 s10, 256
  s_mov_b32 s11, 0x00020000
  s_waitcnt lgkmcnt(0)
  v_mov_b32 v1, 0xdead
  v_mov_b32 v2, 124
  buffer_store_dword v1, v2, s[8:11], 0 offen
  s_waitcnt vmcnt(0)
fz_end:
  s_endpgm

.section .rodata,"a"
.p2align 6
.amdhsa_kernel sequential_preLN__memory_aug_recurrent_mem_tr__swiglu_ffn__prompt_kernel
  .amdhsa_next_free_vgpr 512
  .amdhsa_next_free_sgpr 102
  .amdhsa_accum_offset 256
  .amdhsa_group_segment_fixed_size 0
  .amdhsa_kernarg_size 112
  .amdhsa_user_sgpr_count 2
  .amdhsa_user_sgpr_kernarg_segment_ptr 1
  .amdhsa_system_sgpr_workgroup_id_x 1
.end_amdhsa_kernel
```
